```python
import torch

def _softmax(x, axis=-1):
    return torch.softmax(x, dim=axis)

def _gelu(x):
    return torch.nn.functional.gelu(x, approximate='tanh')

def _silu(x):
    return torch.nn.functional.silu(x)

def _sigmoid(x):
    return torch.sigmoid(x)

def _layernorm(x, axis=-1, eps=1e-05):
    m = x.mean(dim=axis, keepdim=True)
    v = x.var(dim=axis, keepdim=True, unbiased=False)
    return (x - m) / torch.sqrt(v + eps)

def _scatter_add(tgt, idx, src, axis=0):
    return tgt.clone().index_add_(axis, idx, src)

def _segment_sum(src, seg, n):
    out = torch.zeros((n,) + src.shape[1:], dtype=src.dtype)
    return out.index_add_(0, seg, src)

def _pad(x, pw):
    flat = tuple((v for pair in reversed(pw) for v in pair))
    return torch.nn.functional.pad(x, flat)
kernel_name = 'sequential_preLN__memory_aug_recurrent_mem_tr__mixer_token_mlp__prompt'

def setup_inputs():

    _w = lambda a: (lambda t: t.to(torch.bfloat16) if t.is_floating_point() else t)(torch.as_tensor(a))

    def _A_setup():
        B, S, Dm = (1, 2048, 576)
        H, Dh = (32, 128)
        M, seg = (8, 32)
        seg = min(seg, S)
        S = S // seg * seg
        return {'x': _w((lambda *s: torch.randn(*s, dtype=torch.bfloat16) * 0.05)(B, S, Dm)), 'mem0': _w((lambda *s: torch.randn(*s, dtype=torch.bfloat16) * 0.2)(B, M, Dm)), 'Wq': _w((lambda *s: torch.randn(*s, dtype=torch.bfloat16) * 1.6)(Dm, H, Dh) * Dm ** (-0.5)), 'Wk': _w((lambda *s: torch.randn(*s, dtype=torch.bfloat16) * 1.6)(Dm, H, Dh) * Dm ** (-0.5)), 'Wv': _w((lambda *s: torch.randn(*s, dtype=torch.bfloat16) * 0.2)(Dm, H, Dh) * Dm ** (-0.5)), 'Wo': _w((lambda *s: torch.randn(*s, dtype=torch.bfloat16) * 0.2)(H, Dh, Dm) * (H * Dh) ** (-0.5)), 'seg_len': seg}
    _A_in = _A_setup()

    def _B_setup():
        B, S, D, F = (1, 2048, 576, 4608)
        return {'x': _w((lambda *s: torch.randn(*s, dtype=torch.bfloat16) * 0.05)(B, S, D)), 'w1': _w((lambda *s: torch.randn(*s, dtype=torch.bfloat16) * 0.4)(S, F) * S ** (-0.5)), 'b1': _w((lambda *s: torch.randn(*s, dtype=torch.bfloat16) * 3.2)(F) * 0.02), 'w2': _w((lambda *s: torch.randn(*s, dtype=torch.bfloat16) * 0.8)(F, S) * F ** (-0.5)), 'b2': _w((lambda *s: torch.randn(*s, dtype=torch.bfloat16) * 3.2)(S) * 0.02)}
    _B_in = _B_setup()
    return {'A_x': _A_in['x'], 'A_mem0': _A_in['mem0'], 'A_Wq': _A_in['Wq'], 'A_Wk': _A_in['Wk'], 'A_Wv': _A_in['Wv'], 'A_Wo': _A_in['Wo'], 'A_seg_len': _A_in['seg_len'], 'B_x': _B_in['x'], 'B_w1': _B_in['w1'], 'B_b1': _B_in['b1'], 'B_w2': _B_in['w2'], 'B_b2': _B_in['b2']}

def reference(A_x, A_mem0, A_Wq, A_Wk, A_Wv, A_Wo, A_seg_len, B_x, B_w1, B_b1, B_w2, B_b2):

    def _A_ref(x, mem0, Wq, Wk, Wv, Wo, seg_len):
        B, S, Dm = x.shape
        H, Dh = (Wq.shape[1], Wq.shape[2])
        M = mem0.shape[1]
        scale = Dh ** (-0.5)
        n_seg = S // seg_len
        L = M + seg_len
        idx = torch.arange(L)
        mask = (idx[:, None] < M) | (idx[:, None] >= idx[None, :])
        mem = mem0
        outs = []
        for s in range(n_seg):
            xs = x[:, s * seg_len:(s + 1) * seg_len, :].clone()
            h = torch.concatenate([mem, xs], axis=1)
            q = torch.einsum('btd,dhe->bhte', h, Wq)
            k = torch.einsum('btd,dhe->bhte', h, Wk)
            v = torch.einsum('btd,dhe->bhte', h, Wv)
            scores = torch.einsum('bhqe,bhke->bhqk', q, k) * scale
            scores = torch.where(mask[None, None], scores, -1000000000.0)
            p = _softmax(scores, axis=-1)
            o = torch.einsum('bhqk,bhke->bhqe', p, v)
            o = torch.einsum('bhte,hed->btd', o, Wo)
            mem = o[:, :M, :].clone()
            outs.append(o[:, M:, :])
        return torch.concatenate(outs, axis=1)

    def _B_ref(x, w1, b1, w2, b2):
        B, S, D = x.shape
        h = _layernorm(x, axis=-1)
        u = torch.einsum('bsd,sf->bdf', h, w1) + b1
        u = _gelu(u)
        y = torch.einsum('bdf,fs->bds', u, w2) + b2
        return (lambda x, *d: x.permute(*d))(y, 0, 2, 1)
    x = A_x
    h = x + _A_ref(_layernorm(x, axis=-1), A_mem0, A_Wq, A_Wk, A_Wv, A_Wo, A_seg_len)
    h2 = h + _B_ref(_layernorm(h, axis=-1), B_w1, B_b1, B_w2, B_b2)
    return h2
```

```asm
; @launch kernel=sequential_preLN__memory_aug_recurrent_mem_tr__mixer_token_mlp__prompt_kernel grid=(256,1,1) block=(256,1,1) lds=163840
.amdgcn_target "amdgcn-amd-amdhsa--gfx950"
.text
  .globl sequential_preLN__memory_aug_recurrent_mem_tr__mixer_token_mlp__prompt_kernel
  .p2align 8
  .type sequential_preLN__memory_aug_recurrent_mem_tr__mixer_token_mlp__prompt_kernel,@function
sequential_preLN__memory_aug_recurrent_mem_tr__mixer_token_mlp__prompt_kernel:
  s_cmp_ge_u32 s2, 256
  s_cbranch_scc1 K1E
  s_and_b32 s3, s2, 7
  s_cmp_lg_u32 s3, 0
  s_cbranch_scc1 BG
  s_lshr_b32 s20, s2, 3
  v_lshrrev_b32 v1, 6, v0
  v_and_b32 v0, 63, v0
  s_load_dwordx4 s[40:43], s[0:1], 16
  s_load_dwordx4 s[44:47], s[0:1], 32
  s_load_dwordx2 s[48:49], s[0:1], 8
  s_load_dwordx4 s[52:55], s[0:1], 104
  v_readfirstlane_b32 s21, v1
  s_getreg_b32 s24, hwreg(HW_REG_XCC_ID, 0, 4)
  s_waitcnt lgkmcnt(0)
  s_mov_b32 s8, s54
  s_mov_b32 s9, s55
  s_mov_b32 s10, 268435456
  s_mov_b32 s11, 0x00020000
  s_mov_b32 s16, s52
  s_mov_b32 s17, s53
  s_mov_b32 s18, 256
  s_mov_b32 s19, 0x00020000
  v_lshrrev_b32 v1, 3, v0
  v_lshlrev_b32 v1, 13, v1
  v_bfe_u32 v2, v0, 1, 2
  v_bfe_u32 v3, v0, 4, 1
  v_xor_b32 v2, v2, v3
  v_lshlrev_b32 v2, 5, v2
  v_and_b32 v3, 1, v0
  v_lshlrev_b32 v3, 4, v3
  v_add3_u32 v1, v1, v2, v3
  v_xor_b32 v2, 64, v1
  v_lshlrev_b32 v3, 4, v0
  s_lshl_b32 s25, s21, 10
  s_lshl_b32 s26, s21, 16
  s_lshl_b32 s27, s20, 8
  s_add_u32 s26, s26, s27
  s_mul_i32 s27, s20, 147456
  s_add_u32 s27, s27, s25
  s_mov_b32 s12, s42
  s_mov_b32 s13, s43
  s_mov_b32 s14, 4718592
  s_mov_b32 s15, 0x00020000
  s_add_u32 m0, s25, 0
  s_add_u32 s28, s26, 128
  buffer_load_dwordx4 v1, s[12:15], s28 offen lds
  s_add_u32 m0, s25, 4096
  s_add_u32 s28, s26, 262272
  buffer_load_dwordx4 v2, s[12:15], s28 offen lds
  s_add_u32 m0, s25, 8192
  s_add_u32 s28, s26, 524416
  buffer_load_dwordx4 v1, s[12:15], s28 offen lds
  s_add_u32 m0, s25, 12288
  s_add_u32 s28, s26, 786560
  buffer_load_dwordx4 v2, s[12:15], s28 offen lds
  s_add_u32 m0, s25, 16384
  s_add_u32 s28, s26, 1048704
  buffer_load_dwordx4 v1, s[12:15], s28 offen lds
  s_add_u32 m0, s25, 20480
  s_add_u32 s28, s26, 1310848
  buffer_load_dwordx4 v2, s[12:15], s28 offen lds
  s_add_u32 m0, s25, 24576
  s_add_u32 s28, s26, 1572992
  buffer_load_dwordx4 v1, s[12:15], s28 offen lds
  s_add_u32 m0, s25, 28672
  s_add_u32 s28, s26, 1835136
  buffer_load_dwordx4 v2, s[12:15], s28 offen lds
  s_add_u32 m0, s25, 32768
  s_add_u32 s28, s26, 2097280
  buffer_load_dwordx4 v1, s[12:15], s28 offen lds
  s_add_u32 m0, s25, 36864
  s_add_u32 s28, s26, 2359424
  buffer_load_dwordx4 v2, s[12:15], s28 offen lds
  s_add_u32 m0, s25, 40960
  s_add_u32 s28, s26, 2621568
  buffer_load_dwordx4 v1, s[12:15], s28 offen lds
  s_add_u32 m0, s25, 45056
  s_add_u32 s28, s26, 2883712
  buffer_load_dwordx4 v2, s[12:15], s28 offen lds
  s_add_u32 m0, s25, 49152
  s_add_u32 s28, s26, 3145856
  buffer_load_dwordx4 v1, s[12:15], s28 offen lds
  s_add_u32 m0, s25, 53248
  s_add_u32 s28, s26, 3408000
  buffer_load_dwordx4 v2, s[12:15], s28 offen lds
  s_add_u32 m0, s25, 57344
  s_add_u32 s28, s26, 3670144
  buffer_load_dwordx4 v1, s[12:15], s28 offen lds
  s_add_u32 m0, s25, 61440
  s_add_u32 s28, s26, 3932288
  buffer_load_dwordx4 v2, s[12:15], s28 offen lds
  s_add_u32 m0, s25, 65536
  s_add_u32 s28, s26, 4194432
  buffer_load_dwordx4 v1, s[12:15], s28 offen lds
  s_add_u32 m0, s25, 69632
  s_add_u32 s28, s26, 4456576
  buffer_load_dwordx4 v2, s[12:15], s28 offen lds
  s_mov_b32 s12, s44
  s_mov_b32 s13, s45
  s_mov_b32 s14, 4718592
  s_mov_b32 s15, 0x00020000
  s_add_u32 m0, s25, 73728
  s_add_u32 s28, s26, 128
  buffer_load_dwordx4 v1, s[12:15], s28 offen lds
  s_add_u32 m0, s25, 77824
  s_add_u32 s28, s26, 262272
  buffer_load_dwordx4 v2, s[12:15], s28 offen lds
  s_add_u32 m0, s25, 81920
  s_add_u32 s28, s26, 524416
  buffer_load_dwordx4 v1, s[12:15], s28 offen lds
  s_add_u32 m0, s25, 86016
  s_add_u32 s28, s26, 786560
  buffer_load_dwordx4 v2, s[12:15], s28 offen lds
  s_add_u32 m0, s25, 90112
  s_add_u32 s28, s26, 1048704
  buffer_load_dwordx4 v1, s[12:15], s28 offen lds
  s_add_u32 m0, s25, 94208
  s_add_u32 s28, s26, 1310848
  buffer_load_dwordx4 v2, s[12:15], s28 offen lds
  s_add_u32 m0, s25, 98304
  s_add_u32 s28, s26, 1572992
  buffer_load_dwordx4 v1, s[12:15], s28 offen lds
  s_add_u32 m0, s25, 102400
  s_add_u32 s28, s26, 1835136
  buffer_load_dwordx4 v2, s[12:15], s28 offen lds
  s_add_u32 m0, s25, 106496
  s_add_u32 s28, s26, 2097280
  buffer_load_dwordx4 v1, s[12:15], s28 offen lds
  s_add_u32 m0, s25, 110592
  s_add_u32 s28, s26, 2359424
  buffer_load_dwordx4 v2, s[12:15], s28 offen lds
  s_add_u32 m0, s25, 114688
  s_add_u32 s28, s26, 2621568
  buffer_load_dwordx4 v1, s[12:15], s28 offen lds
  s_add_u32 m0, s25, 118784
  s_add_u32 s28, s26, 2883712
  buffer_load_dwordx4 v2, s[12:15], s28 offen lds
  s_add_u32 m0, s25, 122880
  s_add_u32 s28, s26, 3145856
  buffer_load_dwordx4 v1, s[12:15], s28 offen lds
  s_add_u32 m0, s25, 126976
  s_add_u32 s28, s26, 3408000
  buffer_load_dwordx4 v2, s[12:15], s28 offen lds
  s_add_u32 m0, s25, 131072
  s_add_u32 s28, s26, 3670144
  buffer_load_dwordx4 v1, s[12:15], s28 offen lds
  s_add_u32 m0, s25, 135168
  s_add_u32 s28, s26, 3932288
  buffer_load_dwordx4 v2, s[12:15], s28 offen lds
  s_add_u32 m0, s25, 139264
  s_add_u32 s28, s26, 4194432
  buffer_load_dwordx4 v1, s[12:15], s28 offen lds
  s_add_u32 m0, s25, 143360
  s_add_u32 s28, s26, 4456576
  buffer_load_dwordx4 v2, s[12:15], s28 offen lds
  v_mov_b32 v8, 0
  v_mov_b32 v9, 0
  v_mov_b32 v10, 0
  v_mov_b32 v11, 0
  v_lshrrev_b32 v4, 3, v0
  v_lshlrev_b32 v4, 12, v4
  v_and_b32 v5, 7, v0
  v_lshl_add_u32 v4, v5, 4, v4
  s_lshl_b32 s28, s20, 7
  s_add_u32 s28, s28, 71303168
  s_add_u32 s29, s28, 0
  buffer_store_dwordx4 v[8:11], v4, s[8:11], s29 offen sc1
  s_add_u32 s29, s28, 32768
  buffer_store_dwordx4 v[8:11], v4, s[8:11], s29 offen sc1
  s_add_u32 s29, s28, 65536
  buffer_store_dwordx4 v[8:11], v4, s[8:11], s29 offen sc1
  s_add_u32 s29, s28, 98304
  buffer_store_dwordx4 v[8:11], v4, s[8:11], s29 offen sc1
  s_add_u32 s29, s28, 131072
  buffer_store_dwordx4 v[8:11], v4, s[8:11], s29 offen sc1
  s_add_u32 s29, s28, 163840
  buffer_store_dwordx4 v[8:11], v4, s[8:11], s29 offen sc1
  s_add_u32 s29, s28, 196608
  buffer_store_dwordx4 v[8:11], v4, s[8:11], s29 offen sc1
  s_add_u32 s29, s28, 229376
  buffer_store_dwordx4 v[8:11], v4, s[8:11], s29 offen sc1
  s_add_u32 s29, s28, 262144
  buffer_store_dwordx4 v[8:11], v4, s[8:11], s29 offen sc1
  s_mov_b32 s29, 71827456
  buffer_store_dwordx4 v[8:11], v3, s[8:11], s29 offen offset:0 sc1
  buffer_store_dwordx4 v[8:11], v3, s[8:11], s29 offen offset:1024 sc1
  buffer_store_dwordx4 v[8:11], v3, s[8:11], s29 offen offset:2048 sc1
  buffer_store_dwordx4 v[8:11], v3, s[8:11], s29 offen offset:3072 sc1
  s_add_u32 s29, s29, 4096
  buffer_store_dwordx4 v[8:11], v3, s[8:11], s29 offen offset:0 sc1
  buffer_store_dwordx4 v[8:11], v3, s[8:11], s29 offen offset:1024 sc1
  buffer_store_dwordx4 v[8:11], v3, s[8:11], s29 offen offset:2048 sc1
  buffer_store_dwordx4 v[8:11], v3, s[8:11], s29 offen offset:3072 sc1
  s_add_u32 s29, s29, 4096
  buffer_store_dwordx4 v[8:11], v3, s[8:11], s29 offen offset:0 sc1
  s_and_b32 s29, s20, 15
  s_lshl_b32 s29, s29, 2
  s_add_u32 s29, s29, s21
  s_lshl_b32 s29, s29, 10
  s_add_u32 s29, s29, 71958528
  buffer_store_dwordx4 v[8:11], v3, s[8:11], s29 offen offset:0 sc1
  v_bfe_u32 v6, v0, 4, 1
  v_bfe_u32 v7, v0, 5, 1
  v_bfe_u32 v8, v0, 2, 2
  v_lshlrev_b32 v4, 5, v6
  v_lshl_add_u32 v4, v7, 3, v4
  v_add_u32 v4, v4, v8
  v_lshlrev_b32 v4, 7, v4
  v_lshrrev_b32 v9, 1, v8
  v_lshl_add_u32 v10, v6, 1, v9
  v_xor_b32 v10, s21, v10
  v_lshl_add_u32 v4, v10, 5, v4
  v_and_b32 v10, 3, v0
  v_lshl_add_u32 v4, v10, 3, v4
  v_lshlrev_b32 v5, 4, v7
  v_lshl_add_u32 v5, v6, 2, v5
  v_lshl_add_u32 v5, v9, 3, v5
  v_and_b32 v8, 1, v8
  v_add_u32 v5, v5, v8
  v_mul_u32_u24 v5, 1152, v5
  v_lshl_add_u32 v5, v10, 3, v5
  s_mul_i32 s28, s21, 288
  v_add_u32 v5, s28, v5
  s_waitcnt vmcnt(0)
  s_barrier
  s_cmp_lg_u32 s21, 0
  s_cbranch_scc1 NOSIG_1
  s_lshl_b32 s28, 1, s24
  v_mov_b32 v6, s28
  v_mov_b32 v7, 0
  s_mov_b64 exec, 1
  buffer_atomic_or v6, v7, s[16:19], 0 offen offset:4 sc0
  s_waitcnt vmcnt(0)
  v_mov_b32 v6, 1
  buffer_atomic_add v6, v7, s[16:19], 0 offen
  s_waitcnt vmcnt(0)
  s_mov_b64 exec, -1
NOSIG_1:
  v_add_u32 v6, 0, v4
  v_add_u32 v7, 32768, v4
  ds_read_b64_tr_b16 v[152:153], v6 offset:0
  ds_read_b64_tr_b16 v[154:155], v6 offset:512
  ds_read_b64_tr_b16 v[156:157], v6 offset:2048
  ds_read_b64_tr_b16 v[158:159], v6 offset:2560
  ds_read_b64_tr_b16 v[160:161], v6 offset:8192
  ds_read_b64_tr_b16 v[162:163], v6 offset:8704
  ds_read_b64_tr_b16 v[164:165], v6 offset:10240
  ds_read_b64_tr_b16 v[166:167], v6 offset:10752
  ds_read_b64_tr_b16 v[168:169], v6 offset:16384
  ds_read_b64_tr_b16 v[170:171], v6 offset:16896
  ds_read_b64_tr_b16 v[172:173], v6 offset:18432
  ds_read_b64_tr_b16 v[174:175], v6 offset:18944
  ds_read_b64_tr_b16 v[176:177], v6 offset:24576
  ds_read_b64_tr_b16 v[178:179], v6 offset:25088
  ds_read_b64_tr_b16 v[180:181], v6 offset:26624
  ds_read_b64_tr_b16 v[182:183], v6 offset:27136
  ds_read_b64_tr_b16 v[184:185], v7 offset:0
  ds_read_b64_tr_b16 v[186:187], v7 offset:512
  ds_read_b64_tr_b16 v[188:189], v7 offset:2048
  ds_read_b64_tr_b16 v[190:191], v7 offset:2560
  ds_read_b64_tr_b16 v[192:193], v7 offset:8192
  ds_read_b64_tr_b16 v[194:195], v7 offset:8704
  ds_read_b64_tr_b16 v[196:197], v7 offset:10240
  ds_read_b64_tr_b16 v[198:199], v7 offset:10752
  ds_read_b64_tr_b16 v[200:201], v7 offset:16384
  ds_read_b64_tr_b16 v[202:203], v7 offset:16896
  ds_read_b64_tr_b16 v[204:205], v7 offset:18432
  ds_read_b64_tr_b16 v[206:207], v7 offset:18944
  ds_read_b64_tr_b16 v[208:209], v7 offset:24576
  ds_read_b64_tr_b16 v[210:211], v7 offset:25088
  ds_read_b64_tr_b16 v[212:213], v7 offset:26624
  ds_read_b64_tr_b16 v[214:215], v7 offset:27136
  ds_read_b64_tr_b16 v[216:217], v7 offset:32768
  ds_read_b64_tr_b16 v[218:219], v7 offset:33280
  ds_read_b64_tr_b16 v[220:221], v7 offset:34816
  ds_read_b64_tr_b16 v[222:223], v7 offset:35328
  s_waitcnt lgkmcnt(0)
  s_barrier
  s_mov_b32 s12, s42
  s_mov_b32 s13, s43
  s_mov_b32 s14, 4718592
  s_mov_b32 s15, 0x00020000
  s_add_u32 m0, s25, 0
  s_add_u32 s28, s26, 0
  buffer_load_dwordx4 v1, s[12:15], s28 offen lds
  s_add_u32 m0, s25, 4096
  s_add_u32 s28, s26, 262144
  buffer_load_dwordx4 v2, s[12:15], s28 offen lds
  s_add_u32 m0, s25, 8192
  s_add_u32 s28, s26, 524288
  buffer_load_dwordx4 v1, s[12:15], s28 offen lds
  s_add_u32 m0, s25, 12288
  s_add_u32 s28, s26, 786432
  buffer_load_dwordx4 v2, s[12:15], s28 offen lds
  s_add_u32 m0, s25, 16384
  s_add_u32 s28, s26, 1048576
  buffer_load_dwordx4 v1, s[12:15], s28 offen lds
  s_add_u32 m0, s25, 20480
  s_add_u32 s28, s26, 1310720
  buffer_load_dwordx4 v2, s[12:15], s28 offen lds
  s_add_u32 m0, s25, 24576
  s_add_u32 s28, s26, 1572864
  buffer_load_dwordx4 v1, s[12:15], s28 offen lds
  s_add_u32 m0, s25, 28672
  s_add_u32 s28, s26, 1835008
  buffer_load_dwordx4 v2, s[12:15], s28 offen lds
  s_add_u32 m0, s25, 32768
  s_add_u32 s28, s26, 2097152
  buffer_load_dwordx4 v1, s[12:15], s28 offen lds
  s_add_u32 m0, s25, 36864
  s_add_u32 s28, s26, 2359296
  buffer_load_dwordx4 v2, s[12:15], s28 offen lds
  s_add_u32 m0, s25, 40960
  s_add_u32 s28, s26, 2621440
  buffer_load_dwordx4 v1, s[12:15], s28 offen lds
  s_add_u32 m0, s25, 45056
  s_add_u32 s28, s26, 2883584
  buffer_load_dwordx4 v2, s[12:15], s28 offen lds
  s_add_u32 m0, s25, 49152
  s_add_u32 s28, s26, 3145728
  buffer_load_dwordx4 v1, s[12:15], s28 offen lds
  s_add_u32 m0, s25, 53248
  s_add_u32 s28, s26, 3407872
  buffer_load_dwordx4 v2, s[12:15], s28 offen lds
  s_add_u32 m0, s25, 57344
  s_add_u32 s28, s26, 3670016
  buffer_load_dwordx4 v1, s[12:15], s28 offen lds
  s_add_u32 m0, s25, 61440
  s_add_u32 s28, s26, 3932160
  buffer_load_dwordx4 v2, s[12:15], s28 offen lds
  s_add_u32 m0, s25, 65536
  s_add_u32 s28, s26, 4194304
  buffer_load_dwordx4 v1, s[12:15], s28 offen lds
  s_add_u32 m0, s25, 69632
  s_add_u32 s28, s26, 4456448
  buffer_load_dwordx4 v2, s[12:15], s28 offen lds
  s_waitcnt vmcnt(37)
  s_barrier
  v_add_u32 v6, 73728, v4
  v_add_u32 v7, 106496, v4
  ds_read_b64_tr_b16 v[80:81], v6 offset:0
  ds_read_b64_tr_b16 v[82:83], v6 offset:512
  ds_read_b64_tr_b16 v[84:85], v6 offset:2048
  ds_read_b64_tr_b16 v[86:87], v6 offset:2560
  ds_read_b64_tr_b16 v[88:89], v6 offset:8192
  ds_read_b64_tr_b16 v[90:91], v6 offset:8704
  ds_read_b64_tr_b16 v[92:93], v6 offset:10240
  ds_read_b64_tr_b16 v[94:95], v6 offset:10752
  ds_read_b64_tr_b16 v[96:97], v6 offset:16384
  ds_read_b64_tr_b16 v[98:99], v6 offset:16896
  ds_read_b64_tr_b16 v[100:101], v6 offset:18432
  ds_read_b64_tr_b16 v[102:103], v6 offset:18944
  ds_read_b64_tr_b16 v[104:105], v6 offset:24576
  ds_read_b64_tr_b16 v[106:107], v6 offset:25088
  ds_read_b64_tr_b16 v[108:109], v6 offset:26624
  ds_read_b64_tr_b16 v[110:111], v6 offset:27136
  ds_read_b64_tr_b16 v[112:113], v7 offset:0
  ds_read_b64_tr_b16 v[114:115], v7 offset:512
  ds_read_b64_tr_b16 v[116:117], v7 offset:2048
  ds_read_b64_tr_b16 v[118:119], v7 offset:2560
  ds_read_b64_tr_b16 v[120:121], v7 offset:8192
  ds_read_b64_tr_b16 v[122:123], v7 offset:8704
  ds_read_b64_tr_b16 v[124:125], v7 offset:10240
  ds_read_b64_tr_b16 v[126:127], v7 offset:10752
  ds_read_b64_tr_b16 v[128:129], v7 offset:16384
  ds_read_b64_tr_b16 v[130:131], v7 offset:16896
  ds_read_b64_tr_b16 v[132:133], v7 offset:18432
  ds_read_b64_tr_b16 v[134:135], v7 offset:18944
  ds_read_b64_tr_b16 v[136:137], v7 offset:24576
  ds_read_b64_tr_b16 v[138:139], v7 offset:25088
  ds_read_b64_tr_b16 v[140:141], v7 offset:26624
  ds_read_b64_tr_b16 v[142:143], v7 offset:27136
  ds_read_b64_tr_b16 v[144:145], v7 offset:32768
  ds_read_b64_tr_b16 v[146:147], v7 offset:33280
  ds_read_b64_tr_b16 v[148:149], v7 offset:34816
  ds_read_b64_tr_b16 v[150:151], v7 offset:35328
  s_waitcnt lgkmcnt(0)
  s_barrier
  s_mov_b32 s12, s44
  s_mov_b32 s13, s45
  s_mov_b32 s14, 4718592
  s_mov_b32 s15, 0x00020000
  s_add_u32 m0, s25, 73728
  s_add_u32 s28, s26, 0
  buffer_load_dwordx4 v1, s[12:15], s28 offen lds
  s_add_u32 m0, s25, 77824
  s_add_u32 s28, s26, 262144
  buffer_load_dwordx4 v2, s[12:15], s28 offen lds
  s_add_u32 m0, s25, 81920
  s_add_u32 s28, s26, 524288
  buffer_load_dwordx4 v1, s[12:15], s28 offen lds
  s_add_u32 m0, s25, 86016
  s_add_u32 s28, s26, 786432
  buffer_load_dwordx4 v2, s[12:15], s28 offen lds
  s_add_u32 m0, s25, 90112
  s_add_u32 s28, s26, 1048576
  buffer_load_dwordx4 v1, s[12:15], s28 offen lds
  s_add_u32 m0, s25, 94208
  s_add_u32 s28, s26, 1310720
  buffer_load_dwordx4 v2, s[12:15], s28 offen lds
  s_add_u32 m0, s25, 98304
  s_add_u32 s28, s26, 1572864
  buffer_load_dwordx4 v1, s[12:15], s28 offen lds
  s_add_u32 m0, s25, 102400
  s_add_u32 s28, s26, 1835008
  buffer_load_dwordx4 v2, s[12:15], s28 offen lds
  s_add_u32 m0, s25, 106496
  s_add_u32 s28, s26, 2097152
  buffer_load_dwordx4 v1, s[12:15], s28 offen lds
  s_add_u32 m0, s25, 110592
  s_add_u32 s28, s26, 2359296
  buffer_load_dwordx4 v2, s[12:15], s28 offen lds
  s_add_u32 m0, s25, 114688
  s_add_u32 s28, s26, 2621440
  buffer_load_dwordx4 v1, s[12:15], s28 offen lds
  s_add_u32 m0, s25, 118784
  s_add_u32 s28, s26, 2883584
  buffer_load_dwordx4 v2, s[12:15], s28 offen lds
  s_add_u32 m0, s25, 122880
  s_add_u32 s28, s26, 3145728
  buffer_load_dwordx4 v1, s[12:15], s28 offen lds
  s_add_u32 m0, s25, 126976
  s_add_u32 s28, s26, 3407872
  buffer_load_dwordx4 v2, s[12:15], s28 offen lds
  s_add_u32 m0, s25, 131072
  s_add_u32 s28, s26, 3670016
  buffer_load_dwordx4 v1, s[12:15], s28 offen lds
  s_add_u32 m0, s25, 135168
  s_add_u32 s28, s26, 3932160
  buffer_load_dwordx4 v2, s[12:15], s28 offen lds
  s_add_u32 m0, s25, 139264
  s_add_u32 s28, s26, 4194304
  buffer_load_dwordx4 v1, s[12:15], s28 offen lds
  s_add_u32 m0, s25, 143360
  s_add_u32 s28, s26, 4456448
  buffer_load_dwordx4 v2, s[12:15], s28 offen lds
  s_waitcnt vmcnt(18)
  s_barrier
  v_add_u32 v6, 0, v4
  v_add_u32 v7, 32768, v4
  ds_read_b64_tr_b16 a[144:145], v6 offset:0
  ds_read_b64_tr_b16 a[146:147], v6 offset:512
  ds_read_b64_tr_b16 a[148:149], v6 offset:2048
  ds_read_b64_tr_b16 a[150:151], v6 offset:2560
  ds_read_b64_tr_b16 a[152:153], v6 offset:8192
  ds_read_b64_tr_b16 a[154:155], v6 offset:8704
  ds_read_b64_tr_b16 a[156:157], v6 offset:10240
  ds_read_b64_tr_b16 a[158:159], v6 offset:10752
  ds_read_b64_tr_b16 a[160:161], v6 offset:16384
  ds_read_b64_tr_b16 a[162:163], v6 offset:16896
  ds_read_b64_tr_b16 a[164:165], v6 offset:18432
  ds_read_b64_tr_b16 a[166:167], v6 offset:18944
  ds_read_b64_tr_b16 a[168:169], v6 offset:24576
  ds_read_b64_tr_b16 a[170:171], v6 offset:25088
  ds_read_b64_tr_b16 a[172:173], v6 offset:26624
  ds_read_b64_tr_b16 a[174:175], v6 offset:27136
  ds_read_b64_tr_b16 a[176:177], v7 offset:0
  ds_read_b64_tr_b16 a[178:179], v7 offset:512
  ds_read_b64_tr_b16 a[180:181], v7 offset:2048
  ds_read_b64_tr_b16 a[182:183], v7 offset:2560
  ds_read_b64_tr_b16 a[184:185], v7 offset:8192
  ds_read_b64_tr_b16 a[186:187], v7 offset:8704
  ds_read_b64_tr_b16 a[188:189], v7 offset:10240
  ds_read_b64_tr_b16 a[190:191], v7 offset:10752
  ds_read_b64_tr_b16 a[192:193], v7 offset:16384
  ds_read_b64_tr_b16 a[194:195], v7 offset:16896
  ds_read_b64_tr_b16 a[196:197], v7 offset:18432
  ds_read_b64_tr_b16 a[198:199], v7 offset:18944
  ds_read_b64_tr_b16 a[200:201], v7 offset:24576
  ds_read_b64_tr_b16 a[202:203], v7 offset:25088
  ds_read_b64_tr_b16 a[204:205], v7 offset:26624
  ds_read_b64_tr_b16 a[206:207], v7 offset:27136
  ds_read_b64_tr_b16 a[208:209], v7 offset:32768
  ds_read_b64_tr_b16 a[210:211], v7 offset:33280
  ds_read_b64_tr_b16 a[212:213], v7 offset:34816
  ds_read_b64_tr_b16 a[214:215], v7 offset:35328
  s_waitcnt lgkmcnt(0)
  s_barrier
  s_mov_b32 s12, s40
  s_mov_b32 s13, s41
  s_mov_b32 s14, 4718592
  s_mov_b32 s15, 0x00020000
  s_add_u32 m0, s25, 0
  s_add_u32 s28, s26, 0
  buffer_load_dwordx4 v1, s[12:15], s28 offen lds
  s_add_u32 m0, s25, 4096
  s_add_u32 s28, s26, 262144
  buffer_load_dwordx4 v2, s[12:15], s28 offen lds
  s_add_u32 m0, s25, 8192
  s_add_u32 s28, s26, 524288
  buffer_load_dwordx4 v1, s[12:15], s28 offen lds
  s_add_u32 m0, s25, 12288
  s_add_u32 s28, s26, 786432
  buffer_load_dwordx4 v2, s[12:15], s28 offen lds
  s_add_u32 m0, s25, 16384
  s_add_u32 s28, s26, 1048576
  buffer_load_dwordx4 v1, s[12:15], s28 offen lds
  s_add_u32 m0, s25, 20480
  s_add_u32 s28, s26, 1310720
  buffer_load_dwordx4 v2, s[12:15], s28 offen lds
  s_add_u32 m0, s25, 24576
  s_add_u32 s28, s26, 1572864
  buffer_load_dwordx4 v1, s[12:15], s28 offen lds
  s_add_u32 m0, s25, 28672
  s_add_u32 s28, s26, 1835008
  buffer_load_dwordx4 v2, s[12:15], s28 offen lds
  s_add_u32 m0, s25, 32768
  s_add_u32 s28, s26, 2097152
  buffer_load_dwordx4 v1, s[12:15], s28 offen lds
  s_add_u32 m0, s25, 36864
  s_add_u32 s28, s26, 2359296
  buffer_load_dwordx4 v2, s[12:15], s28 offen lds
  s_add_u32 m0, s25, 40960
  s_add_u32 s28, s26, 2621440
  buffer_load_dwordx4 v1, s[12:15], s28 offen lds
  s_add_u32 m0, s25, 45056
  s_add_u32 s28, s26, 2883584
  buffer_load_dwordx4 v2, s[12:15], s28 offen lds
  s_add_u32 m0, s25, 49152
  s_add_u32 s28, s26, 3145728
  buffer_load_dwordx4 v1, s[12:15], s28 offen lds
  s_add_u32 m0, s25, 53248
  s_add_u32 s28, s26, 3407872
  buffer_load_dwordx4 v2, s[12:15], s28 offen lds
  s_add_u32 m0, s25, 57344
  s_add_u32 s28, s26, 3670016
  buffer_load_dwordx4 v1, s[12:15], s28 offen lds
  s_add_u32 m0, s25, 61440
  s_add_u32 s28, s26, 3932160
  buffer_load_dwordx4 v2, s[12:15], s28 offen lds
  s_add_u32 m0, s25, 65536
  s_add_u32 s28, s26, 4194304
  buffer_load_dwordx4 v1, s[12:15], s28 offen lds
  s_add_u32 m0, s25, 69632
  s_add_u32 s28, s26, 4456448
  buffer_load_dwordx4 v2, s[12:15], s28 offen lds
  s_waitcnt vmcnt(18)
  s_barrier
  v_add_u32 v6, 73728, v4
  v_add_u32 v7, 106496, v4
  ds_read_b64_tr_b16 a[216:217], v6 offset:0
  ds_read_b64_tr_b16 a[218:219], v6 offset:512
  ds_read_b64_tr_b16 a[220:221], v6 offset:2048
  ds_read_b64_tr_b16 a[222:223], v6 offset:2560
  ds_read_b64_tr_b16 a[224:225], v6 offset:8192
  ds_read_b64_tr_b16 a[226:227], v6 offset:8704
  ds_read_b64_tr_b16 a[228:229], v6 offset:10240
  ds_read_b64_tr_b16 a[230:231], v6 offset:10752
  ds_read_b64_tr_b16 a[232:233], v6 offset:16384
  ds_read_b64_tr_b16 a[234:235], v6 offset:16896
  ds_read_b64_tr_b16 a[236:237], v6 offset:18432
  ds_read_b64_tr_b16 a[238:239], v6 offset:18944
  ds_read_b64_tr_b16 a[240:241], v6 offset:24576
  ds_read_b64_tr_b16 a[242:243], v6 offset:25088
  ds_read_b64_tr_b16 a[244:245], v6 offset:26624
  ds_read_b64_tr_b16 a[246:247], v6 offset:27136
  ds_read_b64_tr_b16 a[248:249], v7 offset:0
  ds_read_b64_tr_b16 a[250:251], v7 offset:512
  ds_read_b64_tr_b16 a[252:253], v7 offset:2048
  ds_read_b64_tr_b16 a[254:255], v7 offset:2560
  ds_read_b64_tr_b16 v[224:225], v7 offset:8192
  ds_read_b64_tr_b16 v[226:227], v7 offset:8704
  ds_read_b64_tr_b16 v[228:229], v7 offset:10240
  ds_read_b64_tr_b16 v[230:231], v7 offset:10752
  ds_read_b64_tr_b16 v[232:233], v7 offset:16384
  ds_read_b64_tr_b16 v[234:235], v7 offset:16896
  ds_read_b64_tr_b16 v[236:237], v7 offset:18432
  ds_read_b64_tr_b16 v[238:239], v7 offset:18944
  ds_read_b64_tr_b16 v[240:241], v7 offset:24576
  ds_read_b64_tr_b16 v[242:243], v7 offset:25088
  ds_read_b64_tr_b16 v[244:245], v7 offset:26624
  ds_read_b64_tr_b16 v[246:247], v7 offset:27136
  ds_read_b64_tr_b16 v[248:249], v7 offset:32768
  ds_read_b64_tr_b16 v[250:251], v7 offset:33280
  ds_read_b64_tr_b16 v[252:253], v7 offset:34816
  ds_read_b64_tr_b16 v[254:255], v7 offset:35328
  s_waitcnt lgkmcnt(0)
  s_barrier
  s_mov_b32 s12, s40
  s_mov_b32 s13, s41
  s_mov_b32 s14, 4718592
  s_mov_b32 s15, 0x00020000
  s_add_u32 m0, s25, 73728
  s_add_u32 s28, s26, 128
  buffer_load_dwordx4 v1, s[12:15], s28 offen lds
  s_add_u32 m0, s25, 77824
  s_add_u32 s28, s26, 262272
  buffer_load_dwordx4 v2, s[12:15], s28 offen lds
  s_add_u32 m0, s25, 81920
  s_add_u32 s28, s26, 524416
  buffer_load_dwordx4 v1, s[12:15], s28 offen lds
  s_add_u32 m0, s25, 86016
  s_add_u32 s28, s26, 786560
  buffer_load_dwordx4 v2, s[12:15], s28 offen lds
  s_add_u32 m0, s25, 90112
  s_add_u32 s28, s26, 1048704
  buffer_load_dwordx4 v1, s[12:15], s28 offen lds
  s_add_u32 m0, s25, 94208
  s_add_u32 s28, s26, 1310848
  buffer_load_dwordx4 v2, s[12:15], s28 offen lds
  s_add_u32 m0, s25, 98304
  s_add_u32 s28, s26, 1572992
  buffer_load_dwordx4 v1, s[12:15], s28 offen lds
  s_add_u32 m0, s25, 102400
  s_add_u32 s28, s26, 1835136
  buffer_load_dwordx4 v2, s[12:15], s28 offen lds
  s_add_u32 m0, s25, 106496
  s_add_u32 s28, s26, 2097280
  buffer_load_dwordx4 v1, s[12:15], s28 offen lds
  s_add_u32 m0, s25, 110592
  s_add_u32 s28, s26, 2359424
  buffer_load_dwordx4 v2, s[12:15], s28 offen lds
  s_add_u32 m0, s25, 114688
  s_add_u32 s28, s26, 2621568
  buffer_load_dwordx4 v1, s[12:15], s28 offen lds
  s_add_u32 m0, s25, 118784
  s_add_u32 s28, s26, 2883712
  buffer_load_dwordx4 v2, s[12:15], s28 offen lds
  s_add_u32 m0, s25, 122880
  s_add_u32 s28, s26, 3145856
  buffer_load_dwordx4 v1, s[12:15], s28 offen lds
  s_add_u32 m0, s25, 126976
  s_add_u32 s28, s26, 3408000
  buffer_load_dwordx4 v2, s[12:15], s28 offen lds
  s_add_u32 m0, s25, 131072
  s_add_u32 s28, s26, 3670144
  buffer_load_dwordx4 v1, s[12:15], s28 offen lds
  s_add_u32 m0, s25, 135168
  s_add_u32 s28, s26, 3932288
  buffer_load_dwordx4 v2, s[12:15], s28 offen lds
  s_add_u32 m0, s25, 139264
  s_add_u32 s28, s26, 4194432
  buffer_load_dwordx4 v1, s[12:15], s28 offen lds
  s_add_u32 m0, s25, 143360
  s_add_u32 s28, s26, 4456576
  buffer_load_dwordx4 v2, s[12:15], s28 offen lds
  s_waitcnt vmcnt(18)
  s_barrier
  v_add_u32 v6, 0, v4
  v_add_u32 v7, 32768, v4
  ds_read_b64_tr_b16 a[0:1], v6 offset:0
  ds_read_b64_tr_b16 a[2:3], v6 offset:512
  ds_read_b64_tr_b16 a[4:5], v6 offset:2048
  ds_read_b64_tr_b16 a[6:7], v6 offset:2560
  ds_read_b64_tr_b16 a[8:9], v6 offset:8192
  ds_read_b64_tr_b16 a[10:11], v6 offset:8704
  ds_read_b64_tr_b16 a[12:13], v6 offset:10240
  ds_read_b64_tr_b16 a[14:15], v6 offset:10752
  ds_read_b64_tr_b16 a[16:17], v6 offset:16384
  ds_read_b64_tr_b16 a[18:19], v6 offset:16896
  ds_read_b64_tr_b16 a[20:21], v6 offset:18432
  ds_read_b64_tr_b16 a[22:23], v6 offset:18944
  ds_read_b64_tr_b16 a[24:25], v6 offset:24576
  ds_read_b64_tr_b16 a[26:27], v6 offset:25088
  ds_read_b64_tr_b16 a[28:29], v6 offset:26624
  ds_read_b64_tr_b16 a[30:31], v6 offset:27136
  ds_read_b64_tr_b16 a[32:33], v7 offset:0
  ds_read_b64_tr_b16 a[34:35], v7 offset:512
  ds_read_b64_tr_b16 a[36:37], v7 offset:2048
  ds_read_b64_tr_b16 a[38:39], v7 offset:2560
  ds_read_b64_tr_b16 a[40:41], v7 offset:8192
  ds_read_b64_tr_b16 a[42:43], v7 offset:8704
  ds_read_b64_tr_b16 a[44:45], v7 offset:10240
  ds_read_b64_tr_b16 a[46:47], v7 offset:10752
  ds_read_b64_tr_b16 a[48:49], v7 offset:16384
  ds_read_b64_tr_b16 a[50:51], v7 offset:16896
  ds_read_b64_tr_b16 a[52:53], v7 offset:18432
  ds_read_b64_tr_b16 a[54:55], v7 offset:18944
  ds_read_b64_tr_b16 a[56:57], v7 offset:24576
  ds_read_b64_tr_b16 a[58:59], v7 offset:25088
  ds_read_b64_tr_b16 a[60:61], v7 offset:26624
  ds_read_b64_tr_b16 a[62:63], v7 offset:27136
  ds_read_b64_tr_b16 a[64:65], v7 offset:32768
  ds_read_b64_tr_b16 a[66:67], v7 offset:33280
  ds_read_b64_tr_b16 a[68:69], v7 offset:34816
  ds_read_b64_tr_b16 a[70:71], v7 offset:35328
  s_waitcnt lgkmcnt(0)
  s_barrier
  s_mov_b32 s12, s46
  s_mov_b32 s13, s47
  s_mov_b32 s14, 4718592
  s_mov_b32 s15, 0x00020000
  s_add_u32 m0, s25, 0
  s_add_u32 s28, s27, 0
  buffer_load_dwordx4 v3, s[12:15], s28 offen lds
  s_add_u32 m0, s25, 4096
  s_add_u32 s28, s27, 4096
  buffer_load_dwordx4 v3, s[12:15], s28 offen lds
  s_add_u32 m0, s25, 8192
  s_add_u32 s28, s27, 8192
  buffer_load_dwordx4 v3, s[12:15], s28 offen lds
  s_add_u32 m0, s25, 12288
  s_add_u32 s28, s27, 12288
  buffer_load_dwordx4 v3, s[12:15], s28 offen lds
  s_add_u32 m0, s25, 16384
  s_add_u32 s28, s27, 16384
  buffer_load_dwordx4 v3, s[12:15], s28 offen lds
  s_add_u32 m0, s25, 20480
  s_add_u32 s28, s27, 20480
  buffer_load_dwordx4 v3, s[12:15], s28 offen lds
  s_add_u32 m0, s25, 24576
  s_add_u32 s28, s27, 24576
  buffer_load_dwordx4 v3, s[12:15], s28 offen lds
  s_add_u32 m0, s25, 28672
  s_add_u32 s28, s27, 28672
  buffer_load_dwordx4 v3, s[12:15], s28 offen lds
  s_add_u32 m0, s25, 32768
  s_add_u32 s28, s27, 32768
  buffer_load_dwordx4 v3, s[12:15], s28 offen lds
  s_add_u32 m0, s25, 36864
  s_add_u32 s28, s27, 36864
  buffer_load_dwordx4 v3, s[12:15], s28 offen lds
  s_add_u32 m0, s25, 40960
  s_add_u32 s28, s27, 40960
  buffer_load_dwordx4 v3, s[12:15], s28 offen lds
  s_add_u32 m0, s25, 45056
  s_add_u32 s28, s27, 45056
  buffer_load_dwordx4 v3, s[12:15], s28 offen lds
  s_add_u32 m0, s25, 49152
  s_add_u32 s28, s27, 49152
  buffer_load_dwordx4 v3, s[12:15], s28 offen lds
  s_add_u32 m0, s25, 53248
  s_add_u32 s28, s27, 53248
  buffer_load_dwordx4 v3, s[12:15], s28 offen lds
  s_add_u32 m0, s25, 57344
  s_add_u32 s28, s27, 57344
  buffer_load_dwordx4 v3, s[12:15], s28 offen lds
  s_add_u32 m0, s25, 61440
  s_add_u32 s28, s27, 61440
  buffer_load_dwordx4 v3, s[12:15], s28 offen lds
  s_add_u32 m0, s25, 65536
  s_add_u32 s28, s27, 65536
  buffer_load_dwordx4 v3, s[12:15], s28 offen lds
  s_add_u32 m0, s25, 69632
  s_add_u32 s28, s27, 69632
  buffer_load_dwordx4 v3, s[12:15], s28 offen lds
  s_waitcnt vmcnt(18)
  s_barrier
  v_add_u32 v6, 73728, v4
  v_add_u32 v7, 106496, v4
  ds_read_b64_tr_b16 a[72:73], v6 offset:0
  ds_read_b64_tr_b16 a[74:75], v6 offset:512
  ds_read_b64_tr_b16 a[76:77], v6 offset:2048
  ds_read_b64_tr_b16 a[78:79], v6 offset:2560
  ds_read_b64_tr_b16 a[80:81], v6 offset:8192
  ds_read_b64_tr_b16 a[82:83], v6 offset:8704
  ds_read_b64_tr_b16 a[84:85], v6 offset:10240
  ds_read_b64_tr_b16 a[86:87], v6 offset:10752
  ds_read_b64_tr_b16 a[88:89], v6 offset:16384
  ds_read_b64_tr_b16 a[90:91], v6 offset:16896
  ds_read_b64_tr_b16 a[92:93], v6 offset:18432
  ds_read_b64_tr_b16 a[94:95], v6 offset:18944
  ds_read_b64_tr_b16 a[96:97], v6 offset:24576
  ds_read_b64_tr_b16 a[98:99], v6 offset:25088
  ds_read_b64_tr_b16 a[100:101], v6 offset:26624
  ds_read_b64_tr_b16 a[102:103], v6 offset:27136
  ds_read_b64_tr_b16 a[104:105], v7 offset:0
  ds_read_b64_tr_b16 a[106:107], v7 offset:512
  ds_read_b64_tr_b16 a[108:109], v7 offset:2048
  ds_read_b64_tr_b16 a[110:111], v7 offset:2560
  ds_read_b64_tr_b16 a[112:113], v7 offset:8192
  ds_read_b64_tr_b16 a[114:115], v7 offset:8704
  ds_read_b64_tr_b16 a[116:117], v7 offset:10240
  ds_read_b64_tr_b16 a[118:119], v7 offset:10752
  ds_read_b64_tr_b16 a[120:121], v7 offset:16384
  ds_read_b64_tr_b16 a[122:123], v7 offset:16896
  ds_read_b64_tr_b16 a[124:125], v7 offset:18432
  ds_read_b64_tr_b16 a[126:127], v7 offset:18944
  ds_read_b64_tr_b16 a[128:129], v7 offset:24576
  ds_read_b64_tr_b16 a[130:131], v7 offset:25088
  ds_read_b64_tr_b16 a[132:133], v7 offset:26624
  ds_read_b64_tr_b16 a[134:135], v7 offset:27136
  ds_read_b64_tr_b16 a[136:137], v7 offset:32768
  ds_read_b64_tr_b16 a[138:139], v7 offset:33280
  ds_read_b64_tr_b16 a[140:141], v7 offset:34816
  ds_read_b64_tr_b16 a[142:143], v7 offset:35328
  s_waitcnt lgkmcnt(0)
  s_barrier
  s_mov_b32 s12, s46
  s_mov_b32 s13, s47
  s_mov_b32 s14, 4718592
  s_mov_b32 s15, 0x00020000
  s_add_u32 m0, s25, 73728
  s_add_u32 s28, s27, 73728
  buffer_load_dwordx4 v3, s[12:15], s28 offen lds
  s_add_u32 m0, s25, 77824
  s_add_u32 s28, s27, 77824
  buffer_load_dwordx4 v3, s[12:15], s28 offen lds
  s_add_u32 m0, s25, 81920
  s_add_u32 s28, s27, 81920
  buffer_load_dwordx4 v3, s[12:15], s28 offen lds
  s_add_u32 m0, s25, 86016
  s_add_u32 s28, s27, 86016
  buffer_load_dwordx4 v3, s[12:15], s28 offen lds
  s_add_u32 m0, s25, 90112
  s_add_u32 s28, s27, 90112
  buffer_load_dwordx4 v3, s[12:15], s28 offen lds
  s_add_u32 m0, s25, 94208
  s_add_u32 s28, s27, 94208
  buffer_load_dwordx4 v3, s[12:15], s28 offen lds
  s_add_u32 m0, s25, 98304
  s_add_u32 s28, s27, 98304
  buffer_load_dwordx4 v3, s[12:15], s28 offen lds
  s_add_u32 m0, s25, 102400
  s_add_u32 s28, s27, 102400
  buffer_load_dwordx4 v3, s[12:15], s28 offen lds
  s_add_u32 m0, s25, 106496
  s_add_u32 s28, s27, 106496
  buffer_load_dwordx4 v3, s[12:15], s28 offen lds
  s_add_u32 m0, s25, 110592
  s_add_u32 s28, s27, 110592
  buffer_load_dwordx4 v3, s[12:15], s28 offen lds
  s_add_u32 m0, s25, 114688
  s_add_u32 s28, s27, 114688
  buffer_load_dwordx4 v3, s[12:15], s28 offen lds
  s_add_u32 m0, s25, 118784
  s_add_u32 s28, s27, 118784
  buffer_load_dwordx4 v3, s[12:15], s28 offen lds
  s_add_u32 m0, s25, 122880
  s_add_u32 s28, s27, 122880
  buffer_load_dwordx4 v3, s[12:15], s28 offen lds
  s_add_u32 m0, s25, 126976
  s_add_u32 s28, s27, 126976
  buffer_load_dwordx4 v3, s[12:15], s28 offen lds
  s_add_u32 m0, s25, 131072
  s_add_u32 s28, s27, 131072
  buffer_load_dwordx4 v3, s[12:15], s28 offen lds
  s_add_u32 m0, s25, 135168
  s_add_u32 s28, s27, 135168
  buffer_load_dwordx4 v3, s[12:15], s28 offen lds
  s_add_u32 m0, s25, 139264
  s_add_u32 s28, s27, 139264
  buffer_load_dwordx4 v3, s[12:15], s28 offen lds
  s_add_u32 m0, s25, 143360
  s_add_u32 s28, s27, 143360
  buffer_load_dwordx4 v3, s[12:15], s28 offen lds
  s_waitcnt vmcnt(18)
  s_barrier
  v_add_u32 v6, 0, v5
  ds_read_b64_tr_b16 v[72:73], v6 offset:256
  ds_read_b64_tr_b16 v[74:75], v6 offset:2560
  ds_read_b64_tr_b16 v[76:77], v6 offset:37120
  ds_read_b64_tr_b16 v[78:79], v6 offset:39424
  v_bfe_u32 v7, v0, 5, 1
  v_mul_u32_u24 v7, 9216, v7
  v_sub_u32 v6, v6, v7
  v_bfe_u32 v7, v0, 3, 1
  v_mul_u32_u24 v7, 9184, v7
  v_sub_u32 v6, v6, v7
  ds_read_b64_tr_b16 v[8:9], v6 offset:0
  ds_read_b64_tr_b16 v[10:11], v6 offset:2304
  ds_read_b64_tr_b16 v[12:13], v6 offset:18432
  ds_read_b64_tr_b16 v[14:15], v6 offset:20736
  ds_read_b64_tr_b16 v[16:17], v6 offset:36864
  ds_read_b64_tr_b16 v[18:19], v6 offset:39168
  ds_read_b64_tr_b16 v[20:21], v6 offset:55296
  ds_read_b64_tr_b16 v[22:23], v6 offset:57600
  ds_read_b64_tr_b16 v[24:25], v6 offset:64
  ds_read_b64_tr_b16 v[26:27], v6 offset:2368
  ds_read_b64_tr_b16 v[28:29], v6 offset:18496
  ds_read_b64_tr_b16 v[30:31], v6 offset:20800
  ds_read_b64_tr_b16 v[32:33], v6 offset:36928
  ds_read_b64_tr_b16 v[34:35], v6 offset:39232
  ds_read_b64_tr_b16 v[36:37], v6 offset:55360
  ds_read_b64_tr_b16 v[38:39], v6 offset:57664
  ds_read_b64_tr_b16 v[40:41], v6 offset:128
  ds_read_b64_tr_b16 v[42:43], v6 offset:2432
  ds_read_b64_tr_b16 v[44:45], v6 offset:18560
  ds_read_b64_tr_b16 v[46:47], v6 offset:20864
  ds_read_b64_tr_b16 v[48:49], v6 offset:36992
  ds_read_b64_tr_b16 v[50:51], v6 offset:39296
  ds_read_b64_tr_b16 v[52:53], v6 offset:55424
  ds_read_b64_tr_b16 v[54:55], v6 offset:57728
  ds_read_b64_tr_b16 v[56:57], v6 offset:192
  ds_read_b64_tr_b16 v[58:59], v6 offset:2496
  ds_read_b64_tr_b16 v[60:61], v6 offset:18624
  ds_read_b64_tr_b16 v[62:63], v6 offset:20928
  ds_read_b64_tr_b16 v[64:65], v6 offset:37056
  ds_read_b64_tr_b16 v[66:67], v6 offset:39360
  ds_read_b64_tr_b16 v[68:69], v6 offset:55488
  ds_read_b64_tr_b16 v[70:71], v6 offset:57792
  s_waitcnt lgkmcnt(0)
  s_waitcnt vmcnt(0)
  s_barrier
  s_mul_i32 s28, s21, 18432
  v_add_u32 v6, s28, v3
  ds_write_b128 v6, v[152:155] offset:0
  ds_write_b128 v6, v[156:159] offset:1024
  ds_write_b128 v6, v[160:163] offset:2048
  ds_write_b128 v6, v[164:167] offset:3072
  ds_write_b128 v6, v[168:171] offset:4096
  ds_write_b128 v6, v[172:175] offset:5120
  ds_write_b128 v6, v[176:179] offset:6144
  ds_write_b128 v6, v[180:183] offset:7168
  ds_write_b128 v6, v[184:187] offset:8192
  ds_write_b128 v6, v[188:191] offset:9216
  ds_write_b128 v6, v[192:195] offset:10240
  ds_write_b128 v6, v[196:199] offset:11264
  ds_write_b128 v6, v[200:203] offset:12288
  ds_write_b128 v6, v[204:207] offset:13312
  ds_write_b128 v6, v[208:211] offset:14336
  ds_write_b128 v6, v[212:215] offset:15360
  ds_write_b128 v6, v[216:219] offset:16384
  ds_write_b128 v6, v[220:223] offset:17408
  s_waitcnt lgkmcnt(0)
  v_add_u32 v6, 73728, v5
  ds_read_b64_tr_b16 v[216:217], v6 offset:256
  ds_read_b64_tr_b16 v[218:219], v6 offset:2560
  ds_read_b64_tr_b16 v[220:221], v6 offset:37120
  ds_read_b64_tr_b16 v[222:223], v6 offset:39424
  v_bfe_u32 v7, v0, 5, 1
  v_mul_u32_u24 v7, 9216, v7
  v_sub_u32 v6, v6, v7
  v_bfe_u32 v7, v0, 3, 1
  v_mul_u32_u24 v7, 9184, v7
  v_sub_u32 v6, v6, v7
  ds_read_b64_tr_b16 v[152:153], v6 offset:0
  ds_read_b64_tr_b16 v[154:155], v6 offset:2304
  ds_read_b64_tr_b16 v[156:157], v6 offset:18432
  ds_read_b64_tr_b16 v[158:159], v6 offset:20736
  ds_read_b64_tr_b16 v[160:161], v6 offset:36864
  ds_read_b64_tr_b16 v[162:163], v6 offset:39168
  ds_read_b64_tr_b16 v[164:165], v6 offset:55296
  ds_read_b64_tr_b16 v[166:167], v6 offset:57600
  ds_read_b64_tr_b16 v[168:169], v6 offset:64
  ds_read_b64_tr_b16 v[170:171], v6 offset:2368
  ds_read_b64_tr_b16 v[172:173], v6 offset:18496
  ds_read_b64_tr_b16 v[174:175], v6 offset:20800
  ds_read_b64_tr_b16 v[176:177], v6 offset:36928
  ds_read_b64_tr_b16 v[178:179], v6 offset:39232
  ds_read_b64_tr_b16 v[180:181], v6 offset:55360
  ds_read_b64_tr_b16 v[182:183], v6 offset:57664
  ds_read_b64_tr_b16 v[184:185], v6 offset:128
  ds_read_b64_tr_b16 v[186:187], v6 offset:2432
  ds_read_b64_tr_b16 v[188:189], v6 offset:18560
  ds_read_b64_tr_b16 v[190:191], v6 offset:20864
  ds_read_b64_tr_b16 v[192:193], v6 offset:36992
  ds_read_b64_tr_b16 v[194:195], v6 offset:39296
  ds_read_b64_tr_b16 v[196:197], v6 offset:55424
  ds_read_b64_tr_b16 v[198:199], v6 offset:57728
  ds_read_b64_tr_b16 v[200:201], v6 offset:192
  ds_read_b64_tr_b16 v[202:203], v6 offset:2496
  ds_read_b64_tr_b16 v[204:205], v6 offset:18624
  ds_read_b64_tr_b16 v[206:207], v6 offset:20928
  ds_read_b64_tr_b16 v[208:209], v6 offset:37056
  ds_read_b64_tr_b16 v[210:211], v6 offset:39360
  ds_read_b64_tr_b16 v[212:213], v6 offset:55488
  ds_read_b64_tr_b16 v[214:215], v6 offset:57792
  s_waitcnt lgkmcnt(0)
  s_barrier
  s_mul_i32 s28, s21, 18432
  s_add_u32 s28, s28, 73728
  v_add_u32 v6, s28, v3
  ds_write_b128 v6, v[80:83] offset:0
  ds_write_b128 v6, v[84:87] offset:1024
  ds_write_b128 v6, v[88:91] offset:2048
  ds_write_b128 v6, v[92:95] offset:3072
  ds_write_b128 v6, v[96:99] offset:4096
  ds_write_b128 v6, v[100:103] offset:5120
  ds_write_b128 v6, v[104:107] offset:6144
  ds_write_b128 v6, v[108:111] offset:7168
  ds_write_b128 v6, v[112:115] offset:8192
  ds_write_b128 v6, v[116:119] offset:9216
  ds_write_b128 v6, v[120:123] offset:10240
  ds_write_b128 v6, v[124:127] offset:11264
  ds_write_b128 v6, v[128:131] offset:12288
  ds_write_b128 v6, v[132:135] offset:13312
  ds_write_b128 v6, v[136:139] offset:14336
  ds_write_b128 v6, v[140:143] offset:15360
  ds_write_b128 v6, v[144:147] offset:16384
  ds_write_b128 v6, v[148:151] offset:17408
  s_waitcnt lgkmcnt(0)
  v_mov_b32 v80, v8
  v_mov_b32 v81, v9
  v_mov_b32 v82, v10
  v_mov_b32 v83, v11
  v_mov_b32 v84, v12
  v_mov_b32 v85, v13
  v_mov_b32 v86, v14
  v_mov_b32 v87, v15
  v_mov_b32 v88, v16
  v_mov_b32 v89, v17
  v_mov_b32 v90, v18
  v_mov_b32 v91, v19
  v_mov_b32 v92, v20
  v_mov_b32 v93, v21
  v_mov_b32 v94, v22
  v_mov_b32 v95, v23
  v_mov_b32 v96, v24
  v_mov_b32 v97, v25
  v_mov_b32 v98, v26
  v_mov_b32 v99, v27
  v_mov_b32 v100, v28
  v_mov_b32 v101, v29
  v_mov_b32 v102, v30
  v_mov_b32 v103, v31
  v_mov_b32 v104, v32
  v_mov_b32 v105, v33
  v_mov_b32 v106, v34
  v_mov_b32 v107, v35
  v_mov_b32 v108, v36
  v_mov_b32 v109, v37
  v_mov_b32 v110, v38
  v_mov_b32 v111, v39
  v_mov_b32 v112, v40
  v_mov_b32 v113, v41
  v_mov_b32 v114, v42
  v_mov_b32 v115, v43
  v_mov_b32 v116, v44
  v_mov_b32 v117, v45
  v_mov_b32 v118, v46
  v_mov_b32 v119, v47
  v_mov_b32 v120, v48
  v_mov_b32 v121, v49
  v_mov_b32 v122, v50
  v_mov_b32 v123, v51
  v_mov_b32 v124, v52
  v_mov_b32 v125, v53
  v_mov_b32 v126, v54
  v_mov_b32 v127, v55
  v_mov_b32 v128, v56
  v_mov_b32 v129, v57
  v_mov_b32 v130, v58
  v_mov_b32 v131, v59
  v_mov_b32 v132, v60
  v_mov_b32 v133, v61
  v_mov_b32 v134, v62
  v_mov_b32 v135, v63
  v_mov_b32 v136, v64
  v_mov_b32 v137, v65
  v_mov_b32 v138, v66
  v_mov_b32 v139, v67
  v_mov_b32 v140, v68
  v_mov_b32 v141, v69
  v_mov_b32 v142, v70
  v_mov_b32 v143, v71
  v_mov_b32 v144, v72
  v_mov_b32 v145, v73
  v_mov_b32 v146, v74
  v_mov_b32 v147, v75
  v_mov_b32 v148, v76
  v_mov_b32 v149, v77
  v_mov_b32 v150, v78
  v_mov_b32 v151, v79
  s_mov_b32 s12, s48
  s_mov_b32 s13, s49
  s_mov_b32 s14, 9216
  s_mov_b32 s15, 0x00020000
  s_lshl_b32 s28, s21, 6
  v_add_u32 v6, s28, v0
  v_add_u32 v7, 0, v6
  v_min_u32 v7, 575, v7
  v_lshlrev_b32 v8, 1, v7
  v_lshlrev_b32 v7, 4, v7
  v_add_u32 v7, 147456, v7
  buffer_load_ushort v20, v8, s[12:15], 0 offen offset:0
  buffer_load_ushort v21, v8, s[12:15], 0 offen offset:1152
  buffer_load_ushort v22, v8, s[12:15], 0 offen offset:2304
  v_add_u32 v8, 3456, v8
  buffer_load_ushort v23, v8, s[12:15], 0 offen offset:0
  buffer_load_ushort v24, v8, s[12:15], 0 offen offset:1152
  buffer_load_ushort v25, v8, s[12:15], 0 offen offset:2304
  v_add_u32 v8, 3456, v8
  buffer_load_ushort v26, v8, s[12:15], 0 offen offset:0
  buffer_load_ushort v27, v8, s[12:15], 0 offen offset:1152
  s_waitcnt vmcnt(0)
  v_lshl_or_b32 v12, v21, 16, v20
  v_lshl_or_b32 v13, v23, 16, v22
  v_lshl_or_b32 v14, v25, 16, v24
  v_lshl_or_b32 v15, v27, 16, v26
  ds_write_b128 v7, v[12:15]
  s_waitcnt lgkmcnt(0)
  v_add_u32 v7, 256, v6
  v_min_u32 v7, 575, v7
  v_lshlrev_b32 v8, 1, v7
  v_lshlrev_b32 v7, 4, v7
  v_add_u32 v7, 147456, v7
  buffer_load_ushort v20, v8, s[12:15], 0 offen offset:0
  buffer_load_ushort v21, v8, s[12:15], 0 offen offset:1152
  buffer_load_ushort v22, v8, s[12:15], 0 offen offset:2304
  v_add_u32 v8, 3456, v8
  buffer_load_ushort v23, v8, s[12:15], 0 offen offset:0
  buffer_load_ushort v24, v8, s[12:15], 0 offen offset:1152
  buffer_load_ushort v25, v8, s[12:15], 0 offen offset:2304
  v_add_u32 v8, 3456, v8
  buffer_load_ushort v26, v8, s[12:15], 0 offen offset:0
  buffer_load_ushort v27, v8, s[12:15], 0 offen offset:1152
  s_waitcnt vmcnt(0)
  v_lshl_or_b32 v12, v21, 16, v20
  v_lshl_or_b32 v13, v23, 16, v22
  v_lshl_or_b32 v14, v25, 16, v24
  v_lshl_or_b32 v15, v27, 16, v26
  ds_write_b128 v7, v[12:15]
  s_waitcnt lgkmcnt(0)
  v_add_u32 v7, 512, v6
  v_min_u32 v7, 575, v7
  v_lshlrev_b32 v8, 1, v7
  v_lshlrev_b32 v7, 4, v7
  v_add_u32 v7, 147456, v7
  buffer_load_ushort v20, v8, s[12:15], 0 offen offset:0
  buffer_load_ushort v21, v8, s[12:15], 0 offen offset:1152
  buffer_load_ushort v22, v8, s[12:15], 0 offen offset:2304
  v_add_u32 v8, 3456, v8
  buffer_load_ushort v23, v8, s[12:15], 0 offen offset:0
  buffer_load_ushort v24, v8, s[12:15], 0 offen offset:1152
  buffer_load_ushort v25, v8, s[12:15], 0 offen offset:2304
  v_add_u32 v8, 3456, v8
  buffer_load_ushort v26, v8, s[12:15], 0 offen offset:0
  buffer_load_ushort v27, v8, s[12:15], 0 offen offset:1152
  s_waitcnt vmcnt(0)
  v_lshl_or_b32 v12, v21, 16, v20
  v_lshl_or_b32 v13, v23, 16, v22
  v_lshl_or_b32 v14, v25, 16, v24
  v_lshl_or_b32 v15, v27, 16, v26
  ds_write_b128 v7, v[12:15]
  s_waitcnt lgkmcnt(0)
  v_mov_b32 v14, v0
  v_and_b32 v15, 15, v14
  v_lshrrev_b32 v16, 4, v14
  v_lshlrev_b32 v17, 4, v14
  v_add_u32 v0, 156672, v17
  s_mul_i32 s28, s21, 18432
  v_add_u32 v1, s28, v17
  v_bfe_u32 v18, v14, 3, 1
  v_lshlrev_b32 v2, 2, v18
  v_bfe_u32 v18, v14, 2, 1
  v_add_u32 v2, v2, v18
  v_bfe_u32 v18, v14, 1, 1
  v_lshl_add_u32 v2, v18, 1, v2
  v_lshl_add_u32 v2, v16, 3, v2
  v_lshlrev_b32 v2, 4, v2
  v_and_b32 v18, 1, v14
  v_lshl_add_u32 v2, v18, 3, v2
  v_add_u32 v2, 147456, v2
  s_mul_i32 s28, s21, 1280
  v_add_u32 v3, s28, v0
  v_and_b32 v4, 31, v14
  v_lshlrev_b32 v4, 3, v4
  v_add_u32 v4, 157696, v4
  v_add_u32 v5, s28, v4
  v_and_b32 v18, 1, v16
  v_lshrrev_b32 v19, 1, v16
  v_lshlrev_b32 v6, 4, v15
  v_lshl_add_u32 v6, v18, 3, v6
  v_lshl_add_u32 v6, v19, 7, v6
  s_lshl_b32 s28, s21, 8
  s_add_u32 s28, s28, 161792
  v_add_u32 v6, s28, v6
  s_mul_i32 s29, s20, 3
  s_add_u32 s29, s29, s21
  s_lshl_b32 s30, s29, 7
  s_add_u32 s30, s30, 71827456
  s_sub_u32 s30, s30, s28
  s_lshl_b32 s31, s29, 12
  s_add_u32 s31, s31, 71146496
  v_lshl_add_u32 v7, v18, 1, v19
  v_lshl_add_u32 v7, v7, 4, v15
  s_mul_i32 s28, s21, 144
  v_add_u32 v7, s28, v7
  s_add_u32 s28, s28, 128
  v_add_u32 v8, s28, v15
  v_lshrrev_b32 v20, 3, v7
  v_and_b32 v7, 7, v7
  v_lshlrev_b32 v7, 4, v7
  v_lshl_add_u32 v7, v20, 12, v7
  v_lshrrev_b32 v20, 3, v8
  v_and_b32 v8, 7, v8
  v_lshlrev_b32 v8, 4, v8
  v_lshl_add_u32 v8, v20, 12, v8
  v_lshl_add_u32 v8, v18, 3, v8
  v_lshl_add_u32 v8, v19, 2, v8
  s_lshl_b32 s32, s20, 7
  s_add_u32 s32, s32, 71303168
  s_add_u32 s33, s32, 32768
  s_mul_i32 s28, s21, 2304
  s_add_u32 s28, s28, 147456
  v_add_u32 v9, s28, v17
  s_add_u32 s28, s28, 2048
  v_and_b32 v10, 31, v14
  v_lshl_add_u32 v10, v10, 3, s28
  s_mov_b32 s34, 71680000
  s_mov_b32 s60, 0xff00ff00
  s_mov_b32 s61, 0xff00ff00
  s_mov_b32 s62, 0x00ff00ff
  s_mov_b32 s63, 0x00ff00ff
  s_mov_b32 s64, -1
  s_mov_b32 s65, 0
  v_mov_b32 v11, 0x4444
  v_mov_b32 v18, 0xeeee
  v_cndmask_b32 v11, v11, v18, s[60:61]
  v_and_b32 v18, 7, v15
  v_and_b32 v19, 1, v16
  v_lshlrev_b32 v19, 2, v19
  v_sub_u32 v18, v18, v19
  v_mov_b32 v12, 0
  v_mov_b32 v13, 0
  v_mov_b32 v20, 0x3f80
  v_mov_b32 v21, 0x3f800000
  v_cmp_eq_u32 vcc, 0, v18
  s_nop 1
  v_cndmask_b32 v12, v12, v20, vcc
  v_cmp_eq_u32 vcc, 1, v18
  s_nop 1
  v_cndmask_b32 v12, v12, v21, vcc
  v_cmp_eq_u32 vcc, 2, v18
  s_nop 1
  v_cndmask_b32 v13, v13, v20, vcc
  v_cmp_eq_u32 vcc, 3, v18
  s_nop 1
  v_cndmask_b32 v13, v13, v21, vcc
  v_and_b32 v18, 7, v15
  v_lshrrev_b32 v18, 1, v18
  v_cmp_eq_u32 s[66:67], 0, v18
  v_cmp_eq_u32 s[68:69], 1, v18
  v_cmp_eq_u32 s[70:71], 2, v18
  v_cmp_eq_u32 s[72:73], 3, v18
  s_mov_b32 s74, 0xaaaaaaaa
  s_mov_b32 s75, 0xaaaaaaaa
  s_lshl_b32 s35, s20, 13
  s_lshl_b32 s28, s21, 11
  s_add_u32 s36, s35, s28
  s_add_u32 s37, s36, 37592064
  s_add_u32 s36, s36, 20814848
  s_add_u32 s35, s35, 20242432
  s_lshl_b32 s28, s21, 8
  s_add_u32 m0, s28, 161792
  s_mov_b32 s84, 0xffff0000
  s_mov_b32 s85, s84
  s_lshl_b32 s38, s20, 12
  s_lshl_b32 s28, s21, 10
  s_add_u32 s38, s38, s28
  s_add_u32 s39, s38, 62757888
  s_add_u32 s38, s38, 54369280
  s_mov_b32 s76, 0x3e0293ee
  s_mov_b32 s77, 0x3f803f80
  s_mov_b32 s22, 0
  s_mov_b32 s23, 1
  s_cmp_lt_u32 s20, 24
  s_cselect_b32 s78, 1, 0
  s_cmp_lt_u32 s21, 3
  s_cselect_b32 s78, s78, 0
  v_mov_b32 v20, 0
  s_mov_b32 s79, 0
HS_2:
  buffer_load_dwordx2 v[18:19], v20, s[16:19], 0 offen sc1
  s_add_u32 s79, s79, 1
  s_cmp_gt_u32 s79, 0x100000
  s_cbranch_scc1 CH_END
  s_waitcnt vmcnt(0)
  v_readfirstlane_b32 s28, v18
  v_readfirstlane_b32 s29, v19
  s_cmp_lt_u32 s28, 32
  s_cbranch_scc1 HS_2
  s_bcnt1_i32_b32 s29, s29
  s_lshl_b32 s81, s20, 7
  s_cmp_eq_u32 s21, 3
  s_cselect_b64 s[40:41], 1, 0
  s_add_u32 s81, s81, 71958528
  s_mov_b32 s80, 0
  s_mov_b32 s79, 0
RDY_3:
  s_add_u32 s28, s22, 2
  s_cmp_lt_u32 s28, s80
  s_cbranch_scc1 RDY_3_ok
  v_mbcnt_lo_u32_b32 v18, -1, 0
  v_lshlrev_b32 v18, 2, v18
  buffer_load_dword v18, v18, s[16:19], 0 offen offset:8 sc1
  s_add_u32 s79, s79, 1
  s_cmp_gt_u32 s79, 0x100000
  s_cbranch_scc1 CH_END
  s_waitcnt vmcnt(0)
  v_and_b32 v18, 0x200, v18
  v_cmp_ne_u32 vcc, 0, v18
  s_nop 1
  s_and_b32 s28, vcc_lo, 0xffff
  s_ff0_i32_b32 s28, s28
  s_lshl_b32 s80, s28, 2
  s_cmp_eq_u32 s28, 16
  s_cselect_b32 s80, 0x3e8, s80
  s_cmp_lg_u32 s80, 0
  s_cbranch_scc1 RDY_3
  s_sleep 24
  s_branch RDY_3
RDY_3_ok:
  s_cmp_eq_u32 s29, 1
  s_cbranch_scc0 CH_SLOW
  v_mov_b32 v50, 0
  v_mov_b32 v51, 0
  v_mov_b32 v52, 0
  v_mov_b32 v53, 0
  v_mov_b32 v54, 0
  v_mov_b32 v55, 0
  v_mov_b32 v56, 0
  v_mov_b32 v57, 0
  v_mov_b32 v58, 0
  v_mov_b32 v59, 0
  v_mov_b32 v60, 0
  v_mov_b32 v61, 0
  v_mov_b32 v62, 0
  v_mov_b32 v63, 0
  v_mov_b32 v64, 0
  v_mov_b32 v65, 0
  v_mov_b32 v66, 0
  v_mov_b32 v67, 0
  v_mov_b32 v68, 0
  v_mov_b32 v69, 0
  v_mov_b32 v70, 0
  v_mov_b32 v71, 0
  v_mov_b32 v72, 0
  v_mov_b32 v73, 0
  ds_read_b128 v[22:25], v1 offset:0
  ds_read_b128 v[26:29], v1 offset:1024
  ds_read_b128 v[30:33], v1 offset:2048
  ds_read_b128 v[34:37], v1 offset:3072
  buffer_load_dwordx4 v[14:17], v0, s[8:11], s36 offen sc1
  buffer_load_dwordx4 v[18:21], v0, s[8:11], s36 offen offset:1024 sc1
  s_mov_b32 s83, 0
  s_mov_b32 s82, 0
  v_mov_b32 v40, 17196032
  v_mov_b32 v41, 418816
  v_cndmask_b32 v40, v40, v41, s[84:85]
  v_and_b32 v39, 0xf0, v0
  v_lshl_add_u32 v39, v39, 3, v40
  s_waitcnt lgkmcnt(0)
STEPF:
  s_barrier
  buffer_load_dword v39, s[8:11], s36 offen sc1 lds
  buffer_store_dwordx4 v[44:47], v0, s[8:11], s39 offen sc1
  s_add_u32 s39, s39, s83
  ds_read_b64_tr_b16 v[38:39], v2 offset:0
  ds_read_b64_tr_b16 v[40:41], v2 offset:512
  ds_read_b64_tr_b16 v[42:43], v2 offset:1024
  ds_read_b64_tr_b16 v[44:45], v2 offset:1536
  ds_read_b64_tr_b16 v[46:47], v2 offset:2048
  ds_read_b64_tr_b16 v[48:49], v2 offset:2560
  s_waitcnt lgkmcnt(4)
  v_smfmac_f32_16x16x64_bf16 v[50:53], v[38:41], a[0:7], v11
  v_smfmac_f32_16x16x64_bf16 v[54:57], v[38:41], a[72:79], v11
  v_smfmac_f32_16x16x64_bf16 v[58:61], v[38:41], a[144:151], v11
  v_smfmac_f32_16x16x64_bf16 v[62:65], v[38:41], v[22:29], v11
  s_waitcnt lgkmcnt(2)
  v_smfmac_f32_16x16x64_bf16 v[50:53], v[42:45], a[8:15], v11
  ds_read_b128 v[22:25], v1 offset:4096
  ds_read_b128 v[26:29], v1 offset:5120
  v_smfmac_f32_16x16x64_bf16 v[54:57], v[42:45], a[80:87], v11
  ds_read_b64_tr_b16 v[38:39], v2 offset:3072
  ds_read_b64_tr_b16 v[40:41], v2 offset:3584
  v_smfmac_f32_16x16x64_bf16 v[58:61], v[42:45], a[152:159], v11
  v_smfmac_f32_16x16x64_bf16 v[62:65], v[42:45], v[30:37], v11
  s_waitcnt lgkmcnt(4)
  v_smfmac_f32_16x16x64_bf16 v[50:53], v[46:49], a[16:23], v11
  ds_read_b128 v[30:33], v1 offset:6144
  ds_read_b128 v[34:37], v1 offset:7168
  v_smfmac_f32_16x16x64_bf16 v[54:57], v[46:49], a[88:95], v11
  ds_read_b64_tr_b16 v[42:43], v2 offset:4096
  ds_read_b64_tr_b16 v[44:45], v2 offset:4608
  v_smfmac_f32_16x16x64_bf16 v[58:61], v[46:49], a[160:167], v11
  s_waitcnt lgkmcnt(6)
  v_smfmac_f32_16x16x64_bf16 v[62:65], v[46:49], v[22:29], v11
  s_waitcnt lgkmcnt(4)
  v_smfmac_f32_16x16x64_bf16 v[50:53], v[38:41], a[24:31], v11
  ds_read_b128 v[22:25], v1 offset:8192
  ds_read_b128 v[26:29], v1 offset:9216
  v_smfmac_f32_16x16x64_bf16 v[54:57], v[38:41], a[96:103], v11
  ds_read_b64_tr_b16 v[46:47], v2 offset:5120
  ds_read_b64_tr_b16 v[48:49], v2 offset:5632
  v_smfmac_f32_16x16x64_bf16 v[58:61], v[38:41], a[168:175], v11
  s_waitcnt vmcnt(4)
  s_waitcnt lgkmcnt(6)
  v_smfmac_f32_16x16x64_bf16 v[62:65], v[38:41], v[30:37], v11
  v_mov_b64 v[66:67], 0
  s_waitcnt lgkmcnt(4)
  v_smfmac_f32_16x16x64_bf16 v[50:53], v[42:45], a[32:39], v11
  ds_read_b128 v[30:33], v1 offset:10240
  ds_read_b128 v[34:37], v1 offset:11264
  v_smfmac_f32_16x16x64_bf16 v[54:57], v[42:45], a[104:111], v11
  ds_read_b64_tr_b16 v[38:39], v2 offset:6144
  ds_read_b64_tr_b16 v[40:41], v2 offset:6656
  v_smfmac_f32_16x16x64_bf16 v[58:61], v[42:45], a[176:183], v11
  s_waitcnt lgkmcnt(6)
  v_smfmac_f32_16x16x64_bf16 v[62:65], v[42:45], v[22:29], v11
  v_mov_b64 v[68:69], 0
  s_waitcnt lgkmcnt(4)
  v_smfmac_f32_16x16x64_bf16 v[50:53], v[46:49], a[40:47], v11
  ds_read_b128 v[22:25], v1 offset:12288
  ds_read_b128 v[26:29], v1 offset:13312
  v_smfmac_f32_16x16x64_bf16 v[54:57], v[46:49], a[112:119], v11
  ds_read_b64_tr_b16 v[42:43], v2 offset:7168
  ds_read_b64_tr_b16 v[44:45], v2 offset:7680
  v_smfmac_f32_16x16x64_bf16 v[58:61], v[46:49], a[184:191], v11
  s_waitcnt lgkmcnt(6)
  v_smfmac_f32_16x16x64_bf16 v[62:65], v[46:49], v[30:37], v11
  v_mov_b64 v[70:71], 0
  s_waitcnt lgkmcnt(4)
  v_smfmac_f32_16x16x64_bf16 v[50:53], v[38:41], a[48:55], v11
  ds_read_b128 v[30:33], v1 offset:14336
  ds_read_b128 v[34:37], v1 offset:15360
  v_smfmac_f32_16x16x64_bf16 v[54:57], v[38:41], a[120:127], v11
  ds_read_b64_tr_b16 v[46:47], v2 offset:8192
  ds_read_b64_tr_b16 v[48:49], v2 offset:8704
  v_smfmac_f32_16x16x64_bf16 v[58:61], v[38:41], a[192:199], v11
  s_waitcnt lgkmcnt(6)
  v_smfmac_f32_16x16x64_bf16 v[62:65], v[38:41], v[22:29], v11
  v_mov_b64 v[72:73], 0
  s_waitcnt lgkmcnt(4)
  v_smfmac_f32_16x16x64_bf16 v[50:53], v[42:45], a[56:63], v11
  ds_read_b128 v[22:25], v1 offset:16384
  ds_read_b128 v[26:29], v1 offset:17408
  v_smfmac_f32_16x16x64_bf16 v[54:57], v[42:45], a[128:135], v11
  ds_read_b64_tr_b16 v[38:39], v2 offset:0
  ds_read_b64_tr_b16 v[40:41], v2 offset:512
  v_smfmac_f32_16x16x64_bf16 v[58:61], v[42:45], a[200:207], v11
  v_add_u32 v1, 73728, v1
  s_waitcnt lgkmcnt(6)
  v_smfmac_f32_16x16x64_bf16 v[62:65], v[42:45], v[30:37], v11
  s_waitcnt lgkmcnt(4)
  v_smfmac_f32_16x16x64_bf16 v[50:53], v[46:49], a[64:71], v11
  ds_read_b128 v[30:33], v1 offset:0
  ds_read_b128 v[34:37], v1 offset:1024
  v_smfmac_f32_16x16x64_bf16 v[54:57], v[46:49], a[136:143], v11
  ds_read_b64_tr_b16 v[42:43], v2 offset:1024
  ds_read_b64_tr_b16 v[44:45], v2 offset:1536
  v_smfmac_f32_16x16x64_bf16 v[58:61], v[46:49], a[208:215], v11
  s_waitcnt lgkmcnt(6)
  v_smfmac_f32_16x16x64_bf16 v[62:65], v[46:49], v[22:29], v11
  ds_read_b128 v[22:25], v1 offset:2048
  ds_read_b128 v[26:29], v1 offset:3072
  s_waitcnt lgkmcnt(4)
  v_smfmac_f32_16x16x64_bf16 v[70:73], v[38:41], v[30:37], v11
  ds_read_b128 v[30:33], v1 offset:4096
  ds_read_b128 v[34:37], v1 offset:5120
  v_smfmac_f32_16x16x64_bf16 v[66:69], v[38:41], a[216:223], v11
  ds_read_b64_tr_b16 v[38:39], v2 offset:2048
  ds_read_b64_tr_b16 v[40:41], v2 offset:2560
  s_nop 1
  v_cvt_pk_bf16_f32 v74, v50, v51
  v_cvt_pk_bf16_f32 v75, v52, v53
  v_cvt_pk_bf16_f32 v76, v54, v55
  v_cvt_pk_bf16_f32 v77, v56, v57
  v_cvt_pk_bf16_f32 v78, v58, v59
  v_cvt_pk_bf16_f32 v79, v60, v61
  v_cvt_pk_bf16_f32 v46, v62, v63
  v_cvt_pk_bf16_f32 v47, v64, v65
  v_mfma_f32_16x16x16_bf16 v[50:53], v[74:75], v[12:13], 0
  v_mfma_f32_16x16x16_bf16 v[54:57], v[76:77], v[12:13], 0
  v_mfma_f32_16x16x16_bf16 v[58:61], v[78:79], v[12:13], 0
  v_mfma_f32_16x16x16_bf16 v[62:65], v[46:47], v[12:13], 0
  s_waitcnt lgkmcnt(4)
  v_smfmac_f32_16x16x64_bf16 v[70:73], v[42:45], v[22:29], v11
  ds_read_b128 v[22:25], v1 offset:6144
  ds_read_b128 v[26:29], v1 offset:7168
  v_smfmac_f32_16x16x64_bf16 v[66:69], v[42:45], a[224:231], v11
  ds_read_b64_tr_b16 v[42:43], v2 offset:3072
  ds_read_b64_tr_b16 v[44:45], v2 offset:3584
  s_nop 0
  v_cvt_pk_bf16_f32 v74, v50, v51
  v_cvt_pk_bf16_f32 v75, v52, v53
  v_cvt_pk_bf16_f32 v76, v54, v55
  v_cvt_pk_bf16_f32 v77, v56, v57
  v_cvt_pk_bf16_f32 v46, v58, v59
  v_cvt_pk_bf16_f32 v47, v60, v61
  v_cvt_pk_bf16_f32 v48, v62, v63
  v_cvt_pk_bf16_f32 v49, v64, v65
  s_waitcnt vmcnt(2)
  v_mfma_f32_16x16x32_bf16 v[54:57], v[14:17], v[74:77], 0
  v_mfma_f32_16x16x32_bf16 v[58:61], v[18:21], v[74:77], 0
  v_mfma_f32_16x16x32_bf16 v[50:53], v[46:49], v[74:77], 0
  buffer_load_dwordx4 v[14:17], v0, s[8:11], s37 offen sc1
  buffer_load_dwordx4 v[18:21], v0, s[8:11], s37 offen offset:1024 sc1
  s_waitcnt lgkmcnt(4)
  v_smfmac_f32_16x16x64_bf16 v[70:73], v[38:41], v[30:37], v11
  ds_read_b128 v[30:33], v1 offset:8192
  ds_read_b128 v[34:37], v1 offset:9216
  v_smfmac_f32_16x16x64_bf16 v[66:69], v[38:41], a[232:239], v11
  ds_read_b64_tr_b16 v[38:39], v2 offset:4096
  ds_read_b64_tr_b16 v[40:41], v2 offset:4608
  v_cndmask_b32 v62, v54, v58, s[60:61]
  v_cndmask_b32 v63, v55, v59, s[60:61]
  v_cndmask_b32 v64, v56, v60, s[60:61]
  v_cndmask_b32 v65, v57, v61, s[60:61]
  v_cndmask_b32 v78, v50, v52, s[60:61]
  v_cndmask_b32 v79, v51, v53, s[60:61]
  ds_write_b128 v3, v[62:65]
  ds_write_b64 v5, v[78:79]
  buffer_store_dwordx4 v[46:49], v0, s[8:11], s38 offen sc1
  v_mov_b32 v54, s82
  s_mov_b64 exec, s[40:41]
  buffer_store_byte v54, off, s[8:11], s81 sc1
  s_mov_b64 exec, -1
  s_waitcnt lgkmcnt(6)
  v_smfmac_f32_16x16x64_bf16 v[70:73], v[42:45], v[22:29], v11
  ds_read_b128 v[22:25], v1 offset:10240
  ds_read_b128 v[26:29], v1 offset:11264
  v_smfmac_f32_16x16x64_bf16 v[66:69], v[42:45], a[240:247], v11
  ds_read_b64_tr_b16 v[42:43], v2 offset:5120
  ds_read_b64_tr_b16 v[44:45], v2 offset:5632
  s_waitcnt lgkmcnt(4)
  s_barrier
  ds_read_b128 v[50:53], v0 offset:0
  ds_read_b64 v[74:75], v4 offset:0
  ds_read_b128 v[54:57], v0 offset:1280
  ds_read_b64 v[76:77], v4 offset:1280
  ds_read_b128 v[58:61], v0 offset:2560
  ds_read_b64 v[78:79], v4 offset:2560
  ds_read_b128 v[62:65], v0 offset:3840
  ds_read_b64 v[46:47], v4 offset:3840
  s_waitcnt lgkmcnt(14)
  v_smfmac_f32_16x16x64_bf16 v[70:73], v[38:41], v[30:37], v11
  ds_read_b128 v[30:33], v1 offset:12288
  ds_read_b128 v[34:37], v1 offset:13312
  v_smfmac_f32_16x16x64_bf16 v[66:69], v[38:41], a[248:255], v11
  ds_read_b64_tr_b16 v[38:39], v2 offset:6144
  ds_read_b64_tr_b16 v[40:41], v2 offset:6656
  s_waitcnt lgkmcnt(8)
  v_pk_add_f32 v[50:51], v[50:51], v[54:55]
  v_pk_add_f32 v[52:53], v[52:53], v[56:57]
  v_pk_add_f32 v[74:75], v[74:75], v[76:77]
  s_waitcnt lgkmcnt(4)
  v_pk_add_f32 v[58:59], v[58:59], v[62:63]
  v_pk_add_f32 v[60:61], v[60:61], v[64:65]
  v_pk_add_f32 v[78:79], v[78:79], v[46:47]
  v_pk_add_f32 v[50:51], v[50:51], v[58:59]
  v_pk_add_f32 v[52:53], v[52:53], v[60:61]
  v_pk_add_f32 v[74:75], v[74:75], v[78:79]
  v_max3_f32 v54, v50, v51, v52
  v_max3_f32 v54, v54, v53, v74
  s_waitcnt lgkmcnt(12)
  v_smfmac_f32_16x16x64_bf16 v[70:73], v[42:45], v[22:29], v11
  ds_read_b128 v[22:25], v1 offset:14336
  ds_read_b128 v[26:29], v1 offset:15360
  v_max_f32 v54, v54, v75
  v_smfmac_f32_16x16x64_bf16 v[66:69], v[42:45], v[224:231], v11
  ds_read_b64_tr_b16 v[42:43], v2 offset:7168
  ds_read_b64_tr_b16 v[44:45], v2 offset:7680
  v_max_f32_dpp v54, v54, v54 row_ror:8 row_mask:0xf bank_mask:0xf
  v_mov_b32 v55, v54
  v_mov_b32 v60, s77
  v_mov_b32 v61, s77
  v_permlane16_swap_b32 v54, v55
  v_max_f32 v54, v54, v55
  s_waitcnt lgkmcnt(4)
  v_smfmac_f32_16x16x64_bf16 v[70:73], v[38:41], v[30:37], v11
  ds_read_b128 v[30:33], v1 offset:16384
  ds_read_b128 v[34:37], v1 offset:17408
  v_mov_b32 v55, v54
  v_smfmac_f32_16x16x64_bf16 v[66:69], v[38:41], v[232:239], v11
  ds_read_b64_tr_b16 v[38:39], v2 offset:8192
  ds_read_b64_tr_b16 v[40:41], v2 offset:8704
  v_permlane32_swap_b32 v54, v55
  v_max_f32 v54, v54, v55
  v_mul_f32 v54, s76, v54
  s_waitcnt lgkmcnt(4)
  v_smfmac_f32_16x16x64_bf16 v[70:73], v[42:45], v[22:29], v11
  v_pk_fma_f32 v[50:51], v[50:51], s[76:77], v[54:55] op_sel_hi:[1,0,0] neg_lo:[0,0,1] neg_hi:[0,0,1]
  v_pk_fma_f32 v[52:53], v[52:53], s[76:77], v[54:55] op_sel_hi:[1,0,0] neg_lo:[0,0,1] neg_hi:[0,0,1]
  v_pk_fma_f32 v[74:75], v[74:75], s[76:77], v[54:55] op_sel_hi:[1,0,0] neg_lo:[0,0,1] neg_hi:[0,0,1]
  v_smfmac_f32_16x16x64_bf16 v[66:69], v[42:45], v[240:247], v11
  v_exp_f32 v50, v50
  v_exp_f32 v51, v51
  v_exp_f32 v52, v52
  v_exp_f32 v53, v53
  v_exp_f32 v74, v74
  v_exp_f32 v75, v75
  s_waitcnt lgkmcnt(0)
  v_smfmac_f32_16x16x64_bf16 v[70:73], v[38:41], v[30:37], v11
  v_mov_b64 v[62:63], v[60:61]
  v_cndmask_b32 v64, 0, v60, s[64:65]
  v_cndmask_b32 v65, 0, v60, s[64:65]
  v_smfmac_f32_16x16x64_bf16 v[66:69], v[38:41], v[248:255], v11
  v_cvt_pk_bf16_f32 v54, v50, v51
  v_cvt_pk_bf16_f32 v55, v52, v53
  v_cvt_pk_bf16_f32 v58, v74, v75
  v_mov_b32_dpp v56, v54 row_ror:8 row_mask:0xf bank_mask:0xf
  v_mov_b32_dpp v57, v55 row_ror:8 row_mask:0xf bank_mask:0xf
  v_mov_b32_dpp v59, v58 row_ror:8 row_mask:0xf bank_mask:0xf
  v_subrev_u32 v1, 73728, v1
  s_waitcnt vmcnt(2)
  v_mfma_f32_16x16x32_bf16 v[30:33], v[60:63], v[54:57], 0
  v_cvt_pk_bf16_f32 v78, v70, v71
  v_cvt_pk_bf16_f32 v79, v72, v73
  v_mfma_f32_16x16x32_bf16 v[22:25], v[14:17], v[54:57], 0
  v_cvt_pk_bf16_f32 v76, v66, v67
  v_cvt_pk_bf16_f32 v77, v68, v69
  v_mfma_f32_16x16x32_bf16 v[26:29], v[18:21], v[54:57], 0
  v_mfma_f32_16x16x16_bf16 v[30:33], v[64:65], v[58:59], v[30:33]
  v_mfma_f32_16x16x16_bf16 v[22:25], v[76:77], v[58:59], v[22:25]
  v_mfma_f32_16x16x16_bf16 v[26:29], v[78:79], v[58:59], v[26:29]
  s_cmp_eq_u32 s22, 63
  s_cbranch_scc1 CH_LAST
  s_nop 0
  v_lshrrev_b32 v67, 1, v0
  v_and_b32 v67, 0x180, v67
  v_and_b32 v66, 0xfffffc7f, v0
  v_or_b32 v67, v66, v67
  v_rcp_f32 v30, v30
  s_mov_b64 exec, s[62:63]
  v_pk_mul_f32 v[22:23], v[22:23], v[30:31] op_sel_hi:[1,0]
  v_pk_mul_f32 v[24:25], v[24:25], v[30:31] op_sel_hi:[1,0]
  v_pk_mul_f32 v[26:27], v[26:27], v[30:31] op_sel_hi:[1,0]
  v_pk_mul_f32 v[28:29], v[28:29], v[30:31] op_sel_hi:[1,0]
  v_cvt_pk_bf16_f32 v34, v22, v23
  v_cvt_pk_bf16_f32 v35, v24, v25
  v_cvt_pk_bf16_f32 v36, v26, v27
  v_cvt_pk_bf16_f32 v37, v28, v29
  ds_write_b64 v6, v[34:35]
  ds_write_b64 v6, v[36:37] offset:1024
  s_mov_b64 exec, -1
  v_mov_b64 v[38:39], 0
  v_mov_b64 v[40:41], 0
  v_mov_b64 v[42:43], 0
  v_mov_b64 v[44:45], 0
  v_mov_b64 v[46:47], 0
  s_waitcnt lgkmcnt(0)
  s_barrier
  ds_read_b128 v[30:33], v0 offset:5120
  ds_read_b128 v[34:37], v0 offset:6144
  ds_read_b128 v[14:17], v67 offset:5120
  ds_read_b128 v[18:21], v67 offset:5632
  ds_read_b128 v[22:25], v67 offset:6144
  ds_read_b128 v[26:29], v67 offset:6656
  v_mov_b64 v[48:49], 0
  v_mov_b64 v[50:51], 0
  v_mov_b64 v[52:53], 0
  v_mov_b64 v[54:55], 0
  v_mov_b64 v[56:57], 0
  s_nop 0
  s_waitcnt lgkmcnt(5)
  v_smfmac_f32_16x16x64_bf16 v[54:57], v[30:33], v[144:151], v11
  s_waitcnt lgkmcnt(4)
  v_smfmac_f32_16x16x64_bf16 v[54:57], v[34:37], v[216:223], v11
  s_waitcnt lgkmcnt(3)
  v_smfmac_f32_16x16x64_bf16 v[38:41], v[14:17], v[80:87], v11
  s_nop 0
  v_smfmac_f32_16x16x64_bf16 v[42:45], v[14:17], v[96:103], v11
  s_nop 0
  s_waitcnt lgkmcnt(2)
  v_smfmac_f32_16x16x64_bf16 v[38:41], v[18:21], v[88:95], v11
  s_nop 0
  v_smfmac_f32_16x16x64_bf16 v[42:45], v[18:21], v[104:111], v11
  v_permlane32_swap_b32 v54, v56
  s_waitcnt lgkmcnt(1)
  v_smfmac_f32_16x16x64_bf16 v[38:41], v[22:25], v[152:159], v11
  v_permlane32_swap_b32 v55, v57
  v_add_f32 v54, v54, v56
  v_smfmac_f32_16x16x64_bf16 v[42:45], v[22:25], v[168:175], v11
  v_add_f32 v55, v55, v57
  s_waitcnt lgkmcnt(0)
  v_smfmac_f32_16x16x64_bf16 v[38:41], v[26:29], v[160:167], v11
  v_cvt_pk_bf16_f32 v66, v54, v55
  v_and_or_b32 v66, v66, -2, s23
  v_smfmac_f32_16x16x64_bf16 v[42:45], v[26:29], v[176:183], v11
  buffer_store_dword v66, v8, s[8:11], s32 offen
  v_smfmac_f32_16x16x64_bf16 v[46:49], v[14:17], v[112:119], v11
  s_nop 2
  v_smfmac_f32_16x16x64_bf16 v[50:53], v[14:17], v[128:135], v11
  s_nop 2
  v_smfmac_f32_16x16x64_bf16 v[46:49], v[18:21], v[120:127], v11
  v_cvt_pk_bf16_f32 v58, v38, v39
  v_cvt_pk_bf16_f32 v59, v40, v41
  v_smfmac_f32_16x16x64_bf16 v[50:53], v[18:21], v[136:143], v11
  v_cvt_pk_bf16_f32 v60, v42, v43
  v_cvt_pk_bf16_f32 v61, v44, v45
  v_smfmac_f32_16x16x64_bf16 v[46:49], v[22:25], v[184:191], v11
  v_and_or_b32 v58, v58, -2, s23
  v_and_or_b32 v59, v59, -2, s23
  v_smfmac_f32_16x16x64_bf16 v[50:53], v[22:25], v[200:207], v11
  v_and_or_b32 v60, v60, -2, s23
  v_and_or_b32 v61, v61, -2, s23
  v_smfmac_f32_16x16x64_bf16 v[46:49], v[26:29], v[192:199], v11
  s_nop 0
  v_permlane16_swap_b32 v58, v60
  v_smfmac_f32_16x16x64_bf16 v[50:53], v[26:29], v[208:215], v11
  v_permlane16_swap_b32 v59, v61
  buffer_store_dwordx4 v[58:61], v7, s[8:11], s32 offen
  s_nop 4
  v_cvt_pk_bf16_f32 v62, v46, v47
  v_cvt_pk_bf16_f32 v63, v48, v49
  v_cvt_pk_bf16_f32 v64, v50, v51
  v_cvt_pk_bf16_f32 v65, v52, v53
  v_and_or_b32 v62, v62, -2, s23
  v_and_or_b32 v63, v63, -2, s23
  v_and_or_b32 v64, v64, -2, s23
  v_and_or_b32 v65, v65, -2, s23
  s_nop 0
  v_permlane16_swap_b32 v62, v64
  v_permlane16_swap_b32 v63, v65
  buffer_store_dwordx4 v[62:65], v7, s[8:11], s33 offen
  s_add_u32 s36, s36, 262144
  s_add_u32 s37, s37, 262144
  s_add_u32 s38, s38, 131072
  s_mov_b32 s82, s22
  s_add_u32 s22, s22, 1
  s_add_u32 s35, s35, 262144
  s_mov_b32 s79, 0
  s_cmp_eq_u32 s78, 0
  s_cbranch_scc1 NOREDF
  v_mov_b32 v34, 0x3f80
  v_mov_b32 v35, 0x3f800000
  v_cndmask_b32 v34, v34, v35, s[74:75]
  v_cndmask_b32 v30, 0, v34, s[66:67]
  v_cndmask_b32 v31, 0, v34, s[68:69]
  v_cndmask_b32 v32, 0, v34, s[70:71]
  v_cndmask_b32 v33, 0, v34, s[72:73]
  s_sleep 4
  buffer_load_dwordx4 v[38:41], v0, s[8:11], s31 offen offset:0 sc1
  buffer_load_dwordx4 v[42:45], v0, s[8:11], s31 offen offset:1024 sc1
  buffer_load_dwordx4 v[46:49], v0, s[8:11], s31 offen offset:2048 sc1
  buffer_load_dwordx4 v[50:53], v0, s[8:11], s31 offen offset:3072 sc1
  s_sleep 3
  buffer_load_dwordx4 v[54:57], v0, s[8:11], s31 offen offset:0 sc1
  buffer_load_dwordx4 v[58:61], v0, s[8:11], s31 offen offset:1024 sc1
  buffer_load_dwordx4 v[62:65], v0, s[8:11], s31 offen offset:2048 sc1
  buffer_load_dwordx4 v[66:69], v0, s[8:11], s31 offen offset:3072 sc1
POLLAF:
  s_waitcnt vmcnt(7)
  v_mfma_f32_16x16x32_bf16 v[34:37], v[30:33], v[38:41], 0
  v_xor_b32 v14, s23, v38
  v_bitop3_b32 v14, v14, v39, s23 bitop3:0xf6
  v_bitop3_b32 v14, v14, v40, s23 bitop3:0xf6
  v_bitop3_b32 v14, v14, v41, s23 bitop3:0xf6
  s_waitcnt vmcnt(6)
  v_mfma_f32_16x16x32_bf16 v[34:37], v[30:33], v[42:45], v[34:37]
  v_bitop3_b32 v14, v14, v42, s23 bitop3:0xf6
  v_bitop3_b32 v14, v14, v43, s23 bitop3:0xf6
  v_bitop3_b32 v14, v14, v44, s23 bitop3:0xf6
  v_bitop3_b32 v14, v14, v45, s23 bitop3:0xf6
  s_waitcnt vmcnt(5)
  v_mfma_f32_16x16x32_bf16 v[34:37], v[30:33], v[46:49], v[34:37]
  v_bitop3_b32 v14, v14, v46, s23 bitop3:0xf6
  v_bitop3_b32 v14, v14, v47, s23 bitop3:0xf6
  v_bitop3_b32 v14, v14, v48, s23 bitop3:0xf6
  v_bitop3_b32 v14, v14, v49, s23 bitop3:0xf6
  s_waitcnt vmcnt(4)
  v_mfma_f32_16x16x32_bf16 v[34:37], v[30:33], v[50:53], v[34:37]
  v_bitop3_b32 v14, v14, v50, s23 bitop3:0xf6
  v_bitop3_b32 v14, v14, v51, s23 bitop3:0xf6
  v_bitop3_b32 v14, v14, v52, s23 bitop3:0xf6
  v_bitop3_b32 v14, v14, v53, s23 bitop3:0xf6
  v_and_b32 v14, 1, v14
  v_cmp_ne_u32 vcc, 0, v14
  s_nop 0
  s_cbranch_vccz GOTAF
  buffer_load_dwordx4 v[38:41], v0, s[8:11], s31 offen offset:0 sc1
  buffer_load_dwordx4 v[42:45], v0, s[8:11], s31 offen offset:1024 sc1
  buffer_load_dwordx4 v[46:49], v0, s[8:11], s31 offen offset:2048 sc1
  buffer_load_dwordx4 v[50:53], v0, s[8:11], s31 offen offset:3072 sc1
  s_waitcnt vmcnt(7)
  v_mfma_f32_16x16x32_bf16 v[34:37], v[30:33], v[54:57], 0
  v_xor_b32 v14, s23, v54
  v_bitop3_b32 v14, v14, v55, s23 bitop3:0xf6
  v_bitop3_b32 v14, v14, v56, s23 bitop3:0xf6
  v_bitop3_b32 v14, v14, v57, s23 bitop3:0xf6
  s_waitcnt vmcnt(6)
  v_mfma_f32_16x16x32_bf16 v[34:37], v[30:33], v[58:61], v[34:37]
  v_bitop3_b32 v14, v14, v58, s23 bitop3:0xf6
  v_bitop3_b32 v14, v14, v59, s23 bitop3:0xf6
  v_bitop3_b32 v14, v14, v60, s23 bitop3:0xf6
  v_bitop3_b32 v14, v14, v61, s23 bitop3:0xf6
  s_waitcnt vmcnt(5)
  v_mfma_f32_16x16x32_bf16 v[34:37], v[30:33], v[62:65], v[34:37]
  v_bitop3_b32 v14, v14, v62, s23 bitop3:0xf6
  v_bitop3_b32 v14, v14, v63, s23 bitop3:0xf6
  v_bitop3_b32 v14, v14, v64, s23 bitop3:0xf6
  v_bitop3_b32 v14, v14, v65, s23 bitop3:0xf6
  s_waitcnt vmcnt(4)
  v_mfma_f32_16x16x32_bf16 v[34:37], v[30:33], v[66:69], v[34:37]
  v_bitop3_b32 v14, v14, v66, s23 bitop3:0xf6
  v_bitop3_b32 v14, v14, v67, s23 bitop3:0xf6
  v_bitop3_b32 v14, v14, v68, s23 bitop3:0xf6
  v_bitop3_b32 v14, v14, v69, s23 bitop3:0xf6
  v_and_b32 v14, 1, v14
  v_cmp_ne_u32 vcc, 0, v14
  s_nop 0
  s_cbranch_vccz GOTAF
  buffer_load_dwordx4 v[54:57], v0, s[8:11], s31 offen offset:0 sc1
  buffer_load_dwordx4 v[58:61], v0, s[8:11], s31 offen offset:1024 sc1
  buffer_load_dwordx4 v[62:65], v0, s[8:11], s31 offen offset:2048 sc1
  buffer_load_dwordx4 v[66:69], v0, s[8:11], s31 offen offset:3072 sc1
  s_add_u32 s79, s79, 1
  s_cmp_gt_u32 s79, 0x100000
  s_cbranch_scc1 CH_END
  s_branch POLLAF
GOTAF:
  v_add_f32_dpp v14, v34, v34 row_ror:8 row_mask:0xf bank_mask:0xf
  v_add_f32_dpp v15, v35, v35 row_ror:8 row_mask:0xf bank_mask:0xf
  v_add_f32_dpp v16, v36, v36 row_ror:8 row_mask:0xf bank_mask:0xf
  v_add_f32_dpp v17, v37, v37 row_ror:8 row_mask:0xf bank_mask:0xf
  v_cvt_pk_bf16_f32 v17, v16, v17
  v_cvt_pk_bf16_f32 v16, v14, v15
  v_and_or_b32 v16, v16, -2, s23
  s_mov_b64 exec, 0x00ff00ff
  buffer_store_dwordx2 v[16:17], v6, s[8:11], s30 offen
  s_mov_b64 exec, -1
  s_branch REDF
NOREDF:
  s_cmp_lt_u32 s20, 31
  s_cbranch_scc1 NOPFF
  s_mov_b32 s79, 0
RDY_4:
  s_add_u32 s28, s22, 2
  s_cmp_lt_u32 s28, s80
  s_cbranch_scc1 RDY_4_ok
  v_mbcnt_lo_u32_b32 v38, -1, 0
  v_lshlrev_b32 v38, 2, v38
  buffer_load_dword v38, v38, s[16:19], 0 offen offset:8 sc1
  s_add_u32 s79, s79, 1
  s_cmp_gt_u32 s79, 0x100000
  s_cbranch_scc1 CH_END
  s_waitcnt vmcnt(0)
  v_and_b32 v38, 0x200, v38
  v_cmp_ne_u32 vcc, 0, v38
  s_nop 1
  s_and_b32 s28, vcc_lo, 0xffff
  s_ff0_i32_b32 s28, s28
  s_lshl_b32 s80, s28, 2
  s_cmp_eq_u32 s28, 16
  s_cselect_b32 s80, 0x3e8, s80
  s_cmp_lg_u32 s80, 0
  s_cbranch_scc1 RDY_4
  s_sleep 24
  s_branch RDY_4
RDY_4_ok:
NOPFF:
  s_sleep 12
REDF:
  ds_read_b128 v[22:25], v1 offset:0
  ds_read_b128 v[26:29], v1 offset:1024
  ds_read_b128 v[30:33], v1 offset:2048
  ds_read_b128 v[34:37], v1 offset:3072
  s_sleep 3
  buffer_load_dwordx4 v[14:17], v9, s[8:11], s34 offen sc1
  buffer_load_dwordx4 v[18:21], v9, s[8:11], s34 offen offset:1024 sc1
  buffer_load_dwordx2 v[74:75], v10, s[8:11], s34 offen sc1
  s_waitcnt vmcnt(3)
  s_mov_b32 s79, 0
  v_mov_b64 v[44:45], v[76:77]
  v_mov_b64 v[46:47], v[78:79]
  v_mov_b32 v40, 17196032
  v_mov_b32 v41, 418816
  v_cndmask_b32 v40, v40, v41, s[84:85]
  v_and_b32 v39, 0xf0, v0
  v_lshl_add_u32 v39, v39, 3, v40
  v_mov_b64 v[50:51], 0
  v_mov_b64 v[52:53], 0
  v_mov_b64 v[54:55], 0
  v_mov_b64 v[56:57], 0
  v_mov_b64 v[58:59], 0
  v_mov_b64 v[60:61], 0
  v_mov_b64 v[62:63], 0
  v_mov_b64 v[64:65], 0
  s_sleep 2
  buffer_load_dwordx4 v[66:69], v9, s[8:11], s34 offen sc1
  buffer_load_dwordx4 v[70:73], v9, s[8:11], s34 offen offset:1024 sc1
  buffer_load_dwordx2 v[76:77], v10, s[8:11], s34 offen sc1
POLLBF:
  s_waitcnt vmcnt(3)
  v_xor_b32 v38, s23, v14
  v_bitop3_b32 v38, v38, v16, s23 bitop3:0xf6
  v_bitop3_b32 v38, v38, v18, s23 bitop3:0xf6
  v_bitop3_b32 v38, v38, v20, s23 bitop3:0xf6
  v_bitop3_b32 v38, v38, v74, s23 bitop3:0xf6
  v_and_b32 v38, 1, v38
  v_cmp_ne_u32 vcc, 0, v38
  s_nop 0
  s_cbranch_vccz GOTB1F
  buffer_load_dwordx4 v[14:17], v9, s[8:11], s34 offen sc1
  buffer_load_dwordx4 v[18:21], v9, s[8:11], s34 offen offset:1024 sc1
  buffer_load_dwordx2 v[74:75], v10, s[8:11], s34 offen sc1
  s_waitcnt vmcnt(3)
  v_xor_b32 v38, s23, v66
  v_bitop3_b32 v38, v38, v68, s23 bitop3:0xf6
  v_bitop3_b32 v38, v38, v70, s23 bitop3:0xf6
  v_bitop3_b32 v38, v38, v72, s23 bitop3:0xf6
  v_bitop3_b32 v38, v38, v76, s23 bitop3:0xf6
  v_and_b32 v38, 1, v38
  v_cmp_ne_u32 vcc, 0, v38
  s_nop 0
  s_cbranch_vccz GOTB2F
  buffer_load_dwordx4 v[66:69], v9, s[8:11], s34 offen sc1
  buffer_load_dwordx4 v[70:73], v9, s[8:11], s34 offen offset:1024 sc1
  buffer_load_dwordx2 v[76:77], v10, s[8:11], s34 offen sc1
  s_add_u32 s79, s79, 1
  s_cmp_gt_u32 s79, 0x100000
  s_cbranch_scc1 CH_END
  s_branch POLLBF
GOTB1F:
  ds_write_b128 v9, v[14:17]
  ds_write_b128 v9, v[18:21] offset:1024
  ds_write_b64 v10, v[74:75]
  s_branch GOTBF
GOTB2F:
  ds_write_b128 v9, v[66:69]
  ds_write_b128 v9, v[70:73] offset:1024
  ds_write_b64 v10, v[76:77]
GOTBF:
  s_xor_b32 s23, s23, 1
  s_waitcnt lgkmcnt(0)
  buffer_load_dwordx4 v[14:17], v0, s[8:11], s36 offen sc1
  buffer_load_dwordx4 v[18:21], v0, s[8:11], s36 offen offset:1024 sc1
  s_mov_b32 s83, 131072
  s_branch STEPF
CH_SLOW:
  v_mov_b32 v50, 0
  v_mov_b32 v51, 0
  v_mov_b32 v52, 0
  v_mov_b32 v53, 0
  v_mov_b32 v54, 0
  v_mov_b32 v55, 0
  v_mov_b32 v56, 0
  v_mov_b32 v57, 0
  v_mov_b32 v58, 0
  v_mov_b32 v59, 0
  v_mov_b32 v60, 0
  v_mov_b32 v61, 0
  v_mov_b32 v62, 0
  v_mov_b32 v63, 0
  v_mov_b32 v64, 0
  v_mov_b32 v65, 0
  v_mov_b32 v66, 0
  v_mov_b32 v67, 0
  v_mov_b32 v68, 0
  v_mov_b32 v69, 0
  v_mov_b32 v70, 0
  v_mov_b32 v71, 0
  v_mov_b32 v72, 0
  v_mov_b32 v73, 0
  ds_read_b128 v[22:25], v1 offset:0
  ds_read_b128 v[26:29], v1 offset:1024
  ds_read_b128 v[30:33], v1 offset:2048
  ds_read_b128 v[34:37], v1 offset:3072
  buffer_load_dwordx4 v[14:17], v0, s[8:11], s36 offen sc1
  buffer_load_dwordx4 v[18:21], v0, s[8:11], s36 offen offset:1024 sc1
  s_mov_b32 s83, 0
  s_mov_b32 s82, 0
  v_mov_b32 v40, 17196032
  v_mov_b32 v41, 418816
  v_cndmask_b32 v40, v40, v41, s[84:85]
  v_and_b32 v39, 0xf0, v0
  v_lshl_add_u32 v39, v39, 3, v40
  s_waitcnt lgkmcnt(0)
STEPS:
  s_barrier
  buffer_load_dword v39, s[8:11], s36 offen sc1 lds
  buffer_store_dwordx4 v[44:47], v0, s[8:11], s39 offen sc1
  s_add_u32 s39, s39, s83
  ds_read_b64_tr_b16 v[38:39], v2 offset:0
  ds_read_b64_tr_b16 v[40:41], v2 offset:512
  ds_read_b64_tr_b16 v[42:43], v2 offset:1024
  ds_read_b64_tr_b16 v[44:45], v2 offset:1536
  ds_read_b64_tr_b16 v[46:47], v2 offset:2048
  ds_read_b64_tr_b16 v[48:49], v2 offset:2560
  s_waitcnt lgkmcnt(4)
  v_smfmac_f32_16x16x64_bf16 v[50:53], v[38:41], a[0:7], v11
  v_smfmac_f32_16x16x64_bf16 v[54:57], v[38:41], a[72:79], v11
  v_smfmac_f32_16x16x64_bf16 v[58:61], v[38:41], a[144:151], v11
  v_smfmac_f32_16x16x64_bf16 v[62:65], v[38:41], v[22:29], v11
  s_waitcnt lgkmcnt(2)
  v_smfmac_f32_16x16x64_bf16 v[50:53], v[42:45], a[8:15], v11
  ds_read_b128 v[22:25], v1 offset:4096
  ds_read_b128 v[26:29], v1 offset:5120
  v_smfmac_f32_16x16x64_bf16 v[54:57], v[42:45], a[80:87], v11
  ds_read_b64_tr_b16 v[38:39], v2 offset:3072
  ds_read_b64_tr_b16 v[40:41], v2 offset:3584
  v_smfmac_f32_16x16x64_bf16 v[58:61], v[42:45], a[152:159], v11
  v_smfmac_f32_16x16x64_bf16 v[62:65], v[42:45], v[30:37], v11
  s_waitcnt lgkmcnt(4)
  v_smfmac_f32_16x16x64_bf16 v[50:53], v[46:49], a[16:23], v11
  ds_read_b128 v[30:33], v1 offset:6144
  ds_read_b128 v[34:37], v1 offset:7168
  v_smfmac_f32_16x16x64_bf16 v[54:57], v[46:49], a[88:95], v11
  ds_read_b64_tr_b16 v[42:43], v2 offset:4096
  ds_read_b64_tr_b16 v[44:45], v2 offset:4608
  v_smfmac_f32_16x16x64_bf16 v[58:61], v[46:49], a[160:167], v11
  s_waitcnt lgkmcnt(6)
  v_smfmac_f32_16x16x64_bf16 v[62:65], v[46:49], v[22:29], v11
  s_waitcnt lgkmcnt(4)
  v_smfmac_f32_16x16x64_bf16 v[50:53], v[38:41], a[24:31], v11
  ds_read_b128 v[22:25], v1 offset:8192
  ds_read_b128 v[26:29], v1 offset:9216
  v_smfmac_f32_16x16x64_bf16 v[54:57], v[38:41], a[96:103], v11
  ds_read_b64_tr_b16 v[46:47], v2 offset:5120
  ds_read_b64_tr_b16 v[48:49], v2 offset:5632
  v_smfmac_f32_16x16x64_bf16 v[58:61], v[38:41], a[168:175], v11
  s_waitcnt vmcnt(4)
  s_waitcnt lgkmcnt(6)
  v_smfmac_f32_16x16x64_bf16 v[62:65], v[38:41], v[30:37], v11
  v_mov_b64 v[66:67], 0
  s_waitcnt lgkmcnt(4)
  v_smfmac_f32_16x16x64_bf16 v[50:53], v[42:45], a[32:39], v11
  ds_read_b128 v[30:33], v1 offset:10240
  ds_read_b128 v[34:37], v1 offset:11264
  v_smfmac_f32_16x16x64_bf16 v[54:57], v[42:45], a[104:111], v11
  ds_read_b64_tr_b16 v[38:39], v2 offset:6144
  ds_read_b64_tr_b16 v[40:41], v2 offset:6656
  v_smfmac_f32_16x16x64_bf16 v[58:61], v[42:45], a[176:183], v11
  s_waitcnt lgkmcnt(6)
  v_smfmac_f32_16x16x64_bf16 v[62:65], v[42:45], v[22:29], v11
  v_mov_b64 v[68:69], 0
  s_waitcnt lgkmcnt(4)
  v_smfmac_f32_16x16x64_bf16 v[50:53], v[46:49], a[40:47], v11
  ds_read_b128 v[22:25], v1 offset:12288
  ds_read_b128 v[26:29], v1 offset:13312
  v_smfmac_f32_16x16x64_bf16 v[54:57], v[46:49], a[112:119], v11
  ds_read_b64_tr_b16 v[42:43], v2 offset:7168
  ds_read_b64_tr_b16 v[44:45], v2 offset:7680
  v_smfmac_f32_16x16x64_bf16 v[58:61], v[46:49], a[184:191], v11
  s_waitcnt lgkmcnt(6)
  v_smfmac_f32_16x16x64_bf16 v[62:65], v[46:49], v[30:37], v11
  v_mov_b64 v[70:71], 0
  s_waitcnt lgkmcnt(4)
  v_smfmac_f32_16x16x64_bf16 v[50:53], v[38:41], a[48:55], v11
  ds_read_b128 v[30:33], v1 offset:14336
  ds_read_b128 v[34:37], v1 offset:15360
  v_smfmac_f32_16x16x64_bf16 v[54:57], v[38:41], a[120:127], v11
  ds_read_b64_tr_b16 v[46:47], v2 offset:8192
  ds_read_b64_tr_b16 v[48:49], v2 offset:8704
  v_smfmac_f32_16x16x64_bf16 v[58:61], v[38:41], a[192:199], v11
  s_waitcnt lgkmcnt(6)
  v_smfmac_f32_16x16x64_bf16 v[62:65], v[38:41], v[22:29], v11
  v_mov_b64 v[72:73], 0
  s_waitcnt lgkmcnt(4)
  v_smfmac_f32_16x16x64_bf16 v[50:53], v[42:45], a[56:63], v11
  ds_read_b128 v[22:25], v1 offset:16384
  ds_read_b128 v[26:29], v1 offset:17408
  v_smfmac_f32_16x16x64_bf16 v[54:57], v[42:45], a[128:135], v11
  ds_read_b64_tr_b16 v[38:39], v2 offset:0
  ds_read_b64_tr_b16 v[40:41], v2 offset:512
  v_smfmac_f32_16x16x64_bf16 v[58:61], v[42:45], a[200:207], v11
  v_add_u32 v1, 73728, v1
  s_waitcnt lgkmcnt(6)
  v_smfmac_f32_16x16x64_bf16 v[62:65], v[42:45], v[30:37], v11
  s_waitcnt lgkmcnt(4)
  v_smfmac_f32_16x16x64_bf16 v[50:53], v[46:49], a[64:71], v11
  ds_read_b128 v[30:33], v1 offset:0
  ds_read_b128 v[34:37], v1 offset:1024
  v_smfmac_f32_16x16x64_bf16 v[54:57], v[46:49], a[136:143], v11
  ds_read_b64_tr_b16 v[42:43], v2 offset:1024
  ds_read_b64_tr_b16 v[44:45], v2 offset:1536
  v_smfmac_f32_16x16x64_bf16 v[58:61], v[46:49], a[208:215], v11
  s_waitcnt lgkmcnt(6)
  v_smfmac_f32_16x16x64_bf16 v[62:65], v[46:49], v[22:29], v11
  ds_read_b128 v[22:25], v1 offset:2048
  ds_read_b128 v[26:29], v1 offset:3072
  s_waitcnt lgkmcnt(4)
  v_smfmac_f32_16x16x64_bf16 v[70:73], v[38:41], v[30:37], v11
  ds_read_b128 v[30:33], v1 offset:4096
  ds_read_b128 v[34:37], v1 offset:5120
  v_smfmac_f32_16x16x64_bf16 v[66:69], v[38:41], a[216:223], v11
  ds_read_b64_tr_b16 v[38:39], v2 offset:2048
  ds_read_b64_tr_b16 v[40:41], v2 offset:2560
  s_nop 1
  v_cvt_pk_bf16_f32 v74, v50, v51
  v_cvt_pk_bf16_f32 v75, v52, v53
  v_cvt_pk_bf16_f32 v76, v54, v55
  v_cvt_pk_bf16_f32 v77, v56, v57
  v_cvt_pk_bf16_f32 v78, v58, v59
  v_cvt_pk_bf16_f32 v79, v60, v61
  v_cvt_pk_bf16_f32 v46, v62, v63
  v_cvt_pk_bf16_f32 v47, v64, v65
  v_mfma_f32_16x16x16_bf16 v[50:53], v[74:75], v[12:13], 0
  v_mfma_f32_16x16x16_bf16 v[54:57], v[76:77], v[12:13], 0
  v_mfma_f32_16x16x16_bf16 v[58:61], v[78:79], v[12:13], 0
  v_mfma_f32_16x16x16_bf16 v[62:65], v[46:47], v[12:13], 0
  s_waitcnt lgkmcnt(4)
  v_smfmac_f32_16x16x64_bf16 v[70:73], v[42:45], v[22:29], v11
  ds_read_b128 v[22:25], v1 offset:6144
  ds_read_b128 v[26:29], v1 offset:7168
  v_smfmac_f32_16x16x64_bf16 v[66:69], v[42:45], a[224:231], v11
  ds_read_b64_tr_b16 v[42:43], v2 offset:3072
  ds_read_b64_tr_b16 v[44:45], v2 offset:3584
  s_nop 0
  v_cvt_pk_bf16_f32 v74, v50, v51
  v_cvt_pk_bf16_f32 v75, v52, v53
  v_cvt_pk_bf16_f32 v76, v54, v55
  v_cvt_pk_bf16_f32 v77, v56, v57
  v_cvt_pk_bf16_f32 v46, v58, v59
  v_cvt_pk_bf16_f32 v47, v60, v61
  v_cvt_pk_bf16_f32 v48, v62, v63
  v_cvt_pk_bf16_f32 v49, v64, v65
  s_waitcnt vmcnt(2)
  v_mfma_f32_16x16x32_bf16 v[54:57], v[14:17], v[74:77], 0
  v_mfma_f32_16x16x32_bf16 v[58:61], v[18:21], v[74:77], 0
  v_mfma_f32_16x16x32_bf16 v[50:53], v[46:49], v[74:77], 0
  buffer_load_dwordx4 v[14:17], v0, s[8:11], s37 offen sc1
  buffer_load_dwordx4 v[18:21], v0, s[8:11], s37 offen offset:1024 sc1
  s_waitcnt lgkmcnt(4)
  v_smfmac_f32_16x16x64_bf16 v[70:73], v[38:41], v[30:37], v11
  ds_read_b128 v[30:33], v1 offset:8192
  ds_read_b128 v[34:37], v1 offset:9216
  v_smfmac_f32_16x16x64_bf16 v[66:69], v[38:41], a[232:239], v11
  ds_read_b64_tr_b16 v[38:39], v2 offset:4096
  ds_read_b64_tr_b16 v[40:41], v2 offset:4608
  v_cndmask_b32 v62, v54, v58, s[60:61]
  v_cndmask_b32 v63, v55, v59, s[60:61]
  v_cndmask_b32 v64, v56, v60, s[60:61]
  v_cndmask_b32 v65, v57, v61, s[60:61]
  v_cndmask_b32 v78, v50, v52, s[60:61]
  v_cndmask_b32 v79, v51, v53, s[60:61]
  ds_write_b128 v3, v[62:65]
  ds_write_b64 v5, v[78:79]
  buffer_store_dwordx4 v[46:49], v0, s[8:11], s38 offen sc1
  v_mov_b32 v54, s82
  s_mov_b64 exec, s[40:41]
  buffer_store_byte v54, off, s[8:11], s81 sc1
  s_mov_b64 exec, -1
  s_waitcnt lgkmcnt(6)
  v_smfmac_f32_16x16x64_bf16 v[70:73], v[42:45], v[22:29], v11
  ds_read_b128 v[22:25], v1 offset:10240
  ds_read_b128 v[26:29], v1 offset:11264
  v_smfmac_f32_16x16x64_bf16 v[66:69], v[42:45], a[240:247], v11
  ds_read_b64_tr_b16 v[42:43], v2 offset:5120
  ds_read_b64_tr_b16 v[44:45], v2 offset:5632
  s_waitcnt lgkmcnt(4)
  s_barrier
  ds_read_b128 v[50:53], v0 offset:0
  ds_read_b64 v[74:75], v4 offset:0
  ds_read_b128 v[54:57], v0 offset:1280
  ds_read_b64 v[76:77], v4 offset:1280
  ds_read_b128 v[58:61], v0 offset:2560
  ds_read_b64 v[78:79], v4 offset:2560
  ds_read_b128 v[62:65], v0 offset:3840
  ds_read_b64 v[46:47], v4 offset:3840
  s_waitcnt lgkmcnt(14)
  v_smfmac_f32_16x16x64_bf16 v[70:73], v[38:41], v[30:37], v11
  ds_read_b128 v[30:33], v1 offset:12288
  ds_read_b128 v[34:37], v1 offset:13312
  v_smfmac_f32_16x16x64_bf16 v[66:69], v[38:41], a[248:255], v11
  ds_read_b64_tr_b16 v[38:39], v2 offset:6144
  ds_read_b64_tr_b16 v[40:41], v2 offset:6656
  s_waitcnt lgkmcnt(8)
  v_pk_add_f32 v[50:51], v[50:51], v[54:55]
  v_pk_add_f32 v[52:53], v[52:53], v[56:57]
  v_pk_add_f32 v[74:75], v[74:75], v[76:77]
  s_waitcnt lgkmcnt(4)
  v_pk_add_f32 v[58:59], v[58:59], v[62:63]
  v_pk_add_f32 v[60:61], v[60:61], v[64:65]
  v_pk_add_f32 v[78:79], v[78:79], v[46:47]
  v_pk_add_f32 v[50:51], v[50:51], v[58:59]
  v_pk_add_f32 v[52:53], v[52:53], v[60:61]
  v_pk_add_f32 v[74:75], v[74:75], v[78:79]
  v_max3_f32 v54, v50, v51, v52
  v_max3_f32 v54, v54, v53, v74
  s_waitcnt lgkmcnt(12)
  v_smfmac_f32_16x16x64_bf16 v[70:73], v[42:45], v[22:29], v11
  ds_read_b128 v[22:25], v1 offset:14336
  ds_read_b128 v[26:29], v1 offset:15360
  v_max_f32 v54, v54, v75
  v_smfmac_f32_16x16x64_bf16 v[66:69], v[42:45], v[224:231], v11
  ds_read_b64_tr_b16 v[42:43], v2 offset:7168
  ds_read_b64_tr_b16 v[44:45], v2 offset:7680
  v_max_f32_dpp v54, v54, v54 row_ror:8 row_mask:0xf bank_mask:0xf
  v_mov_b32 v55, v54
  v_mov_b32 v60, s77
  v_mov_b32 v61, s77
  v_permlane16_swap_b32 v54, v55
  v_max_f32 v54, v54, v55
  s_waitcnt lgkmcnt(4)
  v_smfmac_f32_16x16x64_bf16 v[70:73], v[38:41], v[30:37], v11
  ds_read_b128 v[30:33], v1 offset:16384
  ds_read_b128 v[34:37], v1 offset:17408
  v_mov_b32 v55, v54
  v_smfmac_f32_16x16x64_bf16 v[66:69], v[38:41], v[232:239], v11
  ds_read_b64_tr_b16 v[38:39], v2 offset:8192
  ds_read_b64_tr_b16 v[40:41], v2 offset:8704
  v_permlane32_swap_b32 v54, v55
  v_max_f32 v54, v54, v55
  v_mul_f32 v54, s76, v54
  s_waitcnt lgkmcnt(4)
  v_smfmac_f32_16x16x64_bf16 v[70:73], v[42:45], v[22:29], v11
  v_pk_fma_f32 v[50:51], v[50:51], s[76:77], v[54:55] op_sel_hi:[1,0,0] neg_lo:[0,0,1] neg_hi:[0,0,1]
  v_pk_fma_f32 v[52:53], v[52:53], s[76:77], v[54:55] op_sel_hi:[1,0,0] neg_lo:[0,0,1] neg_hi:[0,0,1]
  v_pk_fma_f32 v[74:75], v[74:75], s[76:77], v[54:55] op_sel_hi:[1,0,0] neg_lo:[0,0,1] neg_hi:[0,0,1]
  v_smfmac_f32_16x16x64_bf16 v[66:69], v[42:45], v[240:247], v11
  v_exp_f32 v50, v50
  v_exp_f32 v51, v51
  v_exp_f32 v52, v52
  v_exp_f32 v53, v53
  v_exp_f32 v74, v74
  v_exp_f32 v75, v75
  s_waitcnt lgkmcnt(0)
  v_smfmac_f32_16x16x64_bf16 v[70:73], v[38:41], v[30:37], v11
  v_mov_b64 v[62:63], v[60:61]
  v_cndmask_b32 v64, 0, v60, s[64:65]
  v_cndmask_b32 v65, 0, v60, s[64:65]
  v_smfmac_f32_16x16x64_bf16 v[66:69], v[38:41], v[248:255], v11
  v_cvt_pk_bf16_f32 v54, v50, v51
  v_cvt_pk_bf16_f32 v55, v52, v53
  v_cvt_pk_bf16_f32 v58, v74, v75
  v_mov_b32_dpp v56, v54 row_ror:8 row_mask:0xf bank_mask:0xf
  v_mov_b32_dpp v57, v55 row_ror:8 row_mask:0xf bank_mask:0xf
  v_mov_b32_dpp v59, v58 row_ror:8 row_mask:0xf bank_mask:0xf
  v_subrev_u32 v1, 73728, v1
  s_waitcnt vmcnt(2)
  v_mfma_f32_16x16x32_bf16 v[30:33], v[60:63], v[54:57], 0
  v_cvt_pk_bf16_f32 v78, v70, v71
  v_cvt_pk_bf16_f32 v79, v72, v73
  v_mfma_f32_16x16x32_bf16 v[22:25], v[14:17], v[54:57], 0
  v_cvt_pk_bf16_f32 v76, v66, v67
  v_cvt_pk_bf16_f32 v77, v68, v69
  v_mfma_f32_16x16x32_bf16 v[26:29], v[18:21], v[54:57], 0
  v_mfma_f32_16x16x16_bf16 v[30:33], v[64:65], v[58:59], v[30:33]
  v_mfma_f32_16x16x16_bf16 v[22:25], v[76:77], v[58:59], v[22:25]
  v_mfma_f32_16x16x16_bf16 v[26:29], v[78:79], v[58:59], v[26:29]
  s_cmp_eq_u32 s22, 63
  s_cbranch_scc1 CH_LAST
  s_nop 0
  v_lshrrev_b32 v67, 1, v0
  v_and_b32 v67, 0x180, v67
  v_and_b32 v66, 0xfffffc7f, v0
  v_or_b32 v67, v66, v67
  v_rcp_f32 v30, v30
  s_mov_b64 exec, s[62:63]
  v_pk_mul_f32 v[22:23], v[22:23], v[30:31] op_sel_hi:[1,0]
  v_pk_mul_f32 v[24:25], v[24:25], v[30:31] op_sel_hi:[1,0]
  v_pk_mul_f32 v[26:27], v[26:27], v[30:31] op_sel_hi:[1,0]
  v_pk_mul_f32 v[28:29], v[28:29], v[30:31] op_sel_hi:[1,0]
  v_cvt_pk_bf16_f32 v34, v22, v23
  v_cvt_pk_bf16_f32 v35, v24, v25
  v_cvt_pk_bf16_f32 v36, v26, v27
  v_cvt_pk_bf16_f32 v37, v28, v29
  ds_write_b64 v6, v[34:35]
  ds_write_b64 v6, v[36:37] offset:1024
  s_mov_b64 exec, -1
  v_mov_b64 v[38:39], 0
  v_mov_b64 v[40:41], 0
  v_mov_b64 v[42:43], 0
  v_mov_b64 v[44:45], 0
  v_mov_b64 v[46:47], 0
  s_waitcnt lgkmcnt(0)
  s_barrier
  ds_read_b128 v[30:33], v0 offset:5120
  ds_read_b128 v[34:37], v0 offset:6144
  ds_read_b128 v[14:17], v67 offset:5120
  ds_read_b128 v[18:21], v67 offset:5632
  ds_read_b128 v[22:25], v67 offset:6144
  ds_read_b128 v[26:29], v67 offset:6656
  v_mov_b64 v[48:49], 0
  v_mov_b64 v[50:51], 0
  v_mov_b64 v[52:53], 0
  v_mov_b64 v[54:55], 0
  v_mov_b64 v[56:57], 0
  s_nop 0
  s_waitcnt lgkmcnt(5)
  v_smfmac_f32_16x16x64_bf16 v[54:57], v[30:33], v[144:151], v11
  s_waitcnt lgkmcnt(4)
  v_smfmac_f32_16x16x64_bf16 v[54:57], v[34:37], v[216:223], v11
  s_waitcnt lgkmcnt(3)
  v_smfmac_f32_16x16x64_bf16 v[38:41], v[14:17], v[80:87], v11
  s_nop 0
  v_smfmac_f32_16x16x64_bf16 v[42:45], v[14:17], v[96:103], v11
  s_nop 0
  s_waitcnt lgkmcnt(2)
  v_smfmac_f32_16x16x64_bf16 v[38:41], v[18:21], v[88:95], v11
  s_nop 0
  v_smfmac_f32_16x16x64_bf16 v[42:45], v[18:21], v[104:111], v11
  v_permlane32_swap_b32 v54, v56
  s_waitcnt lgkmcnt(1)
  v_smfmac_f32_16x16x64_bf16 v[38:41], v[22:25], v[152:159], v11
  v_permlane32_swap_b32 v55, v57
  v_add_f32 v54, v54, v56
  v_smfmac_f32_16x16x64_bf16 v[42:45], v[22:25], v[168:175], v11
  v_add_f32 v55, v55, v57
  s_waitcnt lgkmcnt(0)
  v_smfmac_f32_16x16x64_bf16 v[38:41], v[26:29], v[160:167], v11
  v_cvt_pk_bf16_f32 v66, v54, v55
  v_and_or_b32 v66, v66, -2, s23
  v_smfmac_f32_16x16x64_bf16 v[42:45], v[26:29], v[176:183], v11
  buffer_store_dword v66, v8, s[8:11], s32 offen sc1
  v_smfmac_f32_16x16x64_bf16 v[46:49], v[14:17], v[112:119], v11
  s_nop 2
  v_smfmac_f32_16x16x64_bf16 v[50:53], v[14:17], v[128:135], v11
  s_nop 2
  v_smfmac_f32_16x16x64_bf16 v[46:49], v[18:21], v[120:127], v11
  v_cvt_pk_bf16_f32 v58, v38, v39
  v_cvt_pk_bf16_f32 v59, v40, v41
  v_smfmac_f32_16x16x64_bf16 v[50:53], v[18:21], v[136:143], v11
  v_cvt_pk_bf16_f32 v60, v42, v43
  v_cvt_pk_bf16_f32 v61, v44, v45
  v_smfmac_f32_16x16x64_bf16 v[46:49], v[22:25], v[184:191], v11
  v_and_or_b32 v58, v58, -2, s23
  v_and_or_b32 v59, v59, -2, s23
  v_smfmac_f32_16x16x64_bf16 v[50:53], v[22:25], v[200:207], v11
  v_and_or_b32 v60, v60, -2, s23
  v_and_or_b32 v61, v61, -2, s23
  v_smfmac_f32_16x16x64_bf16 v[46:49], v[26:29], v[192:199], v11
  s_nop 0
  v_permlane16_swap_b32 v58, v60
  v_smfmac_f32_16x16x64_bf16 v[50:53], v[26:29], v[208:215], v11
  v_permlane16_swap_b32 v59, v61
  buffer_store_dwordx4 v[58:61], v7, s[8:11], s32 offen sc1
  s_nop 4
  v_cvt_pk_bf16_f32 v62, v46, v47
  v_cvt_pk_bf16_f32 v63, v48, v49
  v_cvt_pk_bf16_f32 v64, v50, v51
  v_cvt_pk_bf16_f32 v65, v52, v53
  v_and_or_b32 v62, v62, -2, s23
  v_and_or_b32 v63, v63, -2, s23
  v_and_or_b32 v64, v64, -2, s23
  v_and_or_b32 v65, v65, -2, s23
  s_nop 0
  v_permlane16_swap_b32 v62, v64
  v_permlane16_swap_b32 v63, v65
  buffer_store_dwordx4 v[62:65], v7, s[8:11], s33 offen sc1
  s_add_u32 s36, s36, 262144
  s_add_u32 s37, s37, 262144
  s_add_u32 s38, s38, 131072
  s_mov_b32 s82, s22
  s_add_u32 s22, s22, 1
  s_add_u32 s35, s35, 262144
  s_mov_b32 s79, 0
  s_cmp_eq_u32 s78, 0
  s_cbranch_scc1 NOREDS
  v_mov_b32 v34, 0x3f80
  v_mov_b32 v35, 0x3f800000
  v_cndmask_b32 v34, v34, v35, s[74:75]
  v_cndmask_b32 v30, 0, v34, s[66:67]
  v_cndmask_b32 v31, 0, v34, s[68:69]
  v_cndmask_b32 v32, 0, v34, s[70:71]
  v_cndmask_b32 v33, 0, v34, s[72:73]
  s_sleep 4
  buffer_load_dwordx4 v[38:41], v0, s[8:11], s31 offen offset:0 sc1
  buffer_load_dwordx4 v[42:45], v0, s[8:11], s31 offen offset:1024 sc1
  buffer_load_dwordx4 v[46:49], v0, s[8:11], s31 offen offset:2048 sc1
  buffer_load_dwordx4 v[50:53], v0, s[8:11], s31 offen offset:3072 sc1
  s_sleep 3
  buffer_load_dwordx4 v[54:57], v0, s[8:11], s31 offen offset:0 sc1
  buffer_load_dwordx4 v[58:61], v0, s[8:11], s31 offen offset:1024 sc1
  buffer_load_dwordx4 v[62:65], v0, s[8:11], s31 offen offset:2048 sc1
  buffer_load_dwordx4 v[66:69], v0, s[8:11], s31 offen offset:3072 sc1
POLLAS:
  s_waitcnt vmcnt(7)
  v_mfma_f32_16x16x32_bf16 v[34:37], v[30:33], v[38:41], 0
  v_xor_b32 v14, s23, v38
  v_bitop3_b32 v14, v14, v39, s23 bitop3:0xf6
  v_bitop3_b32 v14, v14, v40, s23 bitop3:0xf6
  v_bitop3_b32 v14, v14, v41, s23 bitop3:0xf6
  s_waitcnt vmcnt(6)
  v_mfma_f32_16x16x32_bf16 v[34:37], v[30:33], v[42:45], v[34:37]
  v_bitop3_b32 v14, v14, v42, s23 bitop3:0xf6
  v_bitop3_b32 v14, v14, v43, s23 bitop3:0xf6
  v_bitop3_b32 v14, v14, v44, s23 bitop3:0xf6
  v_bitop3_b32 v14, v14, v45, s23 bitop3:0xf6
  s_waitcnt vmcnt(5)
  v_mfma_f32_16x16x32_bf16 v[34:37], v[30:33], v[46:49], v[34:37]
  v_bitop3_b32 v14, v14, v46, s23 bitop3:0xf6
  v_bitop3_b32 v14, v14, v47, s23 bitop3:0xf6
  v_bitop3_b32 v14, v14, v48, s23 bitop3:0xf6
  v_bitop3_b32 v14, v14, v49, s23 bitop3:0xf6
  s_waitcnt vmcnt(4)
  v_mfma_f32_16x16x32_bf16 v[34:37], v[30:33], v[50:53], v[34:37]
  v_bitop3_b32 v14, v14, v50, s23 bitop3:0xf6
  v_bitop3_b32 v14, v14, v51, s23 bitop3:0xf6
  v_bitop3_b32 v14, v14, v52, s23 bitop3:0xf6
  v_bitop3_b32 v14, v14, v53, s23 bitop3:0xf6
  v_and_b32 v14, 1, v14
  v_cmp_ne_u32 vcc, 0, v14
  s_nop 0
  s_cbranch_vccz GOTAS
  buffer_load_dwordx4 v[38:41], v0, s[8:11], s31 offen offset:0 sc1
  buffer_load_dwordx4 v[42:45], v0, s[8:11], s31 offen offset:1024 sc1
  buffer_load_dwordx4 v[46:49], v0, s[8:11], s31 offen offset:2048 sc1
  buffer_load_dwordx4 v[50:53], v0, s[8:11], s31 offen offset:3072 sc1
  s_waitcnt vmcnt(7)
  v_mfma_f32_16x16x32_bf16 v[34:37], v[30:33], v[54:57], 0
  v_xor_b32 v14, s23, v54
  v_bitop3_b32 v14, v14, v55, s23 bitop3:0xf6
  v_bitop3_b32 v14, v14, v56, s23 bitop3:0xf6
  v_bitop3_b32 v14, v14, v57, s23 bitop3:0xf6
  s_waitcnt vmcnt(6)
  v_mfma_f32_16x16x32_bf16 v[34:37], v[30:33], v[58:61], v[34:37]
  v_bitop3_b32 v14, v14, v58, s23 bitop3:0xf6
  v_bitop3_b32 v14, v14, v59, s23 bitop3:0xf6
  v_bitop3_b32 v14, v14, v60, s23 bitop3:0xf6
  v_bitop3_b32 v14, v14, v61, s23 bitop3:0xf6
  s_waitcnt vmcnt(5)
  v_mfma_f32_16x16x32_bf16 v[34:37], v[30:33], v[62:65], v[34:37]
  v_bitop3_b32 v14, v14, v62, s23 bitop3:0xf6
  v_bitop3_b32 v14, v14, v63, s23 bitop3:0xf6
  v_bitop3_b32 v14, v14, v64, s23 bitop3:0xf6
  v_bitop3_b32 v14, v14, v65, s23 bitop3:0xf6
  s_waitcnt vmcnt(4)
  v_mfma_f32_16x16x32_bf16 v[34:37], v[30:33], v[66:69], v[34:37]
  v_bitop3_b32 v14, v14, v66, s23 bitop3:0xf6
  v_bitop3_b32 v14, v14, v67, s23 bitop3:0xf6
  v_bitop3_b32 v14, v14, v68, s23 bitop3:0xf6
  v_bitop3_b32 v14, v14, v69, s23 bitop3:0xf6
  v_and_b32 v14, 1, v14
  v_cmp_ne_u32 vcc, 0, v14
  s_nop 0
  s_cbranch_vccz GOTAS
  buffer_load_dwordx4 v[54:57], v0, s[8:11], s31 offen offset:0 sc1
  buffer_load_dwordx4 v[58:61], v0, s[8:11], s31 offen offset:1024 sc1
  buffer_load_dwordx4 v[62:65], v0, s[8:11], s31 offen offset:2048 sc1
  buffer_load_dwordx4 v[66:69], v0, s[8:11], s31 offen offset:3072 sc1
  s_add_u32 s79, s79, 1
  s_cmp_gt_u32 s79, 0x100000
  s_cbranch_scc1 CH_END
  s_branch POLLAS
GOTAS:
  v_add_f32_dpp v14, v34, v34 row_ror:8 row_mask:0xf bank_mask:0xf
  v_add_f32_dpp v15, v35, v35 row_ror:8 row_mask:0xf bank_mask:0xf
  v_add_f32_dpp v16, v36, v36 row_ror:8 row_mask:0xf bank_mask:0xf
  v_add_f32_dpp v17, v37, v37 row_ror:8 row_mask:0xf bank_mask:0xf
  v_cvt_pk_bf16_f32 v17, v16, v17
  v_cvt_pk_bf16_f32 v16, v14, v15
  v_and_or_b32 v16, v16, -2, s23
  s_mov_b64 exec, 0x00ff00ff
  buffer_store_dwordx2 v[16:17], v6, s[8:11], s30 offen sc1
  s_mov_b64 exec, -1
  s_branch REDS
NOREDS:
  s_cmp_lt_u32 s20, 31
  s_cbranch_scc1 NOPFS
  s_mov_b32 s79, 0
RDY_5:
  s_add_u32 s28, s22, 2
  s_cmp_lt_u32 s28, s80
  s_cbranch_scc1 RDY_5_ok
  v_mbcnt_lo_u32_b32 v38, -1, 0
  v_lshlrev_b32 v38, 2, v38
  buffer_load_dword v38, v38, s[16:19], 0 offen offset:8 sc1
  s_add_u32 s79, s79, 1
  s_cmp_gt_u32 s79, 0x100000
  s_cbranch_scc1 CH_END
  s_waitcnt vmcnt(0)
  v_and_b32 v38, 0x200, v38
  v_cmp_ne_u32 vcc, 0, v38
  s_nop 1
  s_and_b32 s28, vcc_lo, 0xffff
  s_ff0_i32_b32 s28, s28
  s_lshl_b32 s80, s28, 2
  s_cmp_eq_u32 s28, 16
  s_cselect_b32 s80, 0x3e8, s80
  s_cmp_lg_u32 s80, 0
  s_cbranch_scc1 RDY_5
  s_sleep 24
  s_branch RDY_5
RDY_5_ok:
NOPFS:
  s_sleep 12
REDS:
  ds_read_b128 v[22:25], v1 offset:0
  ds_read_b128 v[26:29], v1 offset:1024
  ds_read_b128 v[30:33], v1 offset:2048
  ds_read_b128 v[34:37], v1 offset:3072
  s_sleep 3
  buffer_load_dwordx4 v[14:17], v9, s[8:11], s34 offen sc1
  buffer_load_dwordx4 v[18:21], v9, s[8:11], s34 offen offset:1024 sc1
  buffer_load_dwordx2 v[74:75], v10, s[8:11], s34 offen sc1
  s_waitcnt vmcnt(3)
  s_mov_b32 s79, 0
  v_mov_b64 v[44:45], v[76:77]
  v_mov_b64 v[46:47], v[78:79]
  v_mov_b32 v40, 17196032
  v_mov_b32 v41, 418816
  v_cndmask_b32 v40, v40, v41, s[84:85]
  v_and_b32 v39, 0xf0, v0
  v_lshl_add_u32 v39, v39, 3, v40
  v_mov_b64 v[50:51], 0
  v_mov_b64 v[52:53], 0
  v_mov_b64 v[54:55], 0
  v_mov_b64 v[56:57], 0
  v_mov_b64 v[58:59], 0
  v_mov_b64 v[60:61], 0
  v_mov_b64 v[62:63], 0
  v_mov_b64 v[64:65], 0
  s_sleep 2
  buffer_load_dwordx4 v[66:69], v9, s[8:11], s34 offen sc1
  buffer_load_dwordx4 v[70:73], v9, s[8:11], s34 offen offset:1024 sc1
  buffer_load_dwordx2 v[76:77], v10, s[8:11], s34 offen sc1
POLLBS:
  s_waitcnt vmcnt(3)
  v_xor_b32 v38, s23, v14
  v_bitop3_b32 v38, v38, v16, s23 bitop3:0xf6
  v_bitop3_b32 v38, v38, v18, s23 bitop3:0xf6
  v_bitop3_b32 v38, v38, v20, s23 bitop3:0xf6
  v_bitop3_b32 v38, v38, v74, s23 bitop3:0xf6
  v_and_b32 v38, 1, v38
  v_cmp_ne_u32 vcc, 0, v38
  s_nop 0
  s_cbranch_vccz GOTB1S
  buffer_load_dwordx4 v[14:17], v9, s[8:11], s34 offen sc1
  buffer_load_dwordx4 v[18:21], v9, s[8:11], s34 offen offset:1024 sc1
  buffer_load_dwordx2 v[74:75], v10, s[8:11], s34 offen sc1
  s_waitcnt vmcnt(3)
  v_xor_b32 v38, s23, v66
  v_bitop3_b32 v38, v38, v68, s23 bitop3:0xf6
  v_bitop3_b32 v38, v38, v70, s23 bitop3:0xf6
  v_bitop3_b32 v38, v38, v72, s23 bitop3:0xf6
  v_bitop3_b32 v38, v38, v76, s23 bitop3:0xf6
  v_and_b32 v38, 1, v38
  v_cmp_ne_u32 vcc, 0, v38
  s_nop 0
  s_cbranch_vccz GOTB2S
  buffer_load_dwordx4 v[66:69], v9, s[8:11], s34 offen sc1
  buffer_load_dwordx4 v[70:73], v9, s[8:11], s34 offen offset:1024 sc1
  buffer_load_dwordx2 v[76:77], v10, s[8:11], s34 offen sc1
  s_add_u32 s79, s79, 1
  s_cmp_gt_u32 s79, 0x100000
  s_cbranch_scc1 CH_END
  s_branch POLLBS
GOTB1S:
  ds_write_b128 v9, v[14:17]
  ds_write_b128 v9, v[18:21] offset:1024
  ds_write_b64 v10, v[74:75]
  s_branch GOTBS
GOTB2S:
  ds_write_b128 v9, v[66:69]
  ds_write_b128 v9, v[70:73] offset:1024
  ds_write_b64 v10, v[76:77]
GOTBS:
  s_xor_b32 s23, s23, 1
  s_waitcnt lgkmcnt(0)
  buffer_load_dwordx4 v[14:17], v0, s[8:11], s36 offen sc1
  buffer_load_dwordx4 v[18:21], v0, s[8:11], s36 offen offset:1024 sc1
  s_mov_b32 s83, 131072
  s_branch STEPS
CH_LAST:
  buffer_store_dwordx4 v[76:79], v0, s[8:11], s39 offen sc1
CH_END:
  s_waitcnt vmcnt(0)
  s_barrier
  v_mov_b32 v14, s22
  v_add_u32 v14, 1, v14
  buffer_store_byte v14, off, s[8:11], s81 sc1
CHW:
  s_mov_b32 s5, 252
  s_cmp_lg_u32 s21, 0
  s_cbranch_scc1 W_7_ok
  s_mov_b32 s79, 0
W_7:
  buffer_load_dword v251, off, s[16:19], s5 offset:0 sc1
  s_add_u32 s79, s79, 1
  s_cmp_gt_u32 s79, 0x40000
  s_cbranch_scc1 BG_END
  s_waitcnt vmcnt(0)
  v_readfirstlane_b32 s78, v251
  s_bfe_u32 s78, s78, 0x80000
  s_cmp_eq_u32 s78, 120
  s_cbranch_scc1 W_7_ok
  s_sleep 8
  s_branch W_7
W_7_ok:
  s_barrier
  v_mbcnt_lo_u32_b32 v0, -1, 0
  v_mbcnt_hi_u32_b32 v0, -1, v0
  s_lshr_b32 s82, s2, 5
  s_lshl_b32 s82, s82, 1
  s_and_b32 s44, s2, 1
  s_add_u32 s82, s82, s44
  s_bfe_u32 s83, s2, 0x20003
  s_bfe_u32 s84, s2, 0x20001
  s_lshl_b32 s44, s82, 2
  s_add_u32 s44, s44, s21
  s_mul_i32 s44, s44, 294912
  s_mul_i32 s45, s84, 36864
  s_add_u32 s44, s44, s45
  s_add_u32 s44, s44, 184549376
  v_lshlrev_b32 v252, 4, v0
  v_add_u32 v253, 147456, v252
  buffer_load_dwordx4 a[0:3], v252, s[8:11], s44 offen offset:0 sc1
  buffer_load_dwordx4 a[4:7], v253, s[8:11], s44 offen offset:0 sc1
  buffer_load_dwordx4 a[8:11], v252, s[8:11], s44 offen offset:1024 sc1
  buffer_load_dwordx4 a[12:15], v253, s[8:11], s44 offen offset:1024 sc1
  buffer_load_dwordx4 a[16:19], v252, s[8:11], s44 offen offset:2048 sc1
  buffer_load_dwordx4 a[20:23], v253, s[8:11], s44 offen offset:2048 sc1
  buffer_load_dwordx4 a[24:27], v252, s[8:11], s44 offen offset:3072 sc1
  buffer_load_dwordx4 a[28:31], v253, s[8:11], s44 offen offset:3072 sc1
  s_add_u32 s44, s44, 4096
  buffer_load_dwordx4 a[32:35], v252, s[8:11], s44 offen offset:0 sc1
  buffer_load_dwordx4 a[36:39], v253, s[8:11], s44 offen offset:0 sc1
  buffer_load_dwordx4 a[40:43], v252, s[8:11], s44 offen offset:1024 sc1
  buffer_load_dwordx4 a[44:47], v253, s[8:11], s44 offen offset:1024 sc1
  buffer_load_dwordx4 a[48:51], v252, s[8:11], s44 offen offset:2048 sc1
  buffer_load_dwordx4 a[52:55], v253, s[8:11], s44 offen offset:2048 sc1
  buffer_load_dwordx4 a[56:59], v252, s[8:11], s44 offen offset:3072 sc1
  buffer_load_dwordx4 a[60:63], v253, s[8:11], s44 offen offset:3072 sc1
  s_add_u32 s44, s44, 4096
  buffer_load_dwordx4 a[64:67], v252, s[8:11], s44 offen offset:0 sc1
  buffer_load_dwordx4 a[68:71], v253, s[8:11], s44 offen offset:0 sc1
  buffer_load_dwordx4 a[72:75], v252, s[8:11], s44 offen offset:1024 sc1
  buffer_load_dwordx4 a[76:79], v253, s[8:11], s44 offen offset:1024 sc1
  buffer_load_dwordx4 a[80:83], v252, s[8:11], s44 offen offset:2048 sc1
  buffer_load_dwordx4 a[84:87], v253, s[8:11], s44 offen offset:2048 sc1
  buffer_load_dwordx4 a[88:91], v252, s[8:11], s44 offen offset:3072 sc1
  buffer_load_dwordx4 a[92:95], v253, s[8:11], s44 offen offset:3072 sc1
  s_add_u32 s44, s44, 4096
  buffer_load_dwordx4 a[96:99], v252, s[8:11], s44 offen offset:0 sc1
  buffer_load_dwordx4 a[100:103], v253, s[8:11], s44 offen offset:0 sc1
  buffer_load_dwordx4 a[104:107], v252, s[8:11], s44 offen offset:1024 sc1
  buffer_load_dwordx4 a[108:111], v253, s[8:11], s44 offen offset:1024 sc1
  buffer_load_dwordx4 a[112:115], v252, s[8:11], s44 offen offset:2048 sc1
  buffer_load_dwordx4 a[116:119], v253, s[8:11], s44 offen offset:2048 sc1
  buffer_load_dwordx4 a[120:123], v252, s[8:11], s44 offen offset:3072 sc1
  buffer_load_dwordx4 a[124:127], v253, s[8:11], s44 offen offset:3072 sc1
  s_add_u32 s44, s44, 4096
  buffer_load_dwordx4 a[128:131], v252, s[8:11], s44 offen offset:0 sc1
  buffer_load_dwordx4 a[132:135], v253, s[8:11], s44 offen offset:0 sc1
  buffer_load_dwordx4 a[136:139], v252, s[8:11], s44 offen offset:1024 sc1
  buffer_load_dwordx4 a[140:143], v253, s[8:11], s44 offen offset:1024 sc1
  buffer_load_dwordx4 a[144:147], v252, s[8:11], s44 offen offset:2048 sc1
  buffer_load_dwordx4 a[148:151], v253, s[8:11], s44 offen offset:2048 sc1
  buffer_load_dwordx4 a[152:155], v252, s[8:11], s44 offen offset:3072 sc1
  buffer_load_dwordx4 a[156:159], v253, s[8:11], s44 offen offset:3072 sc1
  s_add_u32 s44, s44, 4096
  buffer_load_dwordx4 a[160:163], v252, s[8:11], s44 offen offset:0 sc1
  buffer_load_dwordx4 a[164:167], v253, s[8:11], s44 offen offset:0 sc1
  buffer_load_dwordx4 a[168:171], v252, s[8:11], s44 offen offset:1024 sc1
  buffer_load_dwordx4 a[172:175], v253, s[8:11], s44 offen offset:1024 sc1
  buffer_load_dwordx4 a[176:179], v252, s[8:11], s44 offen offset:2048 sc1
  buffer_load_dwordx4 a[180:183], v253, s[8:11], s44 offen offset:2048 sc1
  buffer_load_dwordx4 a[184:187], v252, s[8:11], s44 offen offset:3072 sc1
  buffer_load_dwordx4 a[188:191], v253, s[8:11], s44 offen offset:3072 sc1
  s_add_u32 s44, s44, 4096
  buffer_load_dwordx4 a[240:243], v252, s[8:11], s44 offen offset:0 sc1
  buffer_load_dwordx4 a[244:247], v253, s[8:11], s44 offen offset:0 sc1
  buffer_load_dwordx4 a[248:251], v252, s[8:11], s44 offen offset:1024 sc1
  buffer_load_dwordx4 a[252:255], v253, s[8:11], s44 offen offset:1024 sc1
  buffer_load_dwordx4 v[96:99], v252, s[8:11], s44 offen offset:2048 sc1
  buffer_load_dwordx4 v[100:103], v253, s[8:11], s44 offen offset:2048 sc1
  buffer_load_dwordx4 v[104:107], v252, s[8:11], s44 offen offset:3072 sc1
  buffer_load_dwordx4 v[108:111], v253, s[8:11], s44 offen offset:3072 sc1
  s_add_u32 s44, s44, 4096
  buffer_load_dwordx4 v[112:115], v252, s[8:11], s44 offen offset:0 sc1
  buffer_load_dwordx4 v[116:119], v253, s[8:11], s44 offen offset:0 sc1
  buffer_load_dwordx4 v[120:123], v252, s[8:11], s44 offen offset:1024 sc1
  buffer_load_dwordx4 v[124:127], v253, s[8:11], s44 offen offset:1024 sc1
  buffer_load_dwordx4 v[128:131], v252, s[8:11], s44 offen offset:2048 sc1
  buffer_load_dwordx4 v[132:135], v253, s[8:11], s44 offen offset:2048 sc1
  buffer_load_dwordx4 v[136:139], v252, s[8:11], s44 offen offset:3072 sc1
  buffer_load_dwordx4 v[140:143], v253, s[8:11], s44 offen offset:3072 sc1
  s_add_u32 s44, s44, 4096
  buffer_load_dwordx4 v[144:147], v252, s[8:11], s44 offen offset:0 sc1
  buffer_load_dwordx4 v[148:151], v253, s[8:11], s44 offen offset:0 sc1
  buffer_load_dwordx4 v[152:155], v252, s[8:11], s44 offen offset:1024 sc1
  buffer_load_dwordx4 v[156:159], v253, s[8:11], s44 offen offset:1024 sc1
  buffer_load_dwordx4 v[160:163], v252, s[8:11], s44 offen offset:2048 sc1
  buffer_load_dwordx4 v[164:167], v253, s[8:11], s44 offen offset:2048 sc1
  buffer_load_dwordx4 v[168:171], v252, s[8:11], s44 offen offset:3072 sc1
  buffer_load_dwordx4 v[172:175], v253, s[8:11], s44 offen offset:3072 sc1
  s_add_u32 s44, s44, 4096
  s_branch DOF
K1E:
  s_endpgm
BG:
  v_lshrrev_b32 v1, 6, v0
  v_and_b32 v0, 63, v0
  s_load_dwordx4 s[52:55], s[0:1], 104
  v_readfirstlane_b32 s21, v1
  s_waitcnt lgkmcnt(0)
  s_mov_b32 s8, s54
  s_mov_b32 s9, s55
  s_mov_b32 s10, 268435456
  s_mov_b32 s11, 0x00020000
  s_mov_b32 s16, s52
  s_mov_b32 s17, s53
  s_mov_b32 s18, 256
  s_mov_b32 s19, 0x00020000
  s_sub_u32 s3, s3, 1
  s_lshr_b32 s4, s2, 3
  s_lshl_b32 s76, s3, 5
  s_add_u32 s76, s76, s4
  s_mul_i32 s77, s4, 7
  s_add_u32 s77, s77, s3
  s_mul_i32 s5, s76, 293
  s_lshr_b32 s5, s5, 11
  s_mul_i32 s6, s5, 7
  s_sub_u32 s6, s76, s6
  s_cmp_ge_u32 s77, 128
  s_cbranch_scc1 NOLN0
  s_mov_b32 s20, s77
  s_lshl_b32 s44, s20, 4
  s_lshl_b32 s45, s21, 2
  s_add_u32 s44, s44, s45
  v_lshrrev_b32 v1, 4, v0
  v_add_u32 v2, s44, v1
  v_mul_u32_u24 v2, 1152, v2
  v_and_b32 v3, 15, v0
  v_lshl_add_u32 v2, v3, 3, v2
  s_load_dwordx2 s[12:13], s[0:1], 0
  s_mov_b32 s14, 2359296
  s_mov_b32 s15, 0x00020000
  v_bfe_u32 v3, v0, 3, 1
  v_mul_u32_u24 v3, 1024, v3
  v_bfe_u32 v4, v0, 2, 1
  v_mul_u32_u24 v4, 8, v4
  v_add_u32 v3, v3, v4
  v_bfe_u32 v4, v0, 0, 2
  v_mul_u32_u24 v4, 256, v4
  v_add_u32 v3, v3, v4
  v_bfe_u32 v4, v0, 4, 2
  v_mul_u32_u24 v4, 16, v4
  v_add_u32 v3, v3, v4
  s_mul_i32 s44, s20, 18432
  s_lshl_b32 s45, s21, 6
  s_add_u32 s45, s45, s44
  s_add_u32 s45, s45, 0
  s_waitcnt lgkmcnt(0)
  buffer_load_dwordx2 v[10:11], v2, s[12:15], 0 offen offset:0
  buffer_load_dwordx2 v[12:13], v2, s[12:15], 0 offen offset:128
  buffer_load_dwordx2 v[14:15], v2, s[12:15], 0 offen offset:256
  buffer_load_dwordx2 v[16:17], v2, s[12:15], 0 offen offset:384
  buffer_load_dwordx2 v[18:19], v2, s[12:15], 0 offen offset:512
  buffer_load_dwordx2 v[20:21], v2, s[12:15], 0 offen offset:640
  buffer_load_dwordx2 v[22:23], v2, s[12:15], 0 offen offset:768
  buffer_load_dwordx2 v[24:25], v2, s[12:15], 0 offen offset:896
  buffer_load_dwordx2 v[26:27], v2, s[12:15], 0 offen offset:1024
  s_mov_b32 s46, 0x3ae38e39
  s_mov_b32 s47, 0x3727c5ac
  s_waitcnt vmcnt(8)
  v_lshlrev_b32 v30, 16, v10
  v_and_b32 v31, 0xffff0000, v10
  v_lshlrev_b32 v32, 16, v11
  v_and_b32 v33, 0xffff0000, v11
  v_pk_add_f32 v[4:5], v[30:31], v[32:33]
  s_waitcnt vmcnt(7)
  v_lshlrev_b32 v34, 16, v12
  v_and_b32 v35, 0xffff0000, v12
  v_pk_add_f32 v[4:5], v[4:5], v[34:35]
  v_lshlrev_b32 v36, 16, v13
  v_and_b32 v37, 0xffff0000, v13
  v_pk_add_f32 v[4:5], v[4:5], v[36:37]
  s_waitcnt vmcnt(6)
  v_lshlrev_b32 v38, 16, v14
  v_and_b32 v39, 0xffff0000, v14
  v_pk_add_f32 v[4:5], v[4:5], v[38:39]
  v_lshlrev_b32 v40, 16, v15
  v_and_b32 v41, 0xffff0000, v15
  v_pk_add_f32 v[4:5], v[4:5], v[40:41]
  s_waitcnt vmcnt(5)
  v_lshlrev_b32 v42, 16, v16
  v_and_b32 v43, 0xffff0000, v16
  v_pk_add_f32 v[4:5], v[4:5], v[42:43]
  v_lshlrev_b32 v44, 16, v17
  v_and_b32 v45, 0xffff0000, v17
  v_pk_add_f32 v[4:5], v[4:5], v[44:45]
  s_waitcnt vmcnt(4)
  v_lshlrev_b32 v46, 16, v18
  v_and_b32 v47, 0xffff0000, v18
  v_pk_add_f32 v[4:5], v[4:5], v[46:47]
  v_lshlrev_b32 v48, 16, v19
  v_and_b32 v49, 0xffff0000, v19
  v_pk_add_f32 v[4:5], v[4:5], v[48:49]
  s_waitcnt vmcnt(3)
  v_lshlrev_b32 v50, 16, v20
  v_and_b32 v51, 0xffff0000, v20
  v_pk_add_f32 v[4:5], v[4:5], v[50:51]
  v_lshlrev_b32 v52, 16, v21
  v_and_b32 v53, 0xffff0000, v21
  v_pk_add_f32 v[4:5], v[4:5], v[52:53]
  s_waitcnt vmcnt(2)
  v_lshlrev_b32 v54, 16, v22
  v_and_b32 v55, 0xffff0000, v22
  v_pk_add_f32 v[4:5], v[4:5], v[54:55]
  v_lshlrev_b32 v56, 16, v23
  v_and_b32 v57, 0xffff0000, v23
  v_pk_add_f32 v[4:5], v[4:5], v[56:57]
  s_waitcnt vmcnt(1)
  v_lshlrev_b32 v58, 16, v24
  v_and_b32 v59, 0xffff0000, v24
  v_pk_add_f32 v[4:5], v[4:5], v[58:59]
  v_lshlrev_b32 v60, 16, v25
  v_and_b32 v61, 0xffff0000, v25
  v_pk_add_f32 v[4:5], v[4:5], v[60:61]
  s_waitcnt vmcnt(0)
  v_lshlrev_b32 v62, 16, v26
  v_and_b32 v63, 0xffff0000, v26
  v_pk_add_f32 v[4:5], v[4:5], v[62:63]
  v_lshlrev_b32 v64, 16, v27
  v_and_b32 v65, 0xffff0000, v27
  v_pk_add_f32 v[4:5], v[4:5], v[64:65]
  v_add_f32 v4, v4, v5
  s_nop 1
  v_add_f32_dpp v4, v4, v4 row_ror:8 row_mask:0xf bank_mask:0xf
  s_nop 1
  v_add_f32_dpp v4, v4, v4 row_ror:4 row_mask:0xf bank_mask:0xf
  s_nop 1
  v_add_f32_dpp v4, v4, v4 row_ror:2 row_mask:0xf bank_mask:0xf
  s_nop 1
  v_add_f32_dpp v4, v4, v4 row_ror:1 row_mask:0xf bank_mask:0xf
  v_mul_f32 v4, s46, v4
  v_mov_b32 v6, 0
  v_mov_b32 v7, 0
  v_mov_b32 v5, v4
  v_pk_add_f32 v[30:31], v[30:31], v[4:5] neg_lo:[0,1] neg_hi:[0,1]
  v_pk_fma_f32 v[6:7], v[30:31], v[30:31], v[6:7]
  v_pk_add_f32 v[32:33], v[32:33], v[4:5] neg_lo:[0,1] neg_hi:[0,1]
  v_pk_fma_f32 v[6:7], v[32:33], v[32:33], v[6:7]
  v_pk_add_f32 v[34:35], v[34:35], v[4:5] neg_lo:[0,1] neg_hi:[0,1]
  v_pk_fma_f32 v[6:7], v[34:35], v[34:35], v[6:7]
  v_pk_add_f32 v[36:37], v[36:37], v[4:5] neg_lo:[0,1] neg_hi:[0,1]
  v_pk_fma_f32 v[6:7], v[36:37], v[36:37], v[6:7]
  v_pk_add_f32 v[38:39], v[38:39], v[4:5] neg_lo:[0,1] neg_hi:[0,1]
  v_pk_fma_f32 v[6:7], v[38:39], v[38:39], v[6:7]
  v_pk_add_f32 v[40:41], v[40:41], v[4:5] neg_lo:[0,1] neg_hi:[0,1]
  v_pk_fma_f32 v[6:7], v[40:41], v[40:41], v[6:7]
  v_pk_add_f32 v[42:43], v[42:43], v[4:5] neg_lo:[0,1] neg_hi:[0,1]
  v_pk_fma_f32 v[6:7], v[42:43], v[42:43], v[6:7]
  v_pk_add_f32 v[44:45], v[44:45], v[4:5] neg_lo:[0,1] neg_hi:[0,1]
  v_pk_fma_f32 v[6:7], v[44:45], v[44:45], v[6:7]
  v_pk_add_f32 v[46:47], v[46:47], v[4:5] neg_lo:[0,1] neg_hi:[0,1]
  v_pk_fma_f32 v[6:7], v[46:47], v[46:47], v[6:7]
  v_pk_add_f32 v[48:49], v[48:49], v[4:5] neg_lo:[0,1] neg_hi:[0,1]
  v_pk_fma_f32 v[6:7], v[48:49], v[48:49], v[6:7]
  v_pk_add_f32 v[50:51], v[50:51], v[4:5] neg_lo:[0,1] neg_hi:[0,1]
  v_pk_fma_f32 v[6:7], v[50:51], v[50:51], v[6:7]
  v_pk_add_f32 v[52:53], v[52:53], v[4:5] neg_lo:[0,1] neg_hi:[0,1]
  v_pk_fma_f32 v[6:7], v[52:53], v[52:53], v[6:7]
  v_pk_add_f32 v[54:55], v[54:55], v[4:5] neg_lo:[0,1] neg_hi:[0,1]
  v_pk_fma_f32 v[6:7], v[54:55], v[54:55], v[6:7]
  v_pk_add_f32 v[56:57], v[56:57], v[4:5] neg_lo:[0,1] neg_hi:[0,1]
  v_pk_fma_f32 v[6:7], v[56:57], v[56:57], v[6:7]
  v_pk_add_f32 v[58:59], v[58:59], v[4:5] neg_lo:[0,1] neg_hi:[0,1]
  v_pk_fma_f32 v[6:7], v[58:59], v[58:59], v[6:7]
  v_pk_add_f32 v[60:61], v[60:61], v[4:5] neg_lo:[0,1] neg_hi:[0,1]
  v_pk_fma_f32 v[6:7], v[60:61], v[60:61], v[6:7]
  v_pk_add_f32 v[62:63], v[62:63], v[4:5] neg_lo:[0,1] neg_hi:[0,1]
  v_pk_fma_f32 v[6:7], v[62:63], v[62:63], v[6:7]
  v_pk_add_f32 v[64:65], v[64:65], v[4:5] neg_lo:[0,1] neg_hi:[0,1]
  v_pk_fma_f32 v[6:7], v[64:65], v[64:65], v[6:7]
  v_add_f32 v6, v6, v7
  s_nop 1
  v_add_f32_dpp v6, v6, v6 row_ror:8 row_mask:0xf bank_mask:0xf
  s_nop 1
  v_add_f32_dpp v6, v6, v6 row_ror:4 row_mask:0xf bank_mask:0xf
  s_nop 1
  v_add_f32_dpp v6, v6, v6 row_ror:2 row_mask:0xf bank_mask:0xf
  s_nop 1
  v_add_f32_dpp v6, v6, v6 row_ror:1 row_mask:0xf bank_mask:0xf
  v_mov_b32 v7, s47
  v_fma_f32 v6, v6, s46, v7
  v_rsq_f32 v6, v6
  s_nop 0
  v_mov_b32 v7, v6
  v_pk_mul_f32 v[30:31], v[30:31], v[6:7]
  v_cvt_pk_bf16_f32 v10, v30, v31
  v_pk_mul_f32 v[32:33], v[32:33], v[6:7]
  v_cvt_pk_bf16_f32 v11, v32, v33
  v_pk_mul_f32 v[34:35], v[34:35], v[6:7]
  v_cvt_pk_bf16_f32 v12, v34, v35
  v_pk_mul_f32 v[36:37], v[36:37], v[6:7]
  v_cvt_pk_bf16_f32 v13, v36, v37
  v_pk_mul_f32 v[38:39], v[38:39], v[6:7]
  v_cvt_pk_bf16_f32 v14, v38, v39
  v_pk_mul_f32 v[40:41], v[40:41], v[6:7]
  v_cvt_pk_bf16_f32 v15, v40, v41
  v_pk_mul_f32 v[42:43], v[42:43], v[6:7]
  v_cvt_pk_bf16_f32 v16, v42, v43
  v_pk_mul_f32 v[44:45], v[44:45], v[6:7]
  v_cvt_pk_bf16_f32 v17, v44, v45
  v_pk_mul_f32 v[46:47], v[46:47], v[6:7]
  v_cvt_pk_bf16_f32 v18, v46, v47
  v_pk_mul_f32 v[48:49], v[48:49], v[6:7]
  v_cvt_pk_bf16_f32 v19, v48, v49
  v_pk_mul_f32 v[50:51], v[50:51], v[6:7]
  v_cvt_pk_bf16_f32 v20, v50, v51
  v_pk_mul_f32 v[52:53], v[52:53], v[6:7]
  v_cvt_pk_bf16_f32 v21, v52, v53
  v_pk_mul_f32 v[54:55], v[54:55], v[6:7]
  v_cvt_pk_bf16_f32 v22, v54, v55
  v_pk_mul_f32 v[56:57], v[56:57], v[6:7]
  v_cvt_pk_bf16_f32 v23, v56, v57
  v_pk_mul_f32 v[58:59], v[58:59], v[6:7]
  v_cvt_pk_bf16_f32 v24, v58, v59
  v_pk_mul_f32 v[60:61], v[60:61], v[6:7]
  v_cvt_pk_bf16_f32 v25, v60, v61
  v_pk_mul_f32 v[62:63], v[62:63], v[6:7]
  v_cvt_pk_bf16_f32 v26, v62, v63
  v_pk_mul_f32 v[64:65], v[64:65], v[6:7]
  v_cvt_pk_bf16_f32 v27, v64, v65
  buffer_store_dwordx2 v[10:11], v3, s[8:11], s45 offen offset:0 sc1
  buffer_store_dwordx2 v[12:13], v3, s[8:11], s45 offen offset:2048 sc1
  s_add_u32 s45, s45, 4096
  buffer_store_dwordx2 v[14:15], v3, s[8:11], s45 offen offset:0 sc1
  buffer_store_dwordx2 v[16:17], v3, s[8:11], s45 offen offset:2048 sc1
  s_add_u32 s45, s45, 4096
  buffer_store_dwordx2 v[18:19], v3, s[8:11], s45 offen offset:0 sc1
  buffer_store_dwordx2 v[20:21], v3, s[8:11], s45 offen offset:2048 sc1
  s_add_u32 s45, s45, 4096
  buffer_store_dwordx2 v[22:23], v3, s[8:11], s45 offen offset:0 sc1
  buffer_store_dwordx2 v[24:25], v3, s[8:11], s45 offen offset:2048 sc1
  s_add_u32 s45, s45, 4096
  buffer_store_dwordx2 v[26:27], v3, s[8:11], s45 offen offset:0 sc1
  s_lshr_b32 s75, s77, 3
  s_lshl_b32 s75, s75, 2
  s_add_u32 s75, s75, 8
  s_waitcnt vmcnt(0)
  s_barrier
  s_cmp_lg_u32 s21, 0
  s_cbranch_scc1 S_8
  v_mov_b32 v251, 1
  s_mov_b64 exec, 1
  buffer_atomic_add v251, off, s[16:19], s75 offset:120 sc1
  s_mov_b64 exec, -1
S_8:
NOLN0:
  s_load_dwordx2 s[12:13], s[0:1], 16
  s_mov_b32 s14, 4718592
  s_mov_b32 s15, 0x00020000
  s_load_dwordx2 s[24:25], s[0:1], 24
  s_mov_b32 s26, 4718592
  s_mov_b32 s27, 0x00020000
  s_load_dwordx2 s[28:29], s[0:1], 32
  s_mov_b32 s30, 4718592
  s_mov_b32 s31, 0x00020000
  s_mul_i32 s44, s21, 4
  s_add_u32 s44, s44, 0
  s_and_b32 s45, s44, 1
  s_lshr_b32 s44, s44, 1
  s_mul_i32 s44, s44, 18432
  s_lshl_b32 s45, s45, 10
  s_add_u32 s44, s44, s45
  v_lshl_add_u32 v2, v0, 4, s44
  s_mul_i32 s44, s21, 4
  s_add_u32 s44, s44, 1
  s_and_b32 s45, s44, 1
  s_lshr_b32 s44, s44, 1
  s_mul_i32 s44, s44, 18432
  s_lshl_b32 s45, s45, 10
  s_add_u32 s44, s44, s45
  v_lshl_add_u32 v3, v0, 4, s44
  s_mul_i32 s44, s21, 4
  s_add_u32 s44, s44, 2
  s_and_b32 s45, s44, 1
  s_lshr_b32 s44, s44, 1
  s_mul_i32 s44, s44, 18432
  s_lshl_b32 s45, s45, 10
  s_add_u32 s44, s44, s45
  v_lshl_add_u32 v4, v0, 4, s44
  s_mul_i32 s44, s21, 4
  s_add_u32 s44, s44, 3
  s_and_b32 s45, s44, 1
  s_lshr_b32 s44, s44, 1
  s_mul_i32 s44, s44, 18432
  s_lshl_b32 s45, s45, 10
  s_add_u32 s44, s44, s45
  v_lshl_add_u32 v5, v0, 4, s44
  v_add_u32 v139, 0, v0
  v_mul_u32_u24 v138, 4096, v139
  v_lshrrev_b32 v138, 16, v138
  v_mul_u32_u24 v6, 16, v138
  v_sub_u32 v139, v139, v6
  v_bfe_u32 v6, v138, 0, 3
  v_lshlrev_b32 v6, 1, v6
  v_xor_b32 v139, v139, v6
  s_lshl_b32 s44, s21, 4
  v_add_u32 v138, s44, v138
  v_mul_u32_u24 v138, 8192, v138
  v_lshl_add_u32 v6, v139, 4, v138
  v_add_u32 v139, 64, v0
  v_mul_u32_u24 v138, 4096, v139
  v_lshrrev_b32 v138, 16, v138
  v_mul_u32_u24 v7, 16, v138
  v_sub_u32 v139, v139, v7
  v_bfe_u32 v7, v138, 0, 3
  v_lshlrev_b32 v7, 1, v7
  v_xor_b32 v139, v139, v7
  s_lshl_b32 s44, s21, 4
  v_add_u32 v138, s44, v138
  v_mul_u32_u24 v138, 8192, v138
  v_lshl_add_u32 v7, v139, 4, v138
  v_add_u32 v139, 128, v0
  v_mul_u32_u24 v138, 4096, v139
  v_lshrrev_b32 v138, 16, v138
  v_mul_u32_u24 v8, 16, v138
  v_sub_u32 v139, v139, v8
  v_bfe_u32 v8, v138, 0, 3
  v_lshlrev_b32 v8, 1, v8
  v_xor_b32 v139, v139, v8
  s_lshl_b32 s44, s21, 4
  v_add_u32 v138, s44, v138
  v_mul_u32_u24 v138, 8192, v138
  v_lshl_add_u32 v8, v139, 4, v138
  v_add_u32 v139, 192, v0
  v_mul_u32_u24 v138, 4096, v139
  v_lshrrev_b32 v138, 16, v138
  v_mul_u32_u24 v9, 16, v138
  v_sub_u32 v139, v139, v9
  v_bfe_u32 v9, v138, 0, 3
  v_lshlrev_b32 v9, 1, v9
  v_xor_b32 v139, v139, v9
  s_lshl_b32 s44, s21, 4
  v_add_u32 v138, s44, v138
  v_mul_u32_u24 v138, 8192, v138
  v_lshl_add_u32 v9, v139, 4, v138
  v_add_u32 v139, 0, v0
  v_mul_u32_u24 v138, 4096, v139
  v_lshrrev_b32 v138, 16, v138
  v_mul_u32_u24 v10, 16, v138
  v_sub_u32 v139, v139, v10
  v_bfe_u32 v10, v138, 0, 3
  v_lshlrev_b32 v10, 1, v10
  v_xor_b32 v139, v139, v10
  s_lshl_b32 s44, s21, 4
  v_add_u32 v138, s44, v138
  v_mul_u32_u24 v138, 8192, v138
  v_lshl_add_u32 v10, v139, 4, v138
  v_add_u32 v139, 64, v0
  v_mul_u32_u24 v138, 4096, v139
  v_lshrrev_b32 v138, 16, v138
  v_mul_u32_u24 v11, 16, v138
  v_sub_u32 v139, v139, v11
  v_bfe_u32 v11, v138, 0, 3
  v_lshlrev_b32 v11, 1, v11
  v_xor_b32 v139, v139, v11
  s_lshl_b32 s44, s21, 4
  v_add_u32 v138, s44, v138
  v_mul_u32_u24 v138, 8192, v138
  v_lshl_add_u32 v11, v139, 4, v138
  v_add_u32 v139, 128, v0
  v_mul_u32_u24 v138, 4096, v139
  v_lshrrev_b32 v138, 16, v138
  v_mul_u32_u24 v12, 16, v138
  v_sub_u32 v139, v139, v12
  v_bfe_u32 v12, v138, 0, 3
  v_lshlrev_b32 v12, 1, v12
  v_xor_b32 v139, v139, v12
  s_lshl_b32 s44, s21, 4
  v_add_u32 v138, s44, v138
  v_mul_u32_u24 v138, 8192, v138
  v_lshl_add_u32 v12, v139, 4, v138
  v_add_u32 v139, 192, v0
  v_mul_u32_u24 v138, 4096, v139
  v_lshrrev_b32 v138, 16, v138
  v_mul_u32_u24 v13, 16, v138
  v_sub_u32 v139, v139, v13
  v_bfe_u32 v13, v138, 0, 3
  v_lshlrev_b32 v13, 1, v13
  v_xor_b32 v139, v139, v13
  s_lshl_b32 s44, s21, 4
  v_add_u32 v138, s44, v138
  v_mul_u32_u24 v138, 8192, v138
  v_lshl_add_u32 v13, v139, 4, v138
  v_add_u32 v139, 0, v0
  v_mul_u32_u24 v138, 4096, v139
  v_lshrrev_b32 v138, 16, v138
  v_mul_u32_u24 v14, 16, v138
  v_sub_u32 v139, v139, v14
  v_bfe_u32 v14, v138, 0, 3
  v_lshlrev_b32 v14, 1, v14
  v_xor_b32 v139, v139, v14
  s_lshl_b32 s44, s21, 4
  v_add_u32 v138, s44, v138
  v_mul_u32_u24 v138, 8192, v138
  v_lshl_add_u32 v14, v139, 4, v138
  v_add_u32 v139, 64, v0
  v_mul_u32_u24 v138, 4096, v139
  v_lshrrev_b32 v138, 16, v138
  v_mul_u32_u24 v15, 16, v138
  v_sub_u32 v139, v139, v15
  v_bfe_u32 v15, v138, 0, 3
  v_lshlrev_b32 v15, 1, v15
  v_xor_b32 v139, v139, v15
  s_lshl_b32 s44, s21, 4
  v_add_u32 v138, s44, v138
  v_mul_u32_u24 v138, 8192, v138
  v_lshl_add_u32 v15, v139, 4, v138
  v_add_u32 v139, 128, v0
  v_mul_u32_u24 v138, 4096, v139
  v_lshrrev_b32 v138, 16, v138
  v_mul_u32_u24 v16, 16, v138
  v_sub_u32 v139, v139, v16
  v_bfe_u32 v16, v138, 0, 3
  v_lshlrev_b32 v16, 1, v16
  v_xor_b32 v139, v139, v16
  s_lshl_b32 s44, s21, 4
  v_add_u32 v138, s44, v138
  v_mul_u32_u24 v138, 8192, v138
  v_lshl_add_u32 v16, v139, 4, v138
  v_add_u32 v139, 192, v0
  v_mul_u32_u24 v138, 4096, v139
  v_lshrrev_b32 v138, 16, v138
  v_mul_u32_u24 v17, 16, v138
  v_sub_u32 v139, v139, v17
  v_bfe_u32 v17, v138, 0, 3
  v_lshlrev_b32 v17, 1, v17
  v_xor_b32 v139, v139, v17
  s_lshl_b32 s44, s21, 4
  v_add_u32 v138, s44, v138
  v_mul_u32_u24 v138, 8192, v138
  v_lshl_add_u32 v17, v139, 4, v138
  s_mov_b32 s44, 0
  v_lshl_add_u32 v18, v0, 4, s44
  v_bfe_u32 v138, v0, 2, 4
  v_mul_u32_u24 v138, 256, v138
  v_bfe_u32 v139, v0, 0, 2
  v_mul_u32_u24 v139, 8, v139
  v_add_u32 v138, v138, v139
  v_add_u32 v138, 16384, v138
  s_add_u32 s44, s21, 0
  v_bfe_u32 v139, v0, 2, 3
  v_xor_b32 v139, s44, v139
  v_lshl_add_u32 v19, v139, 5, v138
  s_add_u32 s44, s21, 4
  v_bfe_u32 v139, v0, 2, 3
  v_xor_b32 v139, s44, v139
  v_lshl_add_u32 v20, v139, 5, v138
  v_bfe_u32 v138, v0, 2, 4
  v_mul_u32_u24 v138, 256, v138
  v_bfe_u32 v139, v0, 0, 2
  v_mul_u32_u24 v139, 8, v139
  v_add_u32 v138, v138, v139
  v_add_u32 v138, 32768, v138
  s_add_u32 s44, s21, 0
  v_bfe_u32 v139, v0, 2, 3
  v_xor_b32 v139, s44, v139
  v_lshl_add_u32 v21, v139, 5, v138
  s_add_u32 s44, s21, 4
  v_bfe_u32 v139, v0, 2, 3
  v_xor_b32 v139, s44, v139
  v_lshl_add_u32 v22, v139, 5, v138
  v_bfe_u32 v138, v0, 2, 4
  v_mul_u32_u24 v138, 256, v138
  v_bfe_u32 v139, v0, 0, 2
  v_mul_u32_u24 v139, 8, v139
  v_add_u32 v138, v138, v139
  v_add_u32 v138, 49152, v138
  s_add_u32 s44, s21, 0
  v_bfe_u32 v139, v0, 2, 3
  v_xor_b32 v139, s44, v139
  v_lshl_add_u32 v23, v139, 5, v138
  s_add_u32 s44, s21, 4
  v_bfe_u32 v139, v0, 2, 3
  v_xor_b32 v139, s44, v139
  v_lshl_add_u32 v24, v139, 5, v138
  v_lshlrev_b32 v1, 4, v0
  s_waitcnt lgkmcnt(0)
  s_cmp_lt_u32 s6, 7
  s_cbranch_scc1 ALOOP
  s_sub_u32 s44, s6, 7
  s_lshl_b32 s44, s44, 2
  s_add_u32 s44, s44, s21
  s_mul_i32 s44, s44, 1152
  v_add_u32 v247, s44, v0
  v_min_u32 v247, 0x47f, v247
  v_and_b32 v246, 1, v247
  v_lshrrev_b32 v247, 1, v247
  v_lshlrev_b32 v247, 13, v247
  v_lshl_add_u32 v247, v246, 7, v247
  s_lshl_b32 s44, s5, 8
  s_mov_b32 s75, 8
  s_cmp_lg_u32 s21, 0
  s_cbranch_scc1 W_9_ok
  s_mov_b32 s79, 0
W_9:
  buffer_load_dword v251, off, s[16:19], s75 offset:0 sc1
  s_add_u32 s79, s79, 1
  s_cmp_gt_u32 s79, 0x40000
  s_cbranch_scc1 BG_END
  s_waitcnt vmcnt(0)
  v_readfirstlane_b32 s78, v251
  s_bfe_u32 s78, s78, 0x60004
  s_cmp_eq_u32 s78, 32
  s_cbranch_scc1 W_9_ok
  s_sleep 32
  s_branch W_9
W_9_ok:
  s_barrier
ALOOP:
  s_lshl_b32 s75, s6, 2
  s_add_u32 s75, s75, 8
  s_lshl_b32 s20, s6, 5
  s_add_u32 s20, s20, s5
  s_lshr_b32 s22, s20, 5
  s_and_b32 s23, s20, 31
  s_mul_i32 s40, s22, 147456
  s_add_u32 s40, s40, 0
  s_lshl_b32 s41, s23, 8
  s_mov_b32 s42, s41
  s_mov_b32 s43, s41
  v_accvgpr_write_b32 a0, 0
  v_accvgpr_write_b32 a1, 0
  v_accvgpr_write_b32 a2, 0
  v_accvgpr_write_b32 a3, 0
  v_accvgpr_write_b32 a4, 0
  v_accvgpr_write_b32 a5, 0
  v_accvgpr_write_b32 a6, 0
  v_accvgpr_write_b32 a7, 0
  v_accvgpr_write_b32 a8, 0
  v_accvgpr_write_b32 a9, 0
  v_accvgpr_write_b32 a10, 0
  v_accvgpr_write_b32 a11, 0
  v_accvgpr_write_b32 a12, 0
  v_accvgpr_write_b32 a13, 0
  v_accvgpr_write_b32 a14, 0
  v_accvgpr_write_b32 a15, 0
  v_accvgpr_write_b32 a16, 0
  v_accvgpr_write_b32 a17, 0
  v_accvgpr_write_b32 a18, 0
  v_accvgpr_write_b32 a19, 0
  v_accvgpr_write_b32 a20, 0
  v_accvgpr_write_b32 a21, 0
  v_accvgpr_write_b32 a22, 0
  v_accvgpr_write_b32 a23, 0
  v_accvgpr_write_b32 a24, 0
  v_accvgpr_write_b32 a25, 0
  v_accvgpr_write_b32 a26, 0
  v_accvgpr_write_b32 a27, 0
  v_accvgpr_write_b32 a28, 0
  v_accvgpr_write_b32 a29, 0
  v_accvgpr_write_b32 a30, 0
  v_accvgpr_write_b32 a31, 0
  v_accvgpr_write_b32 a32, 0
  v_accvgpr_write_b32 a33, 0
  v_accvgpr_write_b32 a34, 0
  v_accvgpr_write_b32 a35, 0
  v_accvgpr_write_b32 a36, 0
  v_accvgpr_write_b32 a37, 0
  v_accvgpr_write_b32 a38, 0
  v_accvgpr_write_b32 a39, 0
  v_accvgpr_write_b32 a40, 0
  v_accvgpr_write_b32 a41, 0
  v_accvgpr_write_b32 a42, 0
  v_accvgpr_write_b32 a43, 0
  v_accvgpr_write_b32 a44, 0
  v_accvgpr_write_b32 a45, 0
  v_accvgpr_write_b32 a46, 0
  v_accvgpr_write_b32 a47, 0
  v_accvgpr_write_b32 a48, 0
  v_accvgpr_write_b32 a49, 0
  v_accvgpr_write_b32 a50, 0
  v_accvgpr_write_b32 a51, 0
  v_accvgpr_write_b32 a52, 0
  v_accvgpr_write_b32 a53, 0
  v_accvgpr_write_b32 a54, 0
  v_accvgpr_write_b32 a55, 0
  v_accvgpr_write_b32 a56, 0
  v_accvgpr_write_b32 a57, 0
  v_accvgpr_write_b32 a58, 0
  v_accvgpr_write_b32 a59, 0
  v_accvgpr_write_b32 a60, 0
  v_accvgpr_write_b32 a61, 0
  v_accvgpr_write_b32 a62, 0
  v_accvgpr_write_b32 a63, 0
  v_accvgpr_write_b32 a64, 0
  v_accvgpr_write_b32 a65, 0
  v_accvgpr_write_b32 a66, 0
  v_accvgpr_write_b32 a67, 0
  v_accvgpr_write_b32 a68, 0
  v_accvgpr_write_b32 a69, 0
  v_accvgpr_write_b32 a70, 0
  v_accvgpr_write_b32 a71, 0
  v_accvgpr_write_b32 a72, 0
  v_accvgpr_write_b32 a73, 0
  v_accvgpr_write_b32 a74, 0
  v_accvgpr_write_b32 a75, 0
  v_accvgpr_write_b32 a76, 0
  v_accvgpr_write_b32 a77, 0
  v_accvgpr_write_b32 a78, 0
  v_accvgpr_write_b32 a79, 0
  v_accvgpr_write_b32 a80, 0
  v_accvgpr_write_b32 a81, 0
  v_accvgpr_write_b32 a82, 0
  v_accvgpr_write_b32 a83, 0
  v_accvgpr_write_b32 a84, 0
  v_accvgpr_write_b32 a85, 0
  v_accvgpr_write_b32 a86, 0
  v_accvgpr_write_b32 a87, 0
  v_accvgpr_write_b32 a88, 0
  v_accvgpr_write_b32 a89, 0
  v_accvgpr_write_b32 a90, 0
  v_accvgpr_write_b32 a91, 0
  v_accvgpr_write_b32 a92, 0
  v_accvgpr_write_b32 a93, 0
  v_accvgpr_write_b32 a94, 0
  v_accvgpr_write_b32 a95, 0
  v_accvgpr_write_b32 a96, 0
  v_accvgpr_write_b32 a97, 0
  v_accvgpr_write_b32 a98, 0
  v_accvgpr_write_b32 a99, 0
  v_accvgpr_write_b32 a100, 0
  v_accvgpr_write_b32 a101, 0
  v_accvgpr_write_b32 a102, 0
  v_accvgpr_write_b32 a103, 0
  v_accvgpr_write_b32 a104, 0
  v_accvgpr_write_b32 a105, 0
  v_accvgpr_write_b32 a106, 0
  v_accvgpr_write_b32 a107, 0
  v_accvgpr_write_b32 a108, 0
  v_accvgpr_write_b32 a109, 0
  v_accvgpr_write_b32 a110, 0
  v_accvgpr_write_b32 a111, 0
  v_accvgpr_write_b32 a112, 0
  v_accvgpr_write_b32 a113, 0
  v_accvgpr_write_b32 a114, 0
  v_accvgpr_write_b32 a115, 0
  v_accvgpr_write_b32 a116, 0
  v_accvgpr_write_b32 a117, 0
  v_accvgpr_write_b32 a118, 0
  v_accvgpr_write_b32 a119, 0
  v_accvgpr_write_b32 a120, 0
  v_accvgpr_write_b32 a121, 0
  v_accvgpr_write_b32 a122, 0
  v_accvgpr_write_b32 a123, 0
  v_accvgpr_write_b32 a124, 0
  v_accvgpr_write_b32 a125, 0
  v_accvgpr_write_b32 a126, 0
  v_accvgpr_write_b32 a127, 0
  v_accvgpr_write_b32 a128, 0
  v_accvgpr_write_b32 a129, 0
  v_accvgpr_write_b32 a130, 0
  v_accvgpr_write_b32 a131, 0
  v_accvgpr_write_b32 a132, 0
  v_accvgpr_write_b32 a133, 0
  v_accvgpr_write_b32 a134, 0
  v_accvgpr_write_b32 a135, 0
  v_accvgpr_write_b32 a136, 0
  v_accvgpr_write_b32 a137, 0
  v_accvgpr_write_b32 a138, 0
  v_accvgpr_write_b32 a139, 0
  v_accvgpr_write_b32 a140, 0
  v_accvgpr_write_b32 a141, 0
  v_accvgpr_write_b32 a142, 0
  v_accvgpr_write_b32 a143, 0
  v_accvgpr_write_b32 a144, 0
  v_accvgpr_write_b32 a145, 0
  v_accvgpr_write_b32 a146, 0
  v_accvgpr_write_b32 a147, 0
  v_accvgpr_write_b32 a148, 0
  v_accvgpr_write_b32 a149, 0
  v_accvgpr_write_b32 a150, 0
  v_accvgpr_write_b32 a151, 0
  v_accvgpr_write_b32 a152, 0
  v_accvgpr_write_b32 a153, 0
  v_accvgpr_write_b32 a154, 0
  v_accvgpr_write_b32 a155, 0
  v_accvgpr_write_b32 a156, 0
  v_accvgpr_write_b32 a157, 0
  v_accvgpr_write_b32 a158, 0
  v_accvgpr_write_b32 a159, 0
  v_accvgpr_write_b32 a160, 0
  v_accvgpr_write_b32 a161, 0
  v_accvgpr_write_b32 a162, 0
  v_accvgpr_write_b32 a163, 0
  v_accvgpr_write_b32 a164, 0
  v_accvgpr_write_b32 a165, 0
  v_accvgpr_write_b32 a166, 0
  v_accvgpr_write_b32 a167, 0
  v_accvgpr_write_b32 a168, 0
  v_accvgpr_write_b32 a169, 0
  v_accvgpr_write_b32 a170, 0
  v_accvgpr_write_b32 a171, 0
  v_accvgpr_write_b32 a172, 0
  v_accvgpr_write_b32 a173, 0
  v_accvgpr_write_b32 a174, 0
  v_accvgpr_write_b32 a175, 0
  v_accvgpr_write_b32 a176, 0
  v_accvgpr_write_b32 a177, 0
  v_accvgpr_write_b32 a178, 0
  v_accvgpr_write_b32 a179, 0
  v_accvgpr_write_b32 a180, 0
  v_accvgpr_write_b32 a181, 0
  v_accvgpr_write_b32 a182, 0
  v_accvgpr_write_b32 a183, 0
  v_accvgpr_write_b32 a184, 0
  v_accvgpr_write_b32 a185, 0
  v_accvgpr_write_b32 a186, 0
  v_accvgpr_write_b32 a187, 0
  v_accvgpr_write_b32 a188, 0
  v_accvgpr_write_b32 a189, 0
  v_accvgpr_write_b32 a190, 0
  v_accvgpr_write_b32 a191, 0
  s_barrier
  s_mul_i32 s44, s21, 4096
  s_add_u32 m0, s44, 16384
  s_nop 0
  buffer_load_dwordx4 v6, s[12:15], s41 offen  lds
  s_add_u32 m0, s44, 17408
  s_nop 0
  buffer_load_dwordx4 v7, s[12:15], s41 offen  lds
  s_add_u32 m0, s44, 18432
  s_nop 0
  buffer_load_dwordx4 v8, s[12:15], s41 offen  lds
  s_add_u32 m0, s44, 19456
  s_nop 0
  buffer_load_dwordx4 v9, s[12:15], s41 offen  lds
  s_add_u32 s41, s41, 524288
  s_mul_i32 s44, s21, 4096
  s_add_u32 m0, s44, 32768
  s_nop 0
  buffer_load_dwordx4 v10, s[24:27], s42 offen  lds
  s_add_u32 m0, s44, 33792
  s_nop 0
  buffer_load_dwordx4 v11, s[24:27], s42 offen  lds
  s_add_u32 m0, s44, 34816
  s_nop 0
  buffer_load_dwordx4 v12, s[24:27], s42 offen  lds
  s_add_u32 m0, s44, 35840
  s_nop 0
  buffer_load_dwordx4 v13, s[24:27], s42 offen  lds
  s_add_u32 s42, s42, 524288
  s_mul_i32 s44, s21, 4096
  s_add_u32 m0, s44, 49152
  s_nop 0
  buffer_load_dwordx4 v14, s[28:31], s43 offen  lds
  s_add_u32 m0, s44, 50176
  s_nop 0
  buffer_load_dwordx4 v15, s[28:31], s43 offen  lds
  s_add_u32 m0, s44, 51200
  s_nop 0
  buffer_load_dwordx4 v16, s[28:31], s43 offen  lds
  s_add_u32 m0, s44, 52224
  s_nop 0
  buffer_load_dwordx4 v17, s[28:31], s43 offen  lds
  s_add_u32 s43, s43, 524288
  s_mul_i32 s44, s21, 4096
  s_add_u32 m0, s44, 81920
  s_nop 0
  buffer_load_dwordx4 v6, s[12:15], s41 offen  lds
  s_add_u32 m0, s44, 82944
  s_nop 0
  buffer_load_dwordx4 v7, s[12:15], s41 offen  lds
  s_add_u32 m0, s44, 83968
  s_nop 0
  buffer_load_dwordx4 v8, s[12:15], s41 offen  lds
  s_add_u32 m0, s44, 84992
  s_nop 0
  buffer_load_dwordx4 v9, s[12:15], s41 offen  lds
  s_add_u32 s41, s41, 524288
  s_mul_i32 s44, s21, 4096
  s_add_u32 m0, s44, 98304
  s_nop 0
  buffer_load_dwordx4 v10, s[24:27], s42 offen  lds
  s_add_u32 m0, s44, 99328
  s_nop 0
  buffer_load_dwordx4 v11, s[24:27], s42 offen  lds
  s_add_u32 m0, s44, 100352
  s_nop 0
  buffer_load_dwordx4 v12, s[24:27], s42 offen  lds
  s_add_u32 m0, s44, 101376
  s_nop 0
  buffer_load_dwordx4 v13, s[24:27], s42 offen  lds
  s_add_u32 s42, s42, 524288
  s_mul_i32 s44, s21, 4096
  s_add_u32 m0, s44, 114688
  s_nop 0
  buffer_load_dwordx4 v14, s[28:31], s43 offen  lds
  s_add_u32 m0, s44, 115712
  s_nop 0
  buffer_load_dwordx4 v15, s[28:31], s43 offen  lds
  s_add_u32 m0, s44, 116736
  s_nop 0
  buffer_load_dwordx4 v16, s[28:31], s43 offen  lds
  s_add_u32 m0, s44, 117760
  s_nop 0
  buffer_load_dwordx4 v17, s[28:31], s43 offen  lds
  s_add_u32 s43, s43, 524288
  s_cmp_lg_u32 s21, 0
  s_cbranch_scc1 W_10_ok
  s_mov_b32 s79, 0
W_10:
  buffer_load_dword v251, off, s[16:19], s75 offset:120 sc1
  s_add_u32 s79, s79, 1
  s_cmp_gt_u32 s79, 0x40000
  s_cbranch_scc1 BG_END
  s_waitcnt vmcnt(0)
  v_readfirstlane_b32 s78, v251
  s_bfe_u32 s78, s78, 0x40000
  s_cmp_eq_u32 s78, 8
  s_cbranch_scc1 W_10_ok
  s_sleep 16
  s_branch W_10
W_10_ok:
  s_barrier
  s_mul_i32 s44, s21, 4096
  s_add_u32 m0, s44, 0
  s_nop 0
  buffer_load_dwordx4 v2, s[8:11], s40 offen sc1 lds
  s_add_u32 m0, s44, 1024
  s_nop 0
  buffer_load_dwordx4 v3, s[8:11], s40 offen sc1 lds
  s_add_u32 m0, s44, 2048
  s_nop 0
  buffer_load_dwordx4 v4, s[8:11], s40 offen sc1 lds
  s_add_u32 m0, s44, 3072
  s_nop 0
  buffer_load_dwordx4 v5, s[8:11], s40 offen sc1 lds
  s_add_u32 s40, s40, 2048
  s_mul_i32 s44, s21, 4096
  s_add_u32 m0, s44, 65536
  s_nop 0
  buffer_load_dwordx4 v2, s[8:11], s40 offen sc1 lds
  s_add_u32 m0, s44, 66560
  s_nop 0
  buffer_load_dwordx4 v3, s[8:11], s40 offen sc1 lds
  s_add_u32 m0, s44, 67584
  s_nop 0
  buffer_load_dwordx4 v4, s[8:11], s40 offen sc1 lds
  s_add_u32 m0, s44, 68608
  s_nop 0
  buffer_load_dwordx4 v5, s[8:11], s40 offen sc1 lds
  s_add_u32 s40, s40, 2048
  s_waitcnt vmcnt(4)
  s_barrier
  ds_read_b128 v[26:29], v18 offset:0
  ds_read_b128 v[30:33], v18 offset:2048
  ds_read_b128 v[34:37], v18 offset:4096
  ds_read_b128 v[38:41], v18 offset:6144
  ds_read_b128 v[42:45], v18 offset:8192
  ds_read_b128 v[46:49], v18 offset:10240
  ds_read_b128 v[50:53], v18 offset:12288
  ds_read_b128 v[54:57], v18 offset:14336
  ds_read_b64_tr_b16 v[58:59], v19 offset:0
  ds_read_b64_tr_b16 v[60:61], v19 offset:4096
  ds_read_b64_tr_b16 v[62:63], v20 offset:0
  ds_read_b64_tr_b16 v[64:65], v20 offset:4096
  ds_read_b64_tr_b16 v[66:67], v21 offset:0
  ds_read_b64_tr_b16 v[68:69], v21 offset:4096
  ds_read_b64_tr_b16 v[70:71], v22 offset:0
  ds_read_b64_tr_b16 v[72:73], v22 offset:4096
  ds_read_b64_tr_b16 v[74:75], v23 offset:0
  ds_read_b64_tr_b16 v[76:77], v23 offset:4096
  ds_read_b64_tr_b16 v[78:79], v24 offset:0
  ds_read_b64_tr_b16 v[80:81], v24 offset:4096
  s_mov_b32 s46, 3
GL_11:
  s_waitcnt lgkmcnt(0)
  v_mfma_f32_16x16x32_bf16 a[0:3], v[58:61], v[26:29], a[0:3]
  ds_read_b128 v[82:85], v18 offset:1024
  v_mfma_f32_16x16x32_bf16 a[8:11], v[58:61], v[30:33], a[8:11]
  ds_read_b128 v[86:89], v18 offset:3072
  v_mfma_f32_16x16x32_bf16 a[16:19], v[58:61], v[34:37], a[16:19]
  v_mfma_f32_16x16x32_bf16 a[24:27], v[58:61], v[38:41], a[24:27]
  ds_read_b128 v[90:93], v18 offset:5120
  v_mfma_f32_16x16x32_bf16 a[32:35], v[58:61], v[42:45], a[32:35]
  v_mfma_f32_16x16x32_bf16 a[40:43], v[58:61], v[46:49], a[40:43]
  ds_read_b128 v[94:97], v18 offset:7168
  v_mfma_f32_16x16x32_bf16 a[48:51], v[58:61], v[50:53], a[48:51]
  v_mfma_f32_16x16x32_bf16 a[56:59], v[58:61], v[54:57], a[56:59]
  ds_read_b128 v[98:101], v18 offset:9216
  v_mfma_f32_16x16x32_bf16 a[4:7], v[62:65], v[26:29], a[4:7]
  ds_read_b128 v[102:105], v18 offset:11264
  v_mfma_f32_16x16x32_bf16 a[12:15], v[62:65], v[30:33], a[12:15]
  v_mfma_f32_16x16x32_bf16 a[20:23], v[62:65], v[34:37], a[20:23]
  ds_read_b128 v[106:109], v18 offset:13312
  v_mfma_f32_16x16x32_bf16 a[28:31], v[62:65], v[38:41], a[28:31]
  v_mfma_f32_16x16x32_bf16 a[36:39], v[62:65], v[42:45], a[36:39]
  ds_read_b128 v[110:113], v18 offset:15360
  v_mfma_f32_16x16x32_bf16 a[44:47], v[62:65], v[46:49], a[44:47]
  v_mfma_f32_16x16x32_bf16 a[52:55], v[62:65], v[50:53], a[52:55]
  ds_read_b64_tr_b16 v[114:115], v19 offset:8192
  v_mfma_f32_16x16x32_bf16 a[60:63], v[62:65], v[54:57], a[60:63]
  v_mfma_f32_16x16x32_bf16 a[64:67], v[66:69], v[26:29], a[64:67]
  ds_read_b64_tr_b16 v[116:117], v19 offset:12288
  v_mfma_f32_16x16x32_bf16 a[72:75], v[66:69], v[30:33], a[72:75]
  ds_read_b64_tr_b16 v[118:119], v20 offset:8192
  v_mfma_f32_16x16x32_bf16 a[80:83], v[66:69], v[34:37], a[80:83]
  v_mfma_f32_16x16x32_bf16 a[88:91], v[66:69], v[38:41], a[88:91]
  ds_read_b64_tr_b16 v[120:121], v20 offset:12288
  v_mfma_f32_16x16x32_bf16 a[96:99], v[66:69], v[42:45], a[96:99]
  v_mfma_f32_16x16x32_bf16 a[104:107], v[66:69], v[46:49], a[104:107]
  ds_read_b64_tr_b16 v[122:123], v21 offset:8192
  v_mfma_f32_16x16x32_bf16 a[112:115], v[66:69], v[50:53], a[112:115]
  v_mfma_f32_16x16x32_bf16 a[120:123], v[66:69], v[54:57], a[120:123]
  ds_read_b64_tr_b16 v[124:125], v21 offset:12288
  v_mfma_f32_16x16x32_bf16 a[68:71], v[70:73], v[26:29], a[68:71]
  ds_read_b64_tr_b16 v[126:127], v22 offset:8192
  v_mfma_f32_16x16x32_bf16 a[76:79], v[70:73], v[30:33], a[76:79]
  v_mfma_f32_16x16x32_bf16 a[84:87], v[70:73], v[34:37], a[84:87]
  ds_read_b64_tr_b16 v[128:129], v22 offset:12288
  v_mfma_f32_16x16x32_bf16 a[92:95], v[70:73], v[38:41], a[92:95]
  v_mfma_f32_16x16x32_bf16 a[100:103], v[70:73], v[42:45], a[100:103]
  ds_read_b64_tr_b16 v[130:131], v23 offset:8192
  v_mfma_f32_16x16x32_bf16 a[108:111], v[70:73], v[46:49], a[108:111]
  v_mfma_f32_16x16x32_bf16 a[116:119], v[70:73], v[50:53], a[116:119]
  ds_read_b64_tr_b16 v[132:133], v23 offset:12288
  v_mfma_f32_16x16x32_bf16 a[124:127], v[70:73], v[54:57], a[124:127]
  v_mfma_f32_16x16x32_bf16 a[128:131], v[26:29], v[74:77], a[128:131]
  ds_read_b64_tr_b16 v[134:135], v24 offset:8192
  v_mfma_f32_16x16x32_bf16 a[136:139], v[30:33], v[74:77], a[136:139]
  ds_read_b64_tr_b16 v[136:137], v24 offset:12288
  v_mfma_f32_16x16x32_bf16 a[144:147], v[34:37], v[74:77], a[144:147]
  v_mfma_f32_16x16x32_bf16 a[152:155], v[38:41], v[74:77], a[152:155]
  v_add_u32 v18, 65536, v18
  v_mfma_f32_16x16x32_bf16 a[160:163], v[42:45], v[74:77], a[160:163]
  v_mfma_f32_16x16x32_bf16 a[168:171], v[46:49], v[74:77], a[168:171]
  v_add_u32 v19, 65536, v19
  v_mfma_f32_16x16x32_bf16 a[176:179], v[50:53], v[74:77], a[176:179]
  v_mfma_f32_16x16x32_bf16 a[184:187], v[54:57], v[74:77], a[184:187]
  v_add_u32 v20, 65536, v20
  v_mfma_f32_16x16x32_bf16 a[132:135], v[26:29], v[78:81], a[132:135]
  v_add_u32 v21, 65536, v21
  v_mfma_f32_16x16x32_bf16 a[140:143], v[30:33], v[78:81], a[140:143]
  v_mfma_f32_16x16x32_bf16 a[148:151], v[34:37], v[78:81], a[148:151]
  v_add_u32 v22, 65536, v22
  v_mfma_f32_16x16x32_bf16 a[156:159], v[38:41], v[78:81], a[156:159]
  v_mfma_f32_16x16x32_bf16 a[164:167], v[42:45], v[78:81], a[164:167]
  v_add_u32 v23, 65536, v23
  v_mfma_f32_16x16x32_bf16 a[172:175], v[46:49], v[78:81], a[172:175]
  v_mfma_f32_16x16x32_bf16 a[180:183], v[50:53], v[78:81], a[180:183]
  v_add_u32 v24, 65536, v24
  v_mfma_f32_16x16x32_bf16 a[188:191], v[54:57], v[78:81], a[188:191]
  s_waitcnt lgkmcnt(0)
  s_waitcnt vmcnt(0)
  s_barrier
  v_mfma_f32_16x16x32_bf16 a[0:3], v[114:117], v[82:85], a[0:3]
  ds_read_b128 v[26:29], v18 offset:0
  v_mfma_f32_16x16x32_bf16 a[8:11], v[114:117], v[86:89], a[8:11]
  ds_read_b128 v[30:33], v18 offset:2048
  v_mfma_f32_16x16x32_bf16 a[16:19], v[114:117], v[90:93], a[16:19]
  ds_read_b128 v[34:37], v18 offset:4096
  v_mfma_f32_16x16x32_bf16 a[24:27], v[114:117], v[94:97], a[24:27]
  v_mfma_f32_16x16x32_bf16 a[32:35], v[114:117], v[98:101], a[32:35]
  ds_read_b128 v[38:41], v18 offset:6144
  v_mfma_f32_16x16x32_bf16 a[40:43], v[114:117], v[102:105], a[40:43]
  ds_read_b128 v[42:45], v18 offset:8192
  v_mfma_f32_16x16x32_bf16 a[48:51], v[114:117], v[106:109], a[48:51]
  ds_read_b128 v[46:49], v18 offset:10240
  v_mfma_f32_16x16x32_bf16 a[56:59], v[114:117], v[110:113], a[56:59]
  v_mfma_f32_16x16x32_bf16 a[4:7], v[118:121], v[82:85], a[4:7]
  ds_read_b128 v[50:53], v18 offset:12288
  v_mfma_f32_16x16x32_bf16 a[12:15], v[118:121], v[86:89], a[12:15]
  ds_read_b128 v[54:57], v18 offset:14336
  v_mfma_f32_16x16x32_bf16 a[20:23], v[118:121], v[90:93], a[20:23]
  ds_read_b64_tr_b16 v[58:59], v19 offset:0
  v_mfma_f32_16x16x32_bf16 a[28:31], v[118:121], v[94:97], a[28:31]
  v_mfma_f32_16x16x32_bf16 a[36:39], v[118:121], v[98:101], a[36:39]
  ds_read_b64_tr_b16 v[60:61], v19 offset:4096
  v_mfma_f32_16x16x32_bf16 a[44:47], v[118:121], v[102:105], a[44:47]
  ds_read_b64_tr_b16 v[62:63], v20 offset:0
  v_mfma_f32_16x16x32_bf16 a[52:55], v[118:121], v[106:109], a[52:55]
  ds_read_b64_tr_b16 v[64:65], v20 offset:4096
  v_mfma_f32_16x16x32_bf16 a[60:63], v[118:121], v[110:113], a[60:63]
  v_mfma_f32_16x16x32_bf16 a[64:67], v[122:125], v[82:85], a[64:67]
  ds_read_b64_tr_b16 v[66:67], v21 offset:0
  v_mfma_f32_16x16x32_bf16 a[72:75], v[122:125], v[86:89], a[72:75]
  ds_read_b64_tr_b16 v[68:69], v21 offset:4096
  v_mfma_f32_16x16x32_bf16 a[80:83], v[122:125], v[90:93], a[80:83]
  ds_read_b64_tr_b16 v[70:71], v22 offset:0
  v_mfma_f32_16x16x32_bf16 a[88:91], v[122:125], v[94:97], a[88:91]
  v_mfma_f32_16x16x32_bf16 a[96:99], v[122:125], v[98:101], a[96:99]
  ds_read_b64_tr_b16 v[72:73], v22 offset:4096
  v_mfma_f32_16x16x32_bf16 a[104:107], v[122:125], v[102:105], a[104:107]
  ds_read_b64_tr_b16 v[74:75], v23 offset:0
  v_mfma_f32_16x16x32_bf16 a[112:115], v[122:125], v[106:109], a[112:115]
  ds_read_b64_tr_b16 v[76:77], v23 offset:4096
  v_mfma_f32_16x16x32_bf16 a[120:123], v[122:125], v[110:113], a[120:123]
  v_mfma_f32_16x16x32_bf16 a[68:71], v[126:129], v[82:85], a[68:71]
  ds_read_b64_tr_b16 v[78:79], v24 offset:0
  v_mfma_f32_16x16x32_bf16 a[76:79], v[126:129], v[86:89], a[76:79]
  ds_read_b64_tr_b16 v[80:81], v24 offset:4096
  v_mfma_f32_16x16x32_bf16 a[84:87], v[126:129], v[90:93], a[84:87]
  s_mul_i32 s44, s21, 4096
  s_add_u32 m0, s44, 0
  s_nop 0
  buffer_load_dwordx4 v2, s[8:11], s40 offen sc1 lds
  v_mfma_f32_16x16x32_bf16 a[92:95], v[126:129], v[94:97], a[92:95]
  v_mfma_f32_16x16x32_bf16 a[100:103], v[126:129], v[98:101], a[100:103]
  s_add_u32 m0, s44, 1024
  s_nop 0
  buffer_load_dwordx4 v3, s[8:11], s40 offen sc1 lds
  v_mfma_f32_16x16x32_bf16 a[108:111], v[126:129], v[102:105], a[108:111]
  s_add_u32 m0, s44, 2048
  s_nop 0
  buffer_load_dwordx4 v4, s[8:11], s40 offen sc1 lds
  v_mfma_f32_16x16x32_bf16 a[116:119], v[126:129], v[106:109], a[116:119]
  s_add_u32 m0, s44, 3072
  s_nop 0
  buffer_load_dwordx4 v5, s[8:11], s40 offen sc1 lds
  s_add_u32 s40, s40, 2048
  v_mfma_f32_16x16x32_bf16 a[124:127], v[126:129], v[110:113], a[124:127]
  v_mfma_f32_16x16x32_bf16 a[128:131], v[82:85], v[130:133], a[128:131]
  s_mul_i32 s44, s21, 4096
  s_add_u32 m0, s44, 16384
  s_nop 0
  buffer_load_dwordx4 v6, s[12:15], s41 offen  lds
  v_mfma_f32_16x16x32_bf16 a[136:139], v[86:89], v[130:133], a[136:139]
  s_add_u32 m0, s44, 17408
  s_nop 0
  buffer_load_dwordx4 v7, s[12:15], s41 offen  lds
  v_mfma_f32_16x16x32_bf16 a[144:147], v[90:93], v[130:133], a[144:147]
  s_add_u32 m0, s44, 18432
  s_nop 0
  buffer_load_dwordx4 v8, s[12:15], s41 offen  lds
  v_mfma_f32_16x16x32_bf16 a[152:155], v[94:97], v[130:133], a[152:155]
  v_mfma_f32_16x16x32_bf16 a[160:163], v[98:101], v[130:133], a[160:163]
  s_add_u32 m0, s44, 19456
  s_nop 0
  buffer_load_dwordx4 v9, s[12:15], s41 offen  lds
  s_add_u32 s41, s41, 524288
  v_mfma_f32_16x16x32_bf16 a[168:171], v[102:105], v[130:133], a[168:171]
  s_mul_i32 s44, s21, 4096
  s_add_u32 m0, s44, 32768
  s_nop 0
  buffer_load_dwordx4 v10, s[24:27], s42 offen  lds
  v_mfma_f32_16x16x32_bf16 a[176:179], v[106:109], v[130:133], a[176:179]
  s_add_u32 m0, s44, 33792
  s_nop 0
  buffer_load_dwordx4 v11, s[24:27], s42 offen  lds
  v_mfma_f32_16x16x32_bf16 a[184:187], v[110:113], v[130:133], a[184:187]
  v_mfma_f32_16x16x32_bf16 a[132:135], v[82:85], v[134:137], a[132:135]
  s_add_u32 m0, s44, 34816
  s_nop 0
  buffer_load_dwordx4 v12, s[24:27], s42 offen  lds
  v_mfma_f32_16x16x32_bf16 a[140:143], v[86:89], v[134:137], a[140:143]
  s_add_u32 m0, s44, 35840
  s_nop 0
  buffer_load_dwordx4 v13, s[24:27], s42 offen  lds
  s_add_u32 s42, s42, 524288
  v_mfma_f32_16x16x32_bf16 a[148:151], v[90:93], v[134:137], a[148:151]
  s_mul_i32 s44, s21, 4096
  s_add_u32 m0, s44, 49152
  s_nop 0
  buffer_load_dwordx4 v14, s[28:31], s43 offen  lds
  v_mfma_f32_16x16x32_bf16 a[156:159], v[94:97], v[134:137], a[156:159]
  v_mfma_f32_16x16x32_bf16 a[164:167], v[98:101], v[134:137], a[164:167]
  s_add_u32 m0, s44, 50176
  s_nop 0
  buffer_load_dwordx4 v15, s[28:31], s43 offen  lds
  v_mfma_f32_16x16x32_bf16 a[172:175], v[102:105], v[134:137], a[172:175]
  s_add_u32 m0, s44, 51200
  s_nop 0
  buffer_load_dwordx4 v16, s[28:31], s43 offen  lds
  v_mfma_f32_16x16x32_bf16 a[180:183], v[106:109], v[134:137], a[180:183]
  s_add_u32 m0, s44, 52224
  s_nop 0
  buffer_load_dwordx4 v17, s[28:31], s43 offen  lds
  s_add_u32 s43, s43, 524288
  v_mfma_f32_16x16x32_bf16 a[188:191], v[110:113], v[134:137], a[188:191]
  s_waitcnt lgkmcnt(0)
  v_mfma_f32_16x16x32_bf16 a[0:3], v[58:61], v[26:29], a[0:3]
  ds_read_b128 v[82:85], v18 offset:1024
  v_mfma_f32_16x16x32_bf16 a[8:11], v[58:61], v[30:33], a[8:11]
  ds_read_b128 v[86:89], v18 offset:3072
  v_mfma_f32_16x16x32_bf16 a[16:19], v[58:61], v[34:37], a[16:19]
  v_mfma_f32_16x16x32_bf16 a[24:27], v[58:61], v[38:41], a[24:27]
  ds_read_b128 v[90:93], v18 offset:5120
  v_mfma_f32_16x16x32_bf16 a[32:35], v[58:61], v[42:45], a[32:35]
  v_mfma_f32_16x16x32_bf16 a[40:43], v[58:61], v[46:49], a[40:43]
  ds_read_b128 v[94:97], v18 offset:7168
  v_mfma_f32_16x16x32_bf16 a[48:51], v[58:61], v[50:53], a[48:51]
  v_mfma_f32_16x16x32_bf16 a[56:59], v[58:61], v[54:57], a[56:59]
  ds_read_b128 v[98:101], v18 offset:9216
  v_mfma_f32_16x16x32_bf16 a[4:7], v[62:65], v[26:29], a[4:7]
  ds_read_b128 v[102:105], v18 offset:11264
  v_mfma_f32_16x16x32_bf16 a[12:15], v[62:65], v[30:33], a[12:15]
  v_mfma_f32_16x16x32_bf16 a[20:23], v[62:65], v[34:37], a[20:23]
  ds_read_b128 v[106:109], v18 offset:13312
  v_mfma_f32_16x16x32_bf16 a[28:31], v[62:65], v[38:41], a[28:31]
  v_mfma_f32_16x16x32_bf16 a[36:39], v[62:65], v[42:45], a[36:39]
  ds_read_b128 v[110:113], v18 offset:15360
  v_mfma_f32_16x16x32_bf16 a[44:47], v[62:65], v[46:49], a[44:47]
  v_mfma_f32_16x16x32_bf16 a[52:55], v[62:65], v[50:53], a[52:55]
  ds_read_b64_tr_b16 v[114:115], v19 offset:8192
  v_mfma_f32_16x16x32_bf16 a[60:63], v[62:65], v[54:57], a[60:63]
  v_mfma_f32_16x16x32_bf16 a[64:67], v[66:69], v[26:29], a[64:67]
  ds_read_b64_tr_b16 v[116:117], v19 offset:12288
  v_mfma_f32_16x16x32_bf16 a[72:75], v[66:69], v[30:33], a[72:75]
  ds_read_b64_tr_b16 v[118:119], v20 offset:8192
  v_mfma_f32_16x16x32_bf16 a[80:83], v[66:69], v[34:37], a[80:83]
  v_mfma_f32_16x16x32_bf16 a[88:91], v[66:69], v[38:41], a[88:91]
  ds_read_b64_tr_b16 v[120:121], v20 offset:12288
  v_mfma_f32_16x16x32_bf16 a[96:99], v[66:69], v[42:45], a[96:99]
  v_mfma_f32_16x16x32_bf16 a[104:107], v[66:69], v[46:49], a[104:107]
  ds_read_b64_tr_b16 v[122:123], v21 offset:8192
  v_mfma_f32_16x16x32_bf16 a[112:115], v[66:69], v[50:53], a[112:115]
  v_mfma_f32_16x16x32_bf16 a[120:123], v[66:69], v[54:57], a[120:123]
  ds_read_b64_tr_b16 v[124:125], v21 offset:12288
  v_mfma_f32_16x16x32_bf16 a[68:71], v[70:73], v[26:29], a[68:71]
  ds_read_b64_tr_b16 v[126:127], v22 offset:8192
  v_mfma_f32_16x16x32_bf16 a[76:79], v[70:73], v[30:33], a[76:79]
  v_mfma_f32_16x16x32_bf16 a[84:87], v[70:73], v[34:37], a[84:87]
  ds_read_b64_tr_b16 v[128:129], v22 offset:12288
  v_mfma_f32_16x16x32_bf16 a[92:95], v[70:73], v[38:41], a[92:95]
  v_mfma_f32_16x16x32_bf16 a[100:103], v[70:73], v[42:45], a[100:103]
  ds_read_b64_tr_b16 v[130:131], v23 offset:8192
  v_mfma_f32_16x16x32_bf16 a[108:111], v[70:73], v[46:49], a[108:111]
  v_mfma_f32_16x16x32_bf16 a[116:119], v[70:73], v[50:53], a[116:119]
  ds_read_b64_tr_b16 v[132:133], v23 offset:12288
  v_mfma_f32_16x16x32_bf16 a[124:127], v[70:73], v[54:57], a[124:127]
  v_mfma_f32_16x16x32_bf16 a[128:131], v[26:29], v[74:77], a[128:131]
  ds_read_b64_tr_b16 v[134:135], v24 offset:8192
  v_mfma_f32_16x16x32_bf16 a[136:139], v[30:33], v[74:77], a[136:139]
  ds_read_b64_tr_b16 v[136:137], v24 offset:12288
  v_mfma_f32_16x16x32_bf16 a[144:147], v[34:37], v[74:77], a[144:147]
  v_mfma_f32_16x16x32_bf16 a[152:155], v[38:41], v[74:77], a[152:155]
  v_add_u32 v18, 4294901760, v18
  v_mfma_f32_16x16x32_bf16 a[160:163], v[42:45], v[74:77], a[160:163]
  v_mfma_f32_16x16x32_bf16 a[168:171], v[46:49], v[74:77], a[168:171]
  v_add_u32 v19, 4294901760, v19
  v_mfma_f32_16x16x32_bf16 a[176:179], v[50:53], v[74:77], a[176:179]
  v_mfma_f32_16x16x32_bf16 a[184:187], v[54:57], v[74:77], a[184:187]
  v_add_u32 v20, 4294901760, v20
  v_mfma_f32_16x16x32_bf16 a[132:135], v[26:29], v[78:81], a[132:135]
  v_add_u32 v21, 4294901760, v21
  v_mfma_f32_16x16x32_bf16 a[140:143], v[30:33], v[78:81], a[140:143]
  v_mfma_f32_16x16x32_bf16 a[148:151], v[34:37], v[78:81], a[148:151]
  v_add_u32 v22, 4294901760, v22
  v_mfma_f32_16x16x32_bf16 a[156:159], v[38:41], v[78:81], a[156:159]
  v_mfma_f32_16x16x32_bf16 a[164:167], v[42:45], v[78:81], a[164:167]
  v_add_u32 v23, 4294901760, v23
  v_mfma_f32_16x16x32_bf16 a[172:175], v[46:49], v[78:81], a[172:175]
  v_mfma_f32_16x16x32_bf16 a[180:183], v[50:53], v[78:81], a[180:183]
  v_add_u32 v24, 4294901760, v24
  v_mfma_f32_16x16x32_bf16 a[188:191], v[54:57], v[78:81], a[188:191]
  s_waitcnt lgkmcnt(0)
  s_waitcnt vmcnt(0)
  s_barrier
  v_mfma_f32_16x16x32_bf16 a[0:3], v[114:117], v[82:85], a[0:3]
  ds_read_b128 v[26:29], v18 offset:0
  v_mfma_f32_16x16x32_bf16 a[8:11], v[114:117], v[86:89], a[8:11]
  ds_read_b128 v[30:33], v18 offset:2048
  v_mfma_f32_16x16x32_bf16 a[16:19], v[114:117], v[90:93], a[16:19]
  ds_read_b128 v[34:37], v18 offset:4096
  v_mfma_f32_16x16x32_bf16 a[24:27], v[114:117], v[94:97], a[24:27]
  v_mfma_f32_16x16x32_bf16 a[32:35], v[114:117], v[98:101], a[32:35]
  ds_read_b128 v[38:41], v18 offset:6144
  v_mfma_f32_16x16x32_bf16 a[40:43], v[114:117], v[102:105], a[40:43]
  ds_read_b128 v[42:45], v18 offset:8192
  v_mfma_f32_16x16x32_bf16 a[48:51], v[114:117], v[106:109], a[48:51]
  ds_read_b128 v[46:49], v18 offset:10240
  v_mfma_f32_16x16x32_bf16 a[56:59], v[114:117], v[110:113], a[56:59]
  v_mfma_f32_16x16x32_bf16 a[4:7], v[118:121], v[82:85], a[4:7]
  ds_read_b128 v[50:53], v18 offset:12288
  v_mfma_f32_16x16x32_bf16 a[12:15], v[118:121], v[86:89], a[12:15]
  ds_read_b128 v[54:57], v18 offset:14336
  v_mfma_f32_16x16x32_bf16 a[20:23], v[118:121], v[90:93], a[20:23]
  ds_read_b64_tr_b16 v[58:59], v19 offset:0
  v_mfma_f32_16x16x32_bf16 a[28:31], v[118:121], v[94:97], a[28:31]
  v_mfma_f32_16x16x32_bf16 a[36:39], v[118:121], v[98:101], a[36:39]
  ds_read_b64_tr_b16 v[60:61], v19 offset:4096
  v_mfma_f32_16x16x32_bf16 a[44:47], v[118:121], v[102:105], a[44:47]
  ds_read_b64_tr_b16 v[62:63], v20 offset:0
  v_mfma_f32_16x16x32_bf16 a[52:55], v[118:121], v[106:109], a[52:55]
  ds_read_b64_tr_b16 v[64:65], v20 offset:4096
  v_mfma_f32_16x16x32_bf16 a[60:63], v[118:121], v[110:113], a[60:63]
  v_mfma_f32_16x16x32_bf16 a[64:67], v[122:125], v[82:85], a[64:67]
  ds_read_b64_tr_b16 v[66:67], v21 offset:0
  v_mfma_f32_16x16x32_bf16 a[72:75], v[122:125], v[86:89], a[72:75]
  ds_read_b64_tr_b16 v[68:69], v21 offset:4096
  v_mfma_f32_16x16x32_bf16 a[80:83], v[122:125], v[90:93], a[80:83]
  ds_read_b64_tr_b16 v[70:71], v22 offset:0
  v_mfma_f32_16x16x32_bf16 a[88:91], v[122:125], v[94:97], a[88:91]
  v_mfma_f32_16x16x32_bf16 a[96:99], v[122:125], v[98:101], a[96:99]
  ds_read_b64_tr_b16 v[72:73], v22 offset:4096
  v_mfma_f32_16x16x32_bf16 a[104:107], v[122:125], v[102:105], a[104:107]
  ds_read_b64_tr_b16 v[74:75], v23 offset:0
  v_mfma_f32_16x16x32_bf16 a[112:115], v[122:125], v[106:109], a[112:115]
  ds_read_b64_tr_b16 v[76:77], v23 offset:4096
  v_mfma_f32_16x16x32_bf16 a[120:123], v[122:125], v[110:113], a[120:123]
  v_mfma_f32_16x16x32_bf16 a[68:71], v[126:129], v[82:85], a[68:71]
  ds_read_b64_tr_b16 v[78:79], v24 offset:0
  v_mfma_f32_16x16x32_bf16 a[76:79], v[126:129], v[86:89], a[76:79]
  ds_read_b64_tr_b16 v[80:81], v24 offset:4096
  v_mfma_f32_16x16x32_bf16 a[84:87], v[126:129], v[90:93], a[84:87]
  s_mul_i32 s44, s21, 4096
  s_add_u32 m0, s44, 65536
  s_nop 0
  buffer_load_dwordx4 v2, s[8:11], s40 offen sc1 lds
  v_mfma_f32_16x16x32_bf16 a[92:95], v[126:129], v[94:97], a[92:95]
  v_mfma_f32_16x16x32_bf16 a[100:103], v[126:129], v[98:101], a[100:103]
  s_add_u32 m0, s44, 66560
  s_nop 0
  buffer_load_dwordx4 v3, s[8:11], s40 offen sc1 lds
  v_mfma_f32_16x16x32_bf16 a[108:111], v[126:129], v[102:105], a[108:111]
  s_add_u32 m0, s44, 67584
  s_nop 0
  buffer_load_dwordx4 v4, s[8:11], s40 offen sc1 lds
  v_mfma_f32_16x16x32_bf16 a[116:119], v[126:129], v[106:109], a[116:119]
  s_add_u32 m0, s44, 68608
  s_nop 0
  buffer_load_dwordx4 v5, s[8:11], s40 offen sc1 lds
  s_add_u32 s40, s40, 2048
  v_mfma_f32_16x16x32_bf16 a[124:127], v[126:129], v[110:113], a[124:127]
  v_mfma_f32_16x16x32_bf16 a[128:131], v[82:85], v[130:133], a[128:131]
  s_mul_i32 s44, s21, 4096
  s_add_u32 m0, s44, 81920
  s_nop 0
  buffer_load_dwordx4 v6, s[12:15], s41 offen  lds
  v_mfma_f32_16x16x32_bf16 a[136:139], v[86:89], v[130:133], a[136:139]
  s_add_u32 m0, s44, 82944
  s_nop 0
  buffer_load_dwordx4 v7, s[12:15], s41 offen  lds
  v_mfma_f32_16x16x32_bf16 a[144:147], v[90:93], v[130:133], a[144:147]
  s_add_u32 m0, s44, 83968
  s_nop 0
  buffer_load_dwordx4 v8, s[12:15], s41 offen  lds
  v_mfma_f32_16x16x32_bf16 a[152:155], v[94:97], v[130:133], a[152:155]
  v_mfma_f32_16x16x32_bf16 a[160:163], v[98:101], v[130:133], a[160:163]
  s_add_u32 m0, s44, 84992
  s_nop 0
  buffer_load_dwordx4 v9, s[12:15], s41 offen  lds
  s_add_u32 s41, s41, 524288
  v_mfma_f32_16x16x32_bf16 a[168:171], v[102:105], v[130:133], a[168:171]
  s_mul_i32 s44, s21, 4096
  s_add_u32 m0, s44, 98304
  s_nop 0
  buffer_load_dwordx4 v10, s[24:27], s42 offen  lds
  v_mfma_f32_16x16x32_bf16 a[176:179], v[106:109], v[130:133], a[176:179]
  s_add_u32 m0, s44, 99328
  s_nop 0
  buffer_load_dwordx4 v11, s[24:27], s42 offen  lds
  v_mfma_f32_16x16x32_bf16 a[184:187], v[110:113], v[130:133], a[184:187]
  v_mfma_f32_16x16x32_bf16 a[132:135], v[82:85], v[134:137], a[132:135]
  s_add_u32 m0, s44, 100352
  s_nop 0
  buffer_load_dwordx4 v12, s[24:27], s42 offen  lds
  v_mfma_f32_16x16x32_bf16 a[140:143], v[86:89], v[134:137], a[140:143]
  s_add_u32 m0, s44, 101376
  s_nop 0
  buffer_load_dwordx4 v13, s[24:27], s42 offen  lds
  s_add_u32 s42, s42, 524288
  v_mfma_f32_16x16x32_bf16 a[148:151], v[90:93], v[134:137], a[148:151]
  s_mul_i32 s44, s21, 4096
  s_add_u32 m0, s44, 114688
  s_nop 0
  buffer_load_dwordx4 v14, s[28:31], s43 offen  lds
  v_mfma_f32_16x16x32_bf16 a[156:159], v[94:97], v[134:137], a[156:159]
  v_mfma_f32_16x16x32_bf16 a[164:167], v[98:101], v[134:137], a[164:167]
  s_add_u32 m0, s44, 115712
  s_nop 0
  buffer_load_dwordx4 v15, s[28:31], s43 offen  lds
  v_mfma_f32_16x16x32_bf16 a[172:175], v[102:105], v[134:137], a[172:175]
  s_add_u32 m0, s44, 116736
  s_nop 0
  buffer_load_dwordx4 v16, s[28:31], s43 offen  lds
  v_mfma_f32_16x16x32_bf16 a[180:183], v[106:109], v[134:137], a[180:183]
  s_add_u32 m0, s44, 117760
  s_nop 0
  buffer_load_dwordx4 v17, s[28:31], s43 offen  lds
  s_add_u32 s43, s43, 524288
  v_mfma_f32_16x16x32_bf16 a[188:191], v[110:113], v[134:137], a[188:191]
  s_sub_u32 s46, s46, 1
  s_cmp_lg_u32 s46, 0
  s_cbranch_scc1 GL_11
  s_waitcnt lgkmcnt(0)
  v_mfma_f32_16x16x32_bf16 a[0:3], v[58:61], v[26:29], a[0:3]
  ds_read_b128 v[82:85], v18 offset:1024
  v_mfma_f32_16x16x32_bf16 a[8:11], v[58:61], v[30:33], a[8:11]
  ds_read_b128 v[86:89], v18 offset:3072
  v_mfma_f32_16x16x32_bf16 a[16:19], v[58:61], v[34:37], a[16:19]
  v_mfma_f32_16x16x32_bf16 a[24:27], v[58:61], v[38:41], a[24:27]
  ds_read_b128 v[90:93], v18 offset:5120
  v_mfma_f32_16x16x32_bf16 a[32:35], v[58:61], v[42:45], a[32:35]
  v_mfma_f32_16x16x32_bf16 a[40:43], v[58:61], v[46:49], a[40:43]
  ds_read_b128 v[94:97], v18 offset:7168
  v_mfma_f32_16x16x32_bf16 a[48:51], v[58:61], v[50:53], a[48:51]
  v_mfma_f32_16x16x32_bf16 a[56:59], v[58:61], v[54:57], a[56:59]
  ds_read_b128 v[98:101], v18 offset:9216
  v_mfma_f32_16x16x32_bf16 a[4:7], v[62:65], v[26:29], a[4:7]
  ds_read_b128 v[102:105], v18 offset:11264
  v_mfma_f32_16x16x32_bf16 a[12:15], v[62:65], v[30:33], a[12:15]
  v_mfma_f32_16x16x32_bf16 a[20:23], v[62:65], v[34:37], a[20:23]
  ds_read_b128 v[106:109], v18 offset:13312
  v_mfma_f32_16x16x32_bf16 a[28:31], v[62:65], v[38:41], a[28:31]
  v_mfma_f32_16x16x32_bf16 a[36:39], v[62:65], v[42:45], a[36:39]
  ds_read_b128 v[110:113], v18 offset:15360
  v_mfma_f32_16x16x32_bf16 a[44:47], v[62:65], v[46:49], a[44:47]
  v_mfma_f32_16x16x32_bf16 a[52:55], v[62:65], v[50:53], a[52:55]
  ds_read_b64_tr_b16 v[114:115], v19 offset:8192
  v_mfma_f32_16x16x32_bf16 a[60:63], v[62:65], v[54:57], a[60:63]
  v_mfma_f32_16x16x32_bf16 a[64:67], v[66:69], v[26:29], a[64:67]
  ds_read_b64_tr_b16 v[116:117], v19 offset:12288
  v_mfma_f32_16x16x32_bf16 a[72:75], v[66:69], v[30:33], a[72:75]
  ds_read_b64_tr_b16 v[118:119], v20 offset:8192
  v_mfma_f32_16x16x32_bf16 a[80:83], v[66:69], v[34:37], a[80:83]
  v_mfma_f32_16x16x32_bf16 a[88:91], v[66:69], v[38:41], a[88:91]
  ds_read_b64_tr_b16 v[120:121], v20 offset:12288
  v_mfma_f32_16x16x32_bf16 a[96:99], v[66:69], v[42:45], a[96:99]
  v_mfma_f32_16x16x32_bf16 a[104:107], v[66:69], v[46:49], a[104:107]
  ds_read_b64_tr_b16 v[122:123], v21 offset:8192
  v_mfma_f32_16x16x32_bf16 a[112:115], v[66:69], v[50:53], a[112:115]
  v_mfma_f32_16x16x32_bf16 a[120:123], v[66:69], v[54:57], a[120:123]
  ds_read_b64_tr_b16 v[124:125], v21 offset:12288
  v_mfma_f32_16x16x32_bf16 a[68:71], v[70:73], v[26:29], a[68:71]
  ds_read_b64_tr_b16 v[126:127], v22 offset:8192
  v_mfma_f32_16x16x32_bf16 a[76:79], v[70:73], v[30:33], a[76:79]
  v_mfma_f32_16x16x32_bf16 a[84:87], v[70:73], v[34:37], a[84:87]
  ds_read_b64_tr_b16 v[128:129], v22 offset:12288
  v_mfma_f32_16x16x32_bf16 a[92:95], v[70:73], v[38:41], a[92:95]
  v_mfma_f32_16x16x32_bf16 a[100:103], v[70:73], v[42:45], a[100:103]
  ds_read_b64_tr_b16 v[130:131], v23 offset:8192
  v_mfma_f32_16x16x32_bf16 a[108:111], v[70:73], v[46:49], a[108:111]
  v_mfma_f32_16x16x32_bf16 a[116:119], v[70:73], v[50:53], a[116:119]
  ds_read_b64_tr_b16 v[132:133], v23 offset:12288
  v_mfma_f32_16x16x32_bf16 a[124:127], v[70:73], v[54:57], a[124:127]
  v_mfma_f32_16x16x32_bf16 a[128:131], v[26:29], v[74:77], a[128:131]
  ds_read_b64_tr_b16 v[134:135], v24 offset:8192
  v_mfma_f32_16x16x32_bf16 a[136:139], v[30:33], v[74:77], a[136:139]
  ds_read_b64_tr_b16 v[136:137], v24 offset:12288
  v_mfma_f32_16x16x32_bf16 a[144:147], v[34:37], v[74:77], a[144:147]
  v_mfma_f32_16x16x32_bf16 a[152:155], v[38:41], v[74:77], a[152:155]
  v_add_u32 v18, 65536, v18
  v_mfma_f32_16x16x32_bf16 a[160:163], v[42:45], v[74:77], a[160:163]
  v_mfma_f32_16x16x32_bf16 a[168:171], v[46:49], v[74:77], a[168:171]
  v_add_u32 v19, 65536, v19
  v_mfma_f32_16x16x32_bf16 a[176:179], v[50:53], v[74:77], a[176:179]
  v_mfma_f32_16x16x32_bf16 a[184:187], v[54:57], v[74:77], a[184:187]
  v_add_u32 v20, 65536, v20
  v_mfma_f32_16x16x32_bf16 a[132:135], v[26:29], v[78:81], a[132:135]
  v_add_u32 v21, 65536, v21
  v_mfma_f32_16x16x32_bf16 a[140:143], v[30:33], v[78:81], a[140:143]
  v_mfma_f32_16x16x32_bf16 a[148:151], v[34:37], v[78:81], a[148:151]
  v_add_u32 v22, 65536, v22
  v_mfma_f32_16x16x32_bf16 a[156:159], v[38:41], v[78:81], a[156:159]
  v_mfma_f32_16x16x32_bf16 a[164:167], v[42:45], v[78:81], a[164:167]
  v_add_u32 v23, 65536, v23
  v_mfma_f32_16x16x32_bf16 a[172:175], v[46:49], v[78:81], a[172:175]
  v_mfma_f32_16x16x32_bf16 a[180:183], v[50:53], v[78:81], a[180:183]
  v_add_u32 v24, 65536, v24
  v_mfma_f32_16x16x32_bf16 a[188:191], v[54:57], v[78:81], a[188:191]
  s_waitcnt lgkmcnt(0)
  s_waitcnt vmcnt(0)
  s_barrier
  v_mfma_f32_16x16x32_bf16 a[0:3], v[114:117], v[82:85], a[0:3]
  ds_read_b128 v[26:29], v18 offset:0
  v_mfma_f32_16x16x32_bf16 a[8:11], v[114:117], v[86:89], a[8:11]
  ds_read_b128 v[30:33], v18 offset:2048
  v_mfma_f32_16x16x32_bf16 a[16:19], v[114:117], v[90:93], a[16:19]
  ds_read_b128 v[34:37], v18 offset:4096
  v_mfma_f32_16x16x32_bf16 a[24:27], v[114:117], v[94:97], a[24:27]
  v_mfma_f32_16x16x32_bf16 a[32:35], v[114:117], v[98:101], a[32:35]
  ds_read_b128 v[38:41], v18 offset:6144
  v_mfma_f32_16x16x32_bf16 a[40:43], v[114:117], v[102:105], a[40:43]
  ds_read_b128 v[42:45], v18 offset:8192
  v_mfma_f32_16x16x32_bf16 a[48:51], v[114:117], v[106:109], a[48:51]
  ds_read_b128 v[46:49], v18 offset:10240
  v_mfma_f32_16x16x32_bf16 a[56:59], v[114:117], v[110:113], a[56:59]
  v_mfma_f32_16x16x32_bf16 a[4:7], v[118:121], v[82:85], a[4:7]
  ds_read_b128 v[50:53], v18 offset:12288
  v_mfma_f32_16x16x32_bf16 a[12:15], v[118:121], v[86:89], a[12:15]
  ds_read_b128 v[54:57], v18 offset:14336
  v_mfma_f32_16x16x32_bf16 a[20:23], v[118:121], v[90:93], a[20:23]
  ds_read_b64_tr_b16 v[58:59], v19 offset:0
  v_mfma_f32_16x16x32_bf16 a[28:31], v[118:121], v[94:97], a[28:31]
  v_mfma_f32_16x16x32_bf16 a[36:39], v[118:121], v[98:101], a[36:39]
  ds_read_b64_tr_b16 v[60:61], v19 offset:4096
  v_mfma_f32_16x16x32_bf16 a[44:47], v[118:121], v[102:105], a[44:47]
  ds_read_b64_tr_b16 v[62:63], v20 offset:0
  v_mfma_f32_16x16x32_bf16 a[52:55], v[118:121], v[106:109], a[52:55]
  ds_read_b64_tr_b16 v[64:65], v20 offset:4096
  v_mfma_f32_16x16x32_bf16 a[60:63], v[118:121], v[110:113], a[60:63]
  v_mfma_f32_16x16x32_bf16 a[64:67], v[122:125], v[82:85], a[64:67]
  ds_read_b64_tr_b16 v[66:67], v21 offset:0
  v_mfma_f32_16x16x32_bf16 a[72:75], v[122:125], v[86:89], a[72:75]
  ds_read_b64_tr_b16 v[68:69], v21 offset:4096
  v_mfma_f32_16x16x32_bf16 a[80:83], v[122:125], v[90:93], a[80:83]
  ds_read_b64_tr_b16 v[70:71], v22 offset:0
  v_mfma_f32_16x16x32_bf16 a[88:91], v[122:125], v[94:97], a[88:91]
  v_mfma_f32_16x16x32_bf16 a[96:99], v[122:125], v[98:101], a[96:99]
  ds_read_b64_tr_b16 v[72:73], v22 offset:4096
  v_mfma_f32_16x16x32_bf16 a[104:107], v[122:125], v[102:105], a[104:107]
  ds_read_b64_tr_b16 v[74:75], v23 offset:0
  v_mfma_f32_16x16x32_bf16 a[112:115], v[122:125], v[106:109], a[112:115]
  ds_read_b64_tr_b16 v[76:77], v23 offset:4096
  v_mfma_f32_16x16x32_bf16 a[120:123], v[122:125], v[110:113], a[120:123]
  v_mfma_f32_16x16x32_bf16 a[68:71], v[126:129], v[82:85], a[68:71]
  ds_read_b64_tr_b16 v[78:79], v24 offset:0
  v_mfma_f32_16x16x32_bf16 a[76:79], v[126:129], v[86:89], a[76:79]
  ds_read_b64_tr_b16 v[80:81], v24 offset:4096
  v_mfma_f32_16x16x32_bf16 a[84:87], v[126:129], v[90:93], a[84:87]
  s_mul_i32 s44, s21, 4096
  s_add_u32 m0, s44, 0
  s_nop 0
  buffer_load_dwordx4 v2, s[8:11], s40 offen sc1 lds
  v_mfma_f32_16x16x32_bf16 a[92:95], v[126:129], v[94:97], a[92:95]
  v_mfma_f32_16x16x32_bf16 a[100:103], v[126:129], v[98:101], a[100:103]
  s_add_u32 m0, s44, 1024
  s_nop 0
  buffer_load_dwordx4 v3, s[8:11], s40 offen sc1 lds
  v_mfma_f32_16x16x32_bf16 a[108:111], v[126:129], v[102:105], a[108:111]
  s_add_u32 m0, s44, 2048
  s_nop 0
  buffer_load_dwordx4 v4, s[8:11], s40 offen sc1 lds
  v_mfma_f32_16x16x32_bf16 a[116:119], v[126:129], v[106:109], a[116:119]
  s_add_u32 m0, s44, 3072
  s_nop 0
  buffer_load_dwordx4 v5, s[8:11], s40 offen sc1 lds
  s_add_u32 s40, s40, 2048
  v_mfma_f32_16x16x32_bf16 a[124:127], v[126:129], v[110:113], a[124:127]
  v_mfma_f32_16x16x32_bf16 a[128:131], v[82:85], v[130:133], a[128:131]
  s_mul_i32 s44, s21, 4096
  s_add_u32 m0, s44, 16384
  s_nop 0
  buffer_load_dwordx4 v6, s[12:15], s41 offen  lds
  v_mfma_f32_16x16x32_bf16 a[136:139], v[86:89], v[130:133], a[136:139]
  s_add_u32 m0, s44, 17408
  s_nop 0
  buffer_load_dwordx4 v7, s[12:15], s41 offen  lds
  v_mfma_f32_16x16x32_bf16 a[144:147], v[90:93], v[130:133], a[144:147]
  s_add_u32 m0, s44, 18432
  s_nop 0
  buffer_load_dwordx4 v8, s[12:15], s41 offen  lds
  v_mfma_f32_16x16x32_bf16 a[152:155], v[94:97], v[130:133], a[152:155]
  v_mfma_f32_16x16x32_bf16 a[160:163], v[98:101], v[130:133], a[160:163]
  s_add_u32 m0, s44, 19456
  s_nop 0
  buffer_load_dwordx4 v9, s[12:15], s41 offen  lds
  s_add_u32 s41, s41, 524288
  v_mfma_f32_16x16x32_bf16 a[168:171], v[102:105], v[130:133], a[168:171]
  s_mul_i32 s44, s21, 4096
  s_add_u32 m0, s44, 32768
  s_nop 0
  buffer_load_dwordx4 v10, s[24:27], s42 offen  lds
  v_mfma_f32_16x16x32_bf16 a[176:179], v[106:109], v[130:133], a[176:179]
  s_add_u32 m0, s44, 33792
  s_nop 0
  buffer_load_dwordx4 v11, s[24:27], s42 offen  lds
  v_mfma_f32_16x16x32_bf16 a[184:187], v[110:113], v[130:133], a[184:187]
  v_mfma_f32_16x16x32_bf16 a[132:135], v[82:85], v[134:137], a[132:135]
  s_add_u32 m0, s44, 34816
  s_nop 0
  buffer_load_dwordx4 v12, s[24:27], s42 offen  lds
  v_mfma_f32_16x16x32_bf16 a[140:143], v[86:89], v[134:137], a[140:143]
  s_add_u32 m0, s44, 35840
  s_nop 0
  buffer_load_dwordx4 v13, s[24:27], s42 offen  lds
  s_add_u32 s42, s42, 524288
  v_mfma_f32_16x16x32_bf16 a[148:151], v[90:93], v[134:137], a[148:151]
  s_mul_i32 s44, s21, 4096
  s_add_u32 m0, s44, 49152
  s_nop 0
  buffer_load_dwordx4 v14, s[28:31], s43 offen  lds
  v_mfma_f32_16x16x32_bf16 a[156:159], v[94:97], v[134:137], a[156:159]
  v_mfma_f32_16x16x32_bf16 a[164:167], v[98:101], v[134:137], a[164:167]
  s_add_u32 m0, s44, 50176
  s_nop 0
  buffer_load_dwordx4 v15, s[28:31], s43 offen  lds
  v_mfma_f32_16x16x32_bf16 a[172:175], v[102:105], v[134:137], a[172:175]
  s_add_u32 m0, s44, 51200
  s_nop 0
  buffer_load_dwordx4 v16, s[28:31], s43 offen  lds
  v_mfma_f32_16x16x32_bf16 a[180:183], v[106:109], v[134:137], a[180:183]
  s_add_u32 m0, s44, 52224
  s_nop 0
  buffer_load_dwordx4 v17, s[28:31], s43 offen  lds
  s_add_u32 s43, s43, 524288
  v_mfma_f32_16x16x32_bf16 a[188:191], v[110:113], v[134:137], a[188:191]
  s_waitcnt lgkmcnt(0)
  v_mfma_f32_16x16x32_bf16 a[0:3], v[58:61], v[26:29], a[0:3]
  ds_read_b128 v[82:85], v18 offset:1024
  v_mfma_f32_16x16x32_bf16 a[8:11], v[58:61], v[30:33], a[8:11]
  ds_read_b128 v[86:89], v18 offset:3072
  v_mfma_f32_16x16x32_bf16 a[16:19], v[58:61], v[34:37], a[16:19]
  v_mfma_f32_16x16x32_bf16 a[24:27], v[58:61], v[38:41], a[24:27]
  ds_read_b128 v[90:93], v18 offset:5120
  v_mfma_f32_16x16x32_bf16 a[32:35], v[58:61], v[42:45], a[32:35]
  v_mfma_f32_16x16x32_bf16 a[40:43], v[58:61], v[46:49], a[40:43]
  ds_read_b128 v[94:97], v18 offset:7168
  v_mfma_f32_16x16x32_bf16 a[48:51], v[58:61], v[50:53], a[48:51]
  v_mfma_f32_16x16x32_bf16 a[56:59], v[58:61], v[54:57], a[56:59]
  ds_read_b128 v[98:101], v18 offset:9216
  v_mfma_f32_16x16x32_bf16 a[4:7], v[62:65], v[26:29], a[4:7]
  ds_read_b128 v[102:105], v18 offset:11264
  v_mfma_f32_16x16x32_bf16 a[12:15], v[62:65], v[30:33], a[12:15]
  v_mfma_f32_16x16x32_bf16 a[20:23], v[62:65], v[34:37], a[20:23]
  ds_read_b128 v[106:109], v18 offset:13312
  v_mfma_f32_16x16x32_bf16 a[28:31], v[62:65], v[38:41], a[28:31]
  v_mfma_f32_16x16x32_bf16 a[36:39], v[62:65], v[42:45], a[36:39]
  ds_read_b128 v[110:113], v18 offset:15360
  v_mfma_f32_16x16x32_bf16 a[44:47], v[62:65], v[46:49], a[44:47]
  v_mfma_f32_16x16x32_bf16 a[52:55], v[62:65], v[50:53], a[52:55]
  ds_read_b64_tr_b16 v[114:115], v19 offset:8192
  v_mfma_f32_16x16x32_bf16 a[60:63], v[62:65], v[54:57], a[60:63]
  v_mfma_f32_16x16x32_bf16 a[64:67], v[66:69], v[26:29], a[64:67]
  ds_read_b64_tr_b16 v[116:117], v19 offset:12288
  v_mfma_f32_16x16x32_bf16 a[72:75], v[66:69], v[30:33], a[72:75]
  ds_read_b64_tr_b16 v[118:119], v20 offset:8192
  v_mfma_f32_16x16x32_bf16 a[80:83], v[66:69], v[34:37], a[80:83]
  v_mfma_f32_16x16x32_bf16 a[88:91], v[66:69], v[38:41], a[88:91]
  ds_read_b64_tr_b16 v[120:121], v20 offset:12288
  v_mfma_f32_16x16x32_bf16 a[96:99], v[66:69], v[42:45], a[96:99]
  v_mfma_f32_16x16x32_bf16 a[104:107], v[66:69], v[46:49], a[104:107]
  ds_read_b64_tr_b16 v[122:123], v21 offset:8192
  v_mfma_f32_16x16x32_bf16 a[112:115], v[66:69], v[50:53], a[112:115]
  v_mfma_f32_16x16x32_bf16 a[120:123], v[66:69], v[54:57], a[120:123]
  ds_read_b64_tr_b16 v[124:125], v21 offset:12288
  v_mfma_f32_16x16x32_bf16 a[68:71], v[70:73], v[26:29], a[68:71]
  ds_read_b64_tr_b16 v[126:127], v22 offset:8192
  v_mfma_f32_16x16x32_bf16 a[76:79], v[70:73], v[30:33], a[76:79]
  v_mfma_f32_16x16x32_bf16 a[84:87], v[70:73], v[34:37], a[84:87]
  ds_read_b64_tr_b16 v[128:129], v22 offset:12288
  v_mfma_f32_16x16x32_bf16 a[92:95], v[70:73], v[38:41], a[92:95]
  v_mfma_f32_16x16x32_bf16 a[100:103], v[70:73], v[42:45], a[100:103]
  ds_read_b64_tr_b16 v[130:131], v23 offset:8192
  v_mfma_f32_16x16x32_bf16 a[108:111], v[70:73], v[46:49], a[108:111]
  v_mfma_f32_16x16x32_bf16 a[116:119], v[70:73], v[50:53], a[116:119]
  ds_read_b64_tr_b16 v[132:133], v23 offset:12288
  v_mfma_f32_16x16x32_bf16 a[124:127], v[70:73], v[54:57], a[124:127]
  v_mfma_f32_16x16x32_bf16 a[128:131], v[26:29], v[74:77], a[128:131]
  ds_read_b64_tr_b16 v[134:135], v24 offset:8192
  v_mfma_f32_16x16x32_bf16 a[136:139], v[30:33], v[74:77], a[136:139]
  ds_read_b64_tr_b16 v[136:137], v24 offset:12288
  v_mfma_f32_16x16x32_bf16 a[144:147], v[34:37], v[74:77], a[144:147]
  v_mfma_f32_16x16x32_bf16 a[152:155], v[38:41], v[74:77], a[152:155]
  v_add_u32 v18, 4294901760, v18
  v_mfma_f32_16x16x32_bf16 a[160:163], v[42:45], v[74:77], a[160:163]
  v_mfma_f32_16x16x32_bf16 a[168:171], v[46:49], v[74:77], a[168:171]
  v_add_u32 v19, 4294901760, v19
  v_mfma_f32_16x16x32_bf16 a[176:179], v[50:53], v[74:77], a[176:179]
  v_mfma_f32_16x16x32_bf16 a[184:187], v[54:57], v[74:77], a[184:187]
  v_add_u32 v20, 4294901760, v20
  v_mfma_f32_16x16x32_bf16 a[132:135], v[26:29], v[78:81], a[132:135]
  v_add_u32 v21, 4294901760, v21
  v_mfma_f32_16x16x32_bf16 a[140:143], v[30:33], v[78:81], a[140:143]
  v_mfma_f32_16x16x32_bf16 a[148:151], v[34:37], v[78:81], a[148:151]
  v_add_u32 v22, 4294901760, v22
  v_mfma_f32_16x16x32_bf16 a[156:159], v[38:41], v[78:81], a[156:159]
  v_mfma_f32_16x16x32_bf16 a[164:167], v[42:45], v[78:81], a[164:167]
  v_add_u32 v23, 4294901760, v23
  v_mfma_f32_16x16x32_bf16 a[172:175], v[46:49], v[78:81], a[172:175]
  v_mfma_f32_16x16x32_bf16 a[180:183], v[50:53], v[78:81], a[180:183]
  v_add_u32 v24, 4294901760, v24
  v_mfma_f32_16x16x32_bf16 a[188:191], v[54:57], v[78:81], a[188:191]
  s_waitcnt lgkmcnt(0)
  s_waitcnt vmcnt(0)
  s_barrier
  v_mfma_f32_16x16x32_bf16 a[0:3], v[114:117], v[82:85], a[0:3]
  ds_read_b128 v[26:29], v18 offset:0
  v_mfma_f32_16x16x32_bf16 a[8:11], v[114:117], v[86:89], a[8:11]
  v_mfma_f32_16x16x32_bf16 a[16:19], v[114:117], v[90:93], a[16:19]
  ds_read_b128 v[30:33], v18 offset:2048
  v_mfma_f32_16x16x32_bf16 a[24:27], v[114:117], v[94:97], a[24:27]
  v_mfma_f32_16x16x32_bf16 a[32:35], v[114:117], v[98:101], a[32:35]
  ds_read_b128 v[34:37], v18 offset:4096
  v_mfma_f32_16x16x32_bf16 a[40:43], v[114:117], v[102:105], a[40:43]
  v_mfma_f32_16x16x32_bf16 a[48:51], v[114:117], v[106:109], a[48:51]
  v_mfma_f32_16x16x32_bf16 a[56:59], v[114:117], v[110:113], a[56:59]
  ds_read_b128 v[38:41], v18 offset:6144
  v_mfma_f32_16x16x32_bf16 a[4:7], v[118:121], v[82:85], a[4:7]
  v_mfma_f32_16x16x32_bf16 a[12:15], v[118:121], v[86:89], a[12:15]
  ds_read_b128 v[42:45], v18 offset:8192
  v_mfma_f32_16x16x32_bf16 a[20:23], v[118:121], v[90:93], a[20:23]
  v_mfma_f32_16x16x32_bf16 a[28:31], v[118:121], v[94:97], a[28:31]
  v_mfma_f32_16x16x32_bf16 a[36:39], v[118:121], v[98:101], a[36:39]
  ds_read_b128 v[46:49], v18 offset:10240
  v_mfma_f32_16x16x32_bf16 a[44:47], v[118:121], v[102:105], a[44:47]
  v_mfma_f32_16x16x32_bf16 a[52:55], v[118:121], v[106:109], a[52:55]
  ds_read_b128 v[50:53], v18 offset:12288
  v_mfma_f32_16x16x32_bf16 a[60:63], v[118:121], v[110:113], a[60:63]
  v_mfma_f32_16x16x32_bf16 a[64:67], v[122:125], v[82:85], a[64:67]
  ds_read_b128 v[54:57], v18 offset:14336
  v_mfma_f32_16x16x32_bf16 a[72:75], v[122:125], v[86:89], a[72:75]
  v_mfma_f32_16x16x32_bf16 a[80:83], v[122:125], v[90:93], a[80:83]
  v_mfma_f32_16x16x32_bf16 a[88:91], v[122:125], v[94:97], a[88:91]
  ds_read_b64_tr_b16 v[58:59], v19 offset:0
  v_mfma_f32_16x16x32_bf16 a[96:99], v[122:125], v[98:101], a[96:99]
  v_mfma_f32_16x16x32_bf16 a[104:107], v[122:125], v[102:105], a[104:107]
  ds_read_b64_tr_b16 v[60:61], v19 offset:4096
  v_mfma_f32_16x16x32_bf16 a[112:115], v[122:125], v[106:109], a[112:115]
  v_mfma_f32_16x16x32_bf16 a[120:123], v[122:125], v[110:113], a[120:123]
  v_mfma_f32_16x16x32_bf16 a[68:71], v[126:129], v[82:85], a[68:71]
  ds_read_b64_tr_b16 v[62:63], v20 offset:0
  v_mfma_f32_16x16x32_bf16 a[76:79], v[126:129], v[86:89], a[76:79]
  v_mfma_f32_16x16x32_bf16 a[84:87], v[126:129], v[90:93], a[84:87]
  ds_read_b64_tr_b16 v[64:65], v20 offset:4096
  v_mfma_f32_16x16x32_bf16 a[92:95], v[126:129], v[94:97], a[92:95]
  v_mfma_f32_16x16x32_bf16 a[100:103], v[126:129], v[98:101], a[100:103]
  ds_read_b64_tr_b16 v[66:67], v21 offset:0
  v_mfma_f32_16x16x32_bf16 a[108:111], v[126:129], v[102:105], a[108:111]
  v_mfma_f32_16x16x32_bf16 a[116:119], v[126:129], v[106:109], a[116:119]
  v_mfma_f32_16x16x32_bf16 a[124:127], v[126:129], v[110:113], a[124:127]
  ds_read_b64_tr_b16 v[68:69], v21 offset:4096
  v_mfma_f32_16x16x32_bf16 a[128:131], v[82:85], v[130:133], a[128:131]
  v_mfma_f32_16x16x32_bf16 a[136:139], v[86:89], v[130:133], a[136:139]
  ds_read_b64_tr_b16 v[70:71], v22 offset:0
  v_mfma_f32_16x16x32_bf16 a[144:147], v[90:93], v[130:133], a[144:147]
  v_mfma_f32_16x16x32_bf16 a[152:155], v[94:97], v[130:133], a[152:155]
  v_mfma_f32_16x16x32_bf16 a[160:163], v[98:101], v[130:133], a[160:163]
  ds_read_b64_tr_b16 v[72:73], v22 offset:4096
  v_mfma_f32_16x16x32_bf16 a[168:171], v[102:105], v[130:133], a[168:171]
  v_mfma_f32_16x16x32_bf16 a[176:179], v[106:109], v[130:133], a[176:179]
  ds_read_b64_tr_b16 v[74:75], v23 offset:0
  v_mfma_f32_16x16x32_bf16 a[184:187], v[110:113], v[130:133], a[184:187]
  v_mfma_f32_16x16x32_bf16 a[132:135], v[82:85], v[134:137], a[132:135]
  ds_read_b64_tr_b16 v[76:77], v23 offset:4096
  v_mfma_f32_16x16x32_bf16 a[140:143], v[86:89], v[134:137], a[140:143]
  v_mfma_f32_16x16x32_bf16 a[148:151], v[90:93], v[134:137], a[148:151]
  v_mfma_f32_16x16x32_bf16 a[156:159], v[94:97], v[134:137], a[156:159]
  ds_read_b64_tr_b16 v[78:79], v24 offset:0
  v_mfma_f32_16x16x32_bf16 a[164:167], v[98:101], v[134:137], a[164:167]
  v_mfma_f32_16x16x32_bf16 a[172:175], v[102:105], v[134:137], a[172:175]
  ds_read_b64_tr_b16 v[80:81], v24 offset:4096
  v_mfma_f32_16x16x32_bf16 a[180:183], v[106:109], v[134:137], a[180:183]
  v_mfma_f32_16x16x32_bf16 a[188:191], v[110:113], v[134:137], a[188:191]
  s_waitcnt lgkmcnt(0)
  v_mfma_f32_16x16x32_bf16 a[0:3], v[58:61], v[26:29], a[0:3]
  ds_read_b128 v[82:85], v18 offset:1024
  v_mfma_f32_16x16x32_bf16 a[8:11], v[58:61], v[30:33], a[8:11]
  ds_read_b128 v[86:89], v18 offset:3072
  v_mfma_f32_16x16x32_bf16 a[16:19], v[58:61], v[34:37], a[16:19]
  v_mfma_f32_16x16x32_bf16 a[24:27], v[58:61], v[38:41], a[24:27]
  ds_read_b128 v[90:93], v18 offset:5120
  v_mfma_f32_16x16x32_bf16 a[32:35], v[58:61], v[42:45], a[32:35]
  v_mfma_f32_16x16x32_bf16 a[40:43], v[58:61], v[46:49], a[40:43]
  ds_read_b128 v[94:97], v18 offset:7168
  v_mfma_f32_16x16x32_bf16 a[48:51], v[58:61], v[50:53], a[48:51]
  v_mfma_f32_16x16x32_bf16 a[56:59], v[58:61], v[54:57], a[56:59]
  ds_read_b128 v[98:101], v18 offset:9216
  v_mfma_f32_16x16x32_bf16 a[4:7], v[62:65], v[26:29], a[4:7]
  ds_read_b128 v[102:105], v18 offset:11264
  v_mfma_f32_16x16x32_bf16 a[12:15], v[62:65], v[30:33], a[12:15]
  v_mfma_f32_16x16x32_bf16 a[20:23], v[62:65], v[34:37], a[20:23]
  ds_read_b128 v[106:109], v18 offset:13312
  v_mfma_f32_16x16x32_bf16 a[28:31], v[62:65], v[38:41], a[28:31]
  v_mfma_f32_16x16x32_bf16 a[36:39], v[62:65], v[42:45], a[36:39]
  ds_read_b128 v[110:113], v18 offset:15360
  v_mfma_f32_16x16x32_bf16 a[44:47], v[62:65], v[46:49], a[44:47]
  v_mfma_f32_16x16x32_bf16 a[52:55], v[62:65], v[50:53], a[52:55]
  ds_read_b64_tr_b16 v[114:115], v19 offset:8192
  v_mfma_f32_16x16x32_bf16 a[60:63], v[62:65], v[54:57], a[60:63]
  v_mfma_f32_16x16x32_bf16 a[64:67], v[66:69], v[26:29], a[64:67]
  ds_read_b64_tr_b16 v[116:117], v19 offset:12288
  v_mfma_f32_16x16x32_bf16 a[72:75], v[66:69], v[30:33], a[72:75]
  ds_read_b64_tr_b16 v[118:119], v20 offset:8192
  v_mfma_f32_16x16x32_bf16 a[80:83], v[66:69], v[34:37], a[80:83]
  v_mfma_f32_16x16x32_bf16 a[88:91], v[66:69], v[38:41], a[88:91]
  ds_read_b64_tr_b16 v[120:121], v20 offset:12288
  v_mfma_f32_16x16x32_bf16 a[96:99], v[66:69], v[42:45], a[96:99]
  v_mfma_f32_16x16x32_bf16 a[104:107], v[66:69], v[46:49], a[104:107]
  ds_read_b64_tr_b16 v[122:123], v21 offset:8192
  v_mfma_f32_16x16x32_bf16 a[112:115], v[66:69], v[50:53], a[112:115]
  v_mfma_f32_16x16x32_bf16 a[120:123], v[66:69], v[54:57], a[120:123]
  ds_read_b64_tr_b16 v[124:125], v21 offset:12288
  v_mfma_f32_16x16x32_bf16 a[68:71], v[70:73], v[26:29], a[68:71]
  ds_read_b64_tr_b16 v[126:127], v22 offset:8192
  v_mfma_f32_16x16x32_bf16 a[76:79], v[70:73], v[30:33], a[76:79]
  v_mfma_f32_16x16x32_bf16 a[84:87], v[70:73], v[34:37], a[84:87]
  ds_read_b64_tr_b16 v[128:129], v22 offset:12288
  v_mfma_f32_16x16x32_bf16 a[92:95], v[70:73], v[38:41], a[92:95]
  v_mfma_f32_16x16x32_bf16 a[100:103], v[70:73], v[42:45], a[100:103]
  ds_read_b64_tr_b16 v[130:131], v23 offset:8192
  v_mfma_f32_16x16x32_bf16 a[108:111], v[70:73], v[46:49], a[108:111]
  v_mfma_f32_16x16x32_bf16 a[116:119], v[70:73], v[50:53], a[116:119]
  ds_read_b64_tr_b16 v[132:133], v23 offset:12288
  v_mfma_f32_16x16x32_bf16 a[124:127], v[70:73], v[54:57], a[124:127]
  v_mfma_f32_16x16x32_bf16 a[128:131], v[26:29], v[74:77], a[128:131]
  ds_read_b64_tr_b16 v[134:135], v24 offset:8192
  v_mfma_f32_16x16x32_bf16 a[136:139], v[30:33], v[74:77], a[136:139]
  ds_read_b64_tr_b16 v[136:137], v24 offset:12288
  v_mfma_f32_16x16x32_bf16 a[144:147], v[34:37], v[74:77], a[144:147]
  v_mfma_f32_16x16x32_bf16 a[152:155], v[38:41], v[74:77], a[152:155]
  v_add_u32 v18, 65536, v18
  v_mfma_f32_16x16x32_bf16 a[160:163], v[42:45], v[74:77], a[160:163]
  v_mfma_f32_16x16x32_bf16 a[168:171], v[46:49], v[74:77], a[168:171]
  v_add_u32 v19, 65536, v19
  v_mfma_f32_16x16x32_bf16 a[176:179], v[50:53], v[74:77], a[176:179]
  v_mfma_f32_16x16x32_bf16 a[184:187], v[54:57], v[74:77], a[184:187]
  v_add_u32 v20, 65536, v20
  v_mfma_f32_16x16x32_bf16 a[132:135], v[26:29], v[78:81], a[132:135]
  v_add_u32 v21, 65536, v21
  v_mfma_f32_16x16x32_bf16 a[140:143], v[30:33], v[78:81], a[140:143]
  v_mfma_f32_16x16x32_bf16 a[148:151], v[34:37], v[78:81], a[148:151]
  v_add_u32 v22, 65536, v22
  v_mfma_f32_16x16x32_bf16 a[156:159], v[38:41], v[78:81], a[156:159]
  v_mfma_f32_16x16x32_bf16 a[164:167], v[42:45], v[78:81], a[164:167]
  v_add_u32 v23, 65536, v23
  v_mfma_f32_16x16x32_bf16 a[172:175], v[46:49], v[78:81], a[172:175]
  v_mfma_f32_16x16x32_bf16 a[180:183], v[50:53], v[78:81], a[180:183]
  v_add_u32 v24, 65536, v24
  v_mfma_f32_16x16x32_bf16 a[188:191], v[54:57], v[78:81], a[188:191]
  s_waitcnt lgkmcnt(0)
  v_mfma_f32_16x16x32_bf16 a[0:3], v[114:117], v[82:85], a[0:3]
  v_mfma_f32_16x16x32_bf16 a[8:11], v[114:117], v[86:89], a[8:11]
  v_mfma_f32_16x16x32_bf16 a[16:19], v[114:117], v[90:93], a[16:19]
  v_mfma_f32_16x16x32_bf16 a[24:27], v[114:117], v[94:97], a[24:27]
  v_mfma_f32_16x16x32_bf16 a[32:35], v[114:117], v[98:101], a[32:35]
  v_mfma_f32_16x16x32_bf16 a[40:43], v[114:117], v[102:105], a[40:43]
  v_mfma_f32_16x16x32_bf16 a[48:51], v[114:117], v[106:109], a[48:51]
  v_mfma_f32_16x16x32_bf16 a[56:59], v[114:117], v[110:113], a[56:59]
  v_mfma_f32_16x16x32_bf16 a[4:7], v[118:121], v[82:85], a[4:7]
  v_mfma_f32_16x16x32_bf16 a[12:15], v[118:121], v[86:89], a[12:15]
  v_mfma_f32_16x16x32_bf16 a[20:23], v[118:121], v[90:93], a[20:23]
  v_mfma_f32_16x16x32_bf16 a[28:31], v[118:121], v[94:97], a[28:31]
  v_mfma_f32_16x16x32_bf16 a[36:39], v[118:121], v[98:101], a[36:39]
  v_mfma_f32_16x16x32_bf16 a[44:47], v[118:121], v[102:105], a[44:47]
  v_mfma_f32_16x16x32_bf16 a[52:55], v[118:121], v[106:109], a[52:55]
  v_mfma_f32_16x16x32_bf16 a[60:63], v[118:121], v[110:113], a[60:63]
  v_mfma_f32_16x16x32_bf16 a[64:67], v[122:125], v[82:85], a[64:67]
  v_mfma_f32_16x16x32_bf16 a[72:75], v[122:125], v[86:89], a[72:75]
  v_mfma_f32_16x16x32_bf16 a[80:83], v[122:125], v[90:93], a[80:83]
  v_mfma_f32_16x16x32_bf16 a[88:91], v[122:125], v[94:97], a[88:91]
  v_mfma_f32_16x16x32_bf16 a[96:99], v[122:125], v[98:101], a[96:99]
  v_mfma_f32_16x16x32_bf16 a[104:107], v[122:125], v[102:105], a[104:107]
  v_mfma_f32_16x16x32_bf16 a[112:115], v[122:125], v[106:109], a[112:115]
  v_mfma_f32_16x16x32_bf16 a[120:123], v[122:125], v[110:113], a[120:123]
  v_mfma_f32_16x16x32_bf16 a[68:71], v[126:129], v[82:85], a[68:71]
  v_mfma_f32_16x16x32_bf16 a[76:79], v[126:129], v[86:89], a[76:79]
  v_mfma_f32_16x16x32_bf16 a[84:87], v[126:129], v[90:93], a[84:87]
  v_mfma_f32_16x16x32_bf16 a[92:95], v[126:129], v[94:97], a[92:95]
  v_mfma_f32_16x16x32_bf16 a[100:103], v[126:129], v[98:101], a[100:103]
  v_mfma_f32_16x16x32_bf16 a[108:111], v[126:129], v[102:105], a[108:111]
  v_mfma_f32_16x16x32_bf16 a[116:119], v[126:129], v[106:109], a[116:119]
  v_mfma_f32_16x16x32_bf16 a[124:127], v[126:129], v[110:113], a[124:127]
  v_mfma_f32_16x16x32_bf16 a[128:131], v[82:85], v[130:133], a[128:131]
  v_mfma_f32_16x16x32_bf16 a[136:139], v[86:89], v[130:133], a[136:139]
  v_mfma_f32_16x16x32_bf16 a[144:147], v[90:93], v[130:133], a[144:147]
  v_mfma_f32_16x16x32_bf16 a[152:155], v[94:97], v[130:133], a[152:155]
  v_mfma_f32_16x16x32_bf16 a[160:163], v[98:101], v[130:133], a[160:163]
  v_mfma_f32_16x16x32_bf16 a[168:171], v[102:105], v[130:133], a[168:171]
  v_mfma_f32_16x16x32_bf16 a[176:179], v[106:109], v[130:133], a[176:179]
  v_mfma_f32_16x16x32_bf16 a[184:187], v[110:113], v[130:133], a[184:187]
  v_mfma_f32_16x16x32_bf16 a[132:135], v[82:85], v[134:137], a[132:135]
  v_mfma_f32_16x16x32_bf16 a[140:143], v[86:89], v[134:137], a[140:143]
  v_mfma_f32_16x16x32_bf16 a[148:151], v[90:93], v[134:137], a[148:151]
  v_mfma_f32_16x16x32_bf16 a[156:159], v[94:97], v[134:137], a[156:159]
  v_mfma_f32_16x16x32_bf16 a[164:167], v[98:101], v[134:137], a[164:167]
  v_mfma_f32_16x16x32_bf16 a[172:175], v[102:105], v[134:137], a[172:175]
  v_mfma_f32_16x16x32_bf16 a[180:183], v[106:109], v[134:137], a[180:183]
  v_mfma_f32_16x16x32_bf16 a[188:191], v[110:113], v[134:137], a[188:191]
  v_subrev_u32 v18, 65536, v18
  v_subrev_u32 v19, 65536, v19
  v_subrev_u32 v20, 65536, v20
  v_subrev_u32 v21, 65536, v21
  v_subrev_u32 v22, 65536, v22
  v_subrev_u32 v23, 65536, v23
  v_subrev_u32 v24, 65536, v24
  s_lshl_b32 s22, s22, 20
  s_lshl_b32 s23, s23, 13
  s_add_u32 s22, s22, s23
  s_lshl_b32 s23, s21, 11
  s_add_u32 s22, s22, s23
  s_nop 7
  s_add_u32 s44, s22, 20971520
  v_accvgpr_read_b32 v26, a64
  v_accvgpr_read_b32 v27, a65
  v_accvgpr_read_b32 v28, a66
  v_accvgpr_read_b32 v29, a67
  v_accvgpr_read_b32 v30, a68
  v_accvgpr_read_b32 v31, a69
  v_accvgpr_read_b32 v32, a70
  v_accvgpr_read_b32 v33, a71
  v_cvt_pk_bf16_f32 v34, v26, v27
  v_cvt_pk_bf16_f32 v35, v28, v29
  v_cvt_pk_bf16_f32 v36, v30, v31
  v_cvt_pk_bf16_f32 v37, v32, v33
  buffer_store_dwordx4 v[34:37], v1, s[8:11], s44 offen offset:0 sc1
  v_accvgpr_read_b32 v38, a72
  v_accvgpr_read_b32 v39, a73
  v_accvgpr_read_b32 v40, a74
  v_accvgpr_read_b32 v41, a75
  v_accvgpr_read_b32 v42, a76
  v_accvgpr_read_b32 v43, a77
  v_accvgpr_read_b32 v44, a78
  v_accvgpr_read_b32 v45, a79
  v_cvt_pk_bf16_f32 v46, v38, v39
  v_cvt_pk_bf16_f32 v47, v40, v41
  v_cvt_pk_bf16_f32 v48, v42, v43
  v_cvt_pk_bf16_f32 v49, v44, v45
  buffer_store_dwordx4 v[46:49], v1, s[8:11], s44 offen offset:1024 sc1
  s_add_u32 s44, s22, 21233664
  v_accvgpr_read_b32 v50, a80
  v_accvgpr_read_b32 v51, a81
  v_accvgpr_read_b32 v52, a82
  v_accvgpr_read_b32 v53, a83
  v_accvgpr_read_b32 v54, a84
  v_accvgpr_read_b32 v55, a85
  v_accvgpr_read_b32 v56, a86
  v_accvgpr_read_b32 v57, a87
  v_cvt_pk_bf16_f32 v58, v50, v51
  v_cvt_pk_bf16_f32 v59, v52, v53
  v_cvt_pk_bf16_f32 v60, v54, v55
  v_cvt_pk_bf16_f32 v61, v56, v57
  buffer_store_dwordx4 v[58:61], v1, s[8:11], s44 offen offset:0 sc1
  v_accvgpr_read_b32 v62, a88
  v_accvgpr_read_b32 v63, a89
  v_accvgpr_read_b32 v64, a90
  v_accvgpr_read_b32 v65, a91
  v_accvgpr_read_b32 v66, a92
  v_accvgpr_read_b32 v67, a93
  v_accvgpr_read_b32 v68, a94
  v_accvgpr_read_b32 v69, a95
  v_cvt_pk_bf16_f32 v70, v62, v63
  v_cvt_pk_bf16_f32 v71, v64, v65
  v_cvt_pk_bf16_f32 v72, v66, v67
  v_cvt_pk_bf16_f32 v73, v68, v69
  buffer_store_dwordx4 v[70:73], v1, s[8:11], s44 offen offset:1024 sc1
  s_add_u32 s44, s22, 21495808
  v_accvgpr_read_b32 v74, a96
  v_accvgpr_read_b32 v75, a97
  v_accvgpr_read_b32 v76, a98
  v_accvgpr_read_b32 v77, a99
  v_accvgpr_read_b32 v78, a100
  v_accvgpr_read_b32 v79, a101
  v_accvgpr_read_b32 v80, a102
  v_accvgpr_read_b32 v81, a103
  v_cvt_pk_bf16_f32 v82, v74, v75
  v_cvt_pk_bf16_f32 v83, v76, v77
  v_cvt_pk_bf16_f32 v84, v78, v79
  v_cvt_pk_bf16_f32 v85, v80, v81
  buffer_store_dwordx4 v[82:85], v1, s[8:11], s44 offen offset:0 sc1
  v_accvgpr_read_b32 v86, a104
  v_accvgpr_read_b32 v87, a105
  v_accvgpr_read_b32 v88, a106
  v_accvgpr_read_b32 v89, a107
  v_accvgpr_read_b32 v90, a108
  v_accvgpr_read_b32 v91, a109
  v_accvgpr_read_b32 v92, a110
  v_accvgpr_read_b32 v93, a111
  v_cvt_pk_bf16_f32 v94, v86, v87
  v_cvt_pk_bf16_f32 v95, v88, v89
  v_cvt_pk_bf16_f32 v96, v90, v91
  v_cvt_pk_bf16_f32 v97, v92, v93
  buffer_store_dwordx4 v[94:97], v1, s[8:11], s44 offen offset:1024 sc1
  s_add_u32 s44, s22, 21757952
  v_accvgpr_read_b32 v98, a112
  v_accvgpr_read_b32 v99, a113
  v_accvgpr_read_b32 v100, a114
  v_accvgpr_read_b32 v101, a115
  v_accvgpr_read_b32 v102, a116
  v_accvgpr_read_b32 v103, a117
  v_accvgpr_read_b32 v104, a118
  v_accvgpr_read_b32 v105, a119
  v_cvt_pk_bf16_f32 v106, v98, v99
  v_cvt_pk_bf16_f32 v107, v100, v101
  v_cvt_pk_bf16_f32 v108, v102, v103
  v_cvt_pk_bf16_f32 v109, v104, v105
  buffer_store_dwordx4 v[106:109], v1, s[8:11], s44 offen offset:0 sc1
  v_accvgpr_read_b32 v110, a120
  v_accvgpr_read_b32 v111, a121
  v_accvgpr_read_b32 v112, a122
  v_accvgpr_read_b32 v113, a123
  v_accvgpr_read_b32 v114, a124
  v_accvgpr_read_b32 v115, a125
  v_accvgpr_read_b32 v116, a126
  v_accvgpr_read_b32 v117, a127
  v_cvt_pk_bf16_f32 v118, v110, v111
  v_cvt_pk_bf16_f32 v119, v112, v113
  v_cvt_pk_bf16_f32 v120, v114, v115
  v_cvt_pk_bf16_f32 v121, v116, v117
  buffer_store_dwordx4 v[118:121], v1, s[8:11], s44 offen offset:1024 sc1
  s_add_u32 s44, s22, 37748736
  v_accvgpr_read_b32 v26, a128
  v_accvgpr_read_b32 v27, a129
  v_accvgpr_read_b32 v28, a130
  v_accvgpr_read_b32 v29, a131
  v_accvgpr_read_b32 v30, a136
  v_accvgpr_read_b32 v31, a137
  v_accvgpr_read_b32 v32, a138
  v_accvgpr_read_b32 v33, a139
  v_cvt_pk_bf16_f32 v34, v26, v27
  v_cvt_pk_bf16_f32 v35, v28, v29
  v_cvt_pk_bf16_f32 v36, v30, v31
  v_cvt_pk_bf16_f32 v37, v32, v33
  buffer_store_dwordx4 v[34:37], v1, s[8:11], s44 offen offset:0 sc1
  v_accvgpr_read_b32 v38, a132
  v_accvgpr_read_b32 v39, a133
  v_accvgpr_read_b32 v40, a134
  v_accvgpr_read_b32 v41, a135
  v_accvgpr_read_b32 v42, a140
  v_accvgpr_read_b32 v43, a141
  v_accvgpr_read_b32 v44, a142
  v_accvgpr_read_b32 v45, a143
  v_cvt_pk_bf16_f32 v46, v38, v39
  v_cvt_pk_bf16_f32 v47, v40, v41
  v_cvt_pk_bf16_f32 v48, v42, v43
  v_cvt_pk_bf16_f32 v49, v44, v45
  buffer_store_dwordx4 v[46:49], v1, s[8:11], s44 offen offset:1024 sc1
  s_add_u32 s44, s22, 38010880
  v_accvgpr_read_b32 v50, a144
  v_accvgpr_read_b32 v51, a145
  v_accvgpr_read_b32 v52, a146
  v_accvgpr_read_b32 v53, a147
  v_accvgpr_read_b32 v54, a152
  v_accvgpr_read_b32 v55, a153
  v_accvgpr_read_b32 v56, a154
  v_accvgpr_read_b32 v57, a155
  v_cvt_pk_bf16_f32 v58, v50, v51
  v_cvt_pk_bf16_f32 v59, v52, v53
  v_cvt_pk_bf16_f32 v60, v54, v55
  v_cvt_pk_bf16_f32 v61, v56, v57
  buffer_store_dwordx4 v[58:61], v1, s[8:11], s44 offen offset:0 sc1
  v_accvgpr_read_b32 v62, a148
  v_accvgpr_read_b32 v63, a149
  v_accvgpr_read_b32 v64, a150
  v_accvgpr_read_b32 v65, a151
  v_accvgpr_read_b32 v66, a156
  v_accvgpr_read_b32 v67, a157
  v_accvgpr_read_b32 v68, a158
  v_accvgpr_read_b32 v69, a159
  v_cvt_pk_bf16_f32 v70, v62, v63
  v_cvt_pk_bf16_f32 v71, v64, v65
  v_cvt_pk_bf16_f32 v72, v66, v67
  v_cvt_pk_bf16_f32 v73, v68, v69
  buffer_store_dwordx4 v[70:73], v1, s[8:11], s44 offen offset:1024 sc1
  s_add_u32 s44, s22, 38273024
  v_accvgpr_read_b32 v74, a160
  v_accvgpr_read_b32 v75, a161
  v_accvgpr_read_b32 v76, a162
  v_accvgpr_read_b32 v77, a163
  v_accvgpr_read_b32 v78, a168
  v_accvgpr_read_b32 v79, a169
  v_accvgpr_read_b32 v80, a170
  v_accvgpr_read_b32 v81, a171
  v_cvt_pk_bf16_f32 v82, v74, v75
  v_cvt_pk_bf16_f32 v83, v76, v77
  v_cvt_pk_bf16_f32 v84, v78, v79
  v_cvt_pk_bf16_f32 v85, v80, v81
  buffer_store_dwordx4 v[82:85], v1, s[8:11], s44 offen offset:0 sc1
  v_accvgpr_read_b32 v86, a164
  v_accvgpr_read_b32 v87, a165
  v_accvgpr_read_b32 v88, a166
  v_accvgpr_read_b32 v89, a167
  v_accvgpr_read_b32 v90, a172
  v_accvgpr_read_b32 v91, a173
  v_accvgpr_read_b32 v92, a174
  v_accvgpr_read_b32 v93, a175
  v_cvt_pk_bf16_f32 v94, v86, v87
  v_cvt_pk_bf16_f32 v95, v88, v89
  v_cvt_pk_bf16_f32 v96, v90, v91
  v_cvt_pk_bf16_f32 v97, v92, v93
  buffer_store_dwordx4 v[94:97], v1, s[8:11], s44 offen offset:1024 sc1
  s_add_u32 s44, s22, 38535168
  v_accvgpr_read_b32 v98, a176
  v_accvgpr_read_b32 v99, a177
  v_accvgpr_read_b32 v100, a178
  v_accvgpr_read_b32 v101, a179
  v_accvgpr_read_b32 v102, a184
  v_accvgpr_read_b32 v103, a185
  v_accvgpr_read_b32 v104, a186
  v_accvgpr_read_b32 v105, a187
  v_cvt_pk_bf16_f32 v106, v98, v99
  v_cvt_pk_bf16_f32 v107, v100, v101
  v_cvt_pk_bf16_f32 v108, v102, v103
  v_cvt_pk_bf16_f32 v109, v104, v105
  buffer_store_dwordx4 v[106:109], v1, s[8:11], s44 offen offset:0 sc1
  v_accvgpr_read_b32 v110, a180
  v_accvgpr_read_b32 v111, a181
  v_accvgpr_read_b32 v112, a182
  v_accvgpr_read_b32 v113, a183
  v_accvgpr_read_b32 v114, a188
  v_accvgpr_read_b32 v115, a189
  v_accvgpr_read_b32 v116, a190
  v_accvgpr_read_b32 v117, a191
  v_cvt_pk_bf16_f32 v118, v110, v111
  v_cvt_pk_bf16_f32 v119, v112, v113
  v_cvt_pk_bf16_f32 v120, v114, v115
  v_cvt_pk_bf16_f32 v121, v116, v117
  buffer_store_dwordx4 v[118:121], v1, s[8:11], s44 offen offset:1024 sc1
  s_add_u32 s44, s22, 4194304
  v_accvgpr_read_b32 v26, a0
  v_accvgpr_read_b32 v27, a1
  v_accvgpr_read_b32 v28, a2
  v_accvgpr_read_b32 v29, a3
  v_accvgpr_read_b32 v30, a4
  v_accvgpr_read_b32 v31, a5
  v_accvgpr_read_b32 v32, a6
  v_accvgpr_read_b32 v33, a7
  v_cvt_pk_bf16_f32 v34, v26, v27
  v_cvt_pk_bf16_f32 v35, v28, v29
  v_cvt_pk_bf16_f32 v36, v30, v31
  v_cvt_pk_bf16_f32 v37, v32, v33
  buffer_store_dwordx4 v[34:37], v1, s[8:11], s44 offen offset:0 sc1
  v_accvgpr_read_b32 v38, a8
  v_accvgpr_read_b32 v39, a9
  v_accvgpr_read_b32 v40, a10
  v_accvgpr_read_b32 v41, a11
  v_accvgpr_read_b32 v42, a12
  v_accvgpr_read_b32 v43, a13
  v_accvgpr_read_b32 v44, a14
  v_accvgpr_read_b32 v45, a15
  v_cvt_pk_bf16_f32 v46, v38, v39
  v_cvt_pk_bf16_f32 v47, v40, v41
  v_cvt_pk_bf16_f32 v48, v42, v43
  v_cvt_pk_bf16_f32 v49, v44, v45
  buffer_store_dwordx4 v[46:49], v1, s[8:11], s44 offen offset:1024 sc1
  s_add_u32 s44, s22, 4456448
  v_accvgpr_read_b32 v50, a16
  v_accvgpr_read_b32 v51, a17
  v_accvgpr_read_b32 v52, a18
  v_accvgpr_read_b32 v53, a19
  v_accvgpr_read_b32 v54, a20
  v_accvgpr_read_b32 v55, a21
  v_accvgpr_read_b32 v56, a22
  v_accvgpr_read_b32 v57, a23
  v_cvt_pk_bf16_f32 v58, v50, v51
  v_cvt_pk_bf16_f32 v59, v52, v53
  v_cvt_pk_bf16_f32 v60, v54, v55
  v_cvt_pk_bf16_f32 v61, v56, v57
  buffer_store_dwordx4 v[58:61], v1, s[8:11], s44 offen offset:0 sc1
  v_accvgpr_read_b32 v62, a24
  v_accvgpr_read_b32 v63, a25
  v_accvgpr_read_b32 v64, a26
  v_accvgpr_read_b32 v65, a27
  v_accvgpr_read_b32 v66, a28
  v_accvgpr_read_b32 v67, a29
  v_accvgpr_read_b32 v68, a30
  v_accvgpr_read_b32 v69, a31
  v_cvt_pk_bf16_f32 v70, v62, v63
  v_cvt_pk_bf16_f32 v71, v64, v65
  v_cvt_pk_bf16_f32 v72, v66, v67
  v_cvt_pk_bf16_f32 v73, v68, v69
  buffer_store_dwordx4 v[70:73], v1, s[8:11], s44 offen offset:1024 sc1
  s_add_u32 s44, s22, 4718592
  v_accvgpr_read_b32 v74, a32
  v_accvgpr_read_b32 v75, a33
  v_accvgpr_read_b32 v76, a34
  v_accvgpr_read_b32 v77, a35
  v_accvgpr_read_b32 v78, a36
  v_accvgpr_read_b32 v79, a37
  v_accvgpr_read_b32 v80, a38
  v_accvgpr_read_b32 v81, a39
  v_cvt_pk_bf16_f32 v82, v74, v75
  v_cvt_pk_bf16_f32 v83, v76, v77
  v_cvt_pk_bf16_f32 v84, v78, v79
  v_cvt_pk_bf16_f32 v85, v80, v81
  buffer_store_dwordx4 v[82:85], v1, s[8:11], s44 offen offset:0 sc1
  v_accvgpr_read_b32 v86, a40
  v_accvgpr_read_b32 v87, a41
  v_accvgpr_read_b32 v88, a42
  v_accvgpr_read_b32 v89, a43
  v_accvgpr_read_b32 v90, a44
  v_accvgpr_read_b32 v91, a45
  v_accvgpr_read_b32 v92, a46
  v_accvgpr_read_b32 v93, a47
  v_cvt_pk_bf16_f32 v94, v86, v87
  v_cvt_pk_bf16_f32 v95, v88, v89
  v_cvt_pk_bf16_f32 v96, v90, v91
  v_cvt_pk_bf16_f32 v97, v92, v93
  buffer_store_dwordx4 v[94:97], v1, s[8:11], s44 offen offset:1024 sc1
  s_add_u32 s44, s22, 4980736
  v_accvgpr_read_b32 v98, a48
  v_accvgpr_read_b32 v99, a49
  v_accvgpr_read_b32 v100, a50
  v_accvgpr_read_b32 v101, a51
  v_accvgpr_read_b32 v102, a52
  v_accvgpr_read_b32 v103, a53
  v_accvgpr_read_b32 v104, a54
  v_accvgpr_read_b32 v105, a55
  v_cvt_pk_bf16_f32 v106, v98, v99
  v_cvt_pk_bf16_f32 v107, v100, v101
  v_cvt_pk_bf16_f32 v108, v102, v103
  v_cvt_pk_bf16_f32 v109, v104, v105
  buffer_store_dwordx4 v[106:109], v1, s[8:11], s44 offen offset:0 sc1
  v_accvgpr_read_b32 v110, a56
  v_accvgpr_read_b32 v111, a57
  v_accvgpr_read_b32 v112, a58
  v_accvgpr_read_b32 v113, a59
  v_accvgpr_read_b32 v114, a60
  v_accvgpr_read_b32 v115, a61
  v_accvgpr_read_b32 v116, a62
  v_accvgpr_read_b32 v117, a63
  v_cvt_pk_bf16_f32 v118, v110, v111
  v_cvt_pk_bf16_f32 v119, v112, v113
  v_cvt_pk_bf16_f32 v120, v114, v115
  v_cvt_pk_bf16_f32 v121, v116, v117
  buffer_store_dwordx4 v[118:121], v1, s[8:11], s44 offen offset:1024 sc1
  s_waitcnt vmcnt(0)
  s_barrier
  s_cmp_lg_u32 s21, 0
  s_cbranch_scc1 S_12
  v_mov_b32 v251, 16
  s_mov_b64 exec, 1
  buffer_atomic_add v251, off, s[16:19], s75 offset:0 sc1
  s_mov_b64 exec, -1
S_12:
  s_add_u32 s6, s6, 7
  s_cmp_lt_u32 s6, 16
  s_cbranch_scc1 ALOOP
  s_sub_u32 s76, s76, s3
  s_cmp_lt_u32 s77, 216
  s_cbranch_scc1 HASE
  s_mov_b32 s6, 0
  s_cmp_lg_u32 s21, 0
  s_cbranch_scc1 W_13_ok
  s_mov_b32 s79, 0
W_13:
  buffer_load_dword v251, off, s[16:19], s6 offset:0 sc1
  s_add_u32 s79, s79, 1
  s_cmp_gt_u32 s79, 0x40000
  s_cbranch_scc1 BG_END
  s_waitcnt vmcnt(0)
  v_readfirstlane_b32 s78, v251
  s_bfe_u32 s78, s78, 0x80000
  s_cmp_eq_u32 s78, 32
  s_cbranch_scc1 W_13_ok
  s_sleep 8
  s_branch W_13
W_13_ok:
  s_barrier
LLOOP:
  s_lshl_b32 s5, s6, 2
  s_add_u32 s5, s5, s21
  s_lshl_b32 s20, s5, 3
  s_add_u32 s20, s20, s77
  s_sub_u32 s20, s20, 216
  s_lshl_b32 s75, s5, 7
  s_add_u32 s75, s75, 71962624
  s_lshl_b32 s44, s20, 2
  v_lshrrev_b32 v1, 4, v0
  v_add_u32 v2, s44, v1
  v_mul_u32_u24 v2, 1152, v2
  v_and_b32 v3, 15, v0
  v_lshl_add_u32 v2, v3, 3, v2
  s_mov_b32 s44, 92274688
  s_mov_b32 s45, 96468992
  s_load_dwordx2 s[12:13], s[0:1], 0
  s_mov_b32 s14, 2359296
  s_mov_b32 s15, 0x00020000
  v_lshlrev_b32 v3, 1, v2
  s_mov_b32 s46, 134217728
  s_waitcnt lgkmcnt(0)
  buffer_load_dwordx2 v[10:11], v2, s[12:15], 0 offen offset:0
  buffer_load_dwordx2 v[12:13], v2, s[12:15], 0 offen offset:128
  buffer_load_dwordx2 v[14:15], v2, s[12:15], 0 offen offset:256
  buffer_load_dwordx2 v[16:17], v2, s[12:15], 0 offen offset:384
  buffer_load_dwordx2 v[18:19], v2, s[12:15], 0 offen offset:512
  buffer_load_dwordx2 v[20:21], v2, s[12:15], 0 offen offset:640
  buffer_load_dwordx2 v[22:23], v2, s[12:15], 0 offen offset:768
  buffer_load_dwordx2 v[24:25], v2, s[12:15], 0 offen offset:896
  buffer_load_dwordx2 v[26:27], v2, s[12:15], 0 offen offset:1024
  s_mov_b32 s79, 0
W_14:
  buffer_load_dword v251, off, s[8:11], s75 offset:0 sc1
  s_add_u32 s79, s79, 1
  s_cmp_gt_u32 s79, 0x40000
  s_cbranch_scc1 BG_END
  s_waitcnt vmcnt(0)
  v_readfirstlane_b32 s78, v251
  s_bfe_u32 s78, s78, 0x80000
  s_cmp_eq_u32 s78, 24
  s_cbranch_scc1 W_14_ok
  s_sleep 2
  s_branch W_14
W_14_ok:
  buffer_load_dwordx4 v[66:69], v3, s[8:11], s46 offen offset:0 sc1
  buffer_load_dwordx4 v[70:73], v3, s[8:11], s46 offen offset:256 sc1
  buffer_load_dwordx4 v[74:77], v3, s[8:11], s46 offen offset:512 sc1
  buffer_load_dwordx4 v[78:81], v3, s[8:11], s46 offen offset:768 sc1
  buffer_load_dwordx4 v[82:85], v3, s[8:11], s46 offen offset:1024 sc1
  buffer_load_dwordx4 v[86:89], v3, s[8:11], s46 offen offset:1280 sc1
  buffer_load_dwordx4 v[90:93], v3, s[8:11], s46 offen offset:1536 sc1
  buffer_load_dwordx4 v[94:97], v3, s[8:11], s46 offen offset:1792 sc1
  buffer_load_dwordx4 v[98:101], v3, s[8:11], s46 offen offset:2048 sc1
  s_add_u32 s46, s46, 4718592
  buffer_load_dwordx4 v[102:105], v3, s[8:11], s46 offen offset:0 sc1
  buffer_load_dwordx4 v[106:109], v3, s[8:11], s46 offen offset:256 sc1
  buffer_load_dwordx4 v[110:113], v3, s[8:11], s46 offen offset:512 sc1
  buffer_load_dwordx4 v[114:117], v3, s[8:11], s46 offen offset:768 sc1
  buffer_load_dwordx4 v[118:121], v3, s[8:11], s46 offen offset:1024 sc1
  buffer_load_dwordx4 v[122:125], v3, s[8:11], s46 offen offset:1280 sc1
  buffer_load_dwordx4 v[126:129], v3, s[8:11], s46 offen offset:1536 sc1
  buffer_load_dwordx4 v[130:133], v3, s[8:11], s46 offen offset:1792 sc1
  buffer_load_dwordx4 v[134:137], v3, s[8:11], s46 offen offset:2048 sc1
  s_add_u32 s46, s46, 4718592
  buffer_load_dwordx4 v[138:141], v3, s[8:11], s46 offen offset:0 sc1
  buffer_load_dwordx4 v[142:145], v3, s[8:11], s46 offen offset:256 sc1
  buffer_load_dwordx4 v[146:149], v3, s[8:11], s46 offen offset:512 sc1
  buffer_load_dwordx4 v[150:153], v3, s[8:11], s46 offen offset:768 sc1
  buffer_load_dwordx4 v[154:157], v3, s[8:11], s46 offen offset:1024 sc1
  buffer_load_dwordx4 v[158:161], v3, s[8:11], s46 offen offset:1280 sc1
  buffer_load_dwordx4 v[162:165], v3, s[8:11], s46 offen offset:1536 sc1
  buffer_load_dwordx4 v[166:169], v3, s[8:11], s46 offen offset:1792 sc1
  buffer_load_dwordx4 v[170:173], v3, s[8:11], s46 offen offset:2048 sc1
  s_add_u32 s46, s46, 4718592
  buffer_load_dwordx4 v[174:177], v3, s[8:11], s46 offen offset:0 sc1
  buffer_load_dwordx4 v[178:181], v3, s[8:11], s46 offen offset:256 sc1
  buffer_load_dwordx4 v[182:185], v3, s[8:11], s46 offen offset:512 sc1
  buffer_load_dwordx4 v[186:189], v3, s[8:11], s46 offen offset:768 sc1
  buffer_load_dwordx4 v[190:193], v3, s[8:11], s46 offen offset:1024 sc1
  buffer_load_dwordx4 v[194:197], v3, s[8:11], s46 offen offset:1280 sc1
  buffer_load_dwordx4 v[198:201], v3, s[8:11], s46 offen offset:1536 sc1
  buffer_load_dwordx4 v[202:205], v3, s[8:11], s46 offen offset:1792 sc1
  buffer_load_dwordx4 v[206:209], v3, s[8:11], s46 offen offset:2048 sc1
  s_add_u32 s46, s46, 4718592
  buffer_load_dwordx4 v[210:213], v3, s[8:11], s46 offen offset:0 sc1
  buffer_load_dwordx4 v[214:217], v3, s[8:11], s46 offen offset:256 sc1
  buffer_load_dwordx4 v[218:221], v3, s[8:11], s46 offen offset:512 sc1
  buffer_load_dwordx4 v[222:225], v3, s[8:11], s46 offen offset:768 sc1
  buffer_load_dwordx4 v[226:229], v3, s[8:11], s46 offen offset:1024 sc1
  buffer_load_dwordx4 v[230:233], v3, s[8:11], s46 offen offset:1280 sc1
  buffer_load_dwordx4 v[234:237], v3, s[8:11], s46 offen offset:1536 sc1
  buffer_load_dwordx4 v[238:241], v3, s[8:11], s46 offen offset:1792 sc1
  buffer_load_dwordx4 v[242:245], v3, s[8:11], s46 offen offset:2048 sc1
  s_add_u32 s46, s46, 4718592
  v_lshlrev_b32 v30, 16, v10
  v_and_b32 v31, 0xffff0000, v10
  v_lshlrev_b32 v32, 16, v11
  v_and_b32 v33, 0xffff0000, v11
  v_lshlrev_b32 v34, 16, v12
  v_and_b32 v35, 0xffff0000, v12
  v_lshlrev_b32 v36, 16, v13
  v_and_b32 v37, 0xffff0000, v13
  v_lshlrev_b32 v38, 16, v14
  v_and_b32 v39, 0xffff0000, v14
  v_lshlrev_b32 v40, 16, v15
  v_and_b32 v41, 0xffff0000, v15
  v_lshlrev_b32 v42, 16, v16
  v_and_b32 v43, 0xffff0000, v16
  v_lshlrev_b32 v44, 16, v17
  v_and_b32 v45, 0xffff0000, v17
  v_lshlrev_b32 v46, 16, v18
  v_and_b32 v47, 0xffff0000, v18
  v_lshlrev_b32 v48, 16, v19
  v_and_b32 v49, 0xffff0000, v19
  v_lshlrev_b32 v50, 16, v20
  v_and_b32 v51, 0xffff0000, v20
  v_lshlrev_b32 v52, 16, v21
  v_and_b32 v53, 0xffff0000, v21
  v_lshlrev_b32 v54, 16, v22
  v_and_b32 v55, 0xffff0000, v22
  v_lshlrev_b32 v56, 16, v23
  v_and_b32 v57, 0xffff0000, v23
  v_lshlrev_b32 v58, 16, v24
  v_and_b32 v59, 0xffff0000, v24
  v_lshlrev_b32 v60, 16, v25
  v_and_b32 v61, 0xffff0000, v25
  v_lshlrev_b32 v62, 16, v26
  v_and_b32 v63, 0xffff0000, v26
  v_lshlrev_b32 v64, 16, v27
  v_and_b32 v65, 0xffff0000, v27
  s_waitcnt vmcnt(36)
  v_pk_add_f32 v[30:31], v[30:31], v[66:67]
  v_pk_add_f32 v[32:33], v[32:33], v[68:69]
  v_pk_add_f32 v[34:35], v[34:35], v[70:71]
  v_pk_add_f32 v[36:37], v[36:37], v[72:73]
  v_pk_add_f32 v[38:39], v[38:39], v[74:75]
  v_pk_add_f32 v[40:41], v[40:41], v[76:77]
  v_pk_add_f32 v[42:43], v[42:43], v[78:79]
  v_pk_add_f32 v[44:45], v[44:45], v[80:81]
  v_pk_add_f32 v[46:47], v[46:47], v[82:83]
  v_pk_add_f32 v[48:49], v[48:49], v[84:85]
  v_pk_add_f32 v[50:51], v[50:51], v[86:87]
  v_pk_add_f32 v[52:53], v[52:53], v[88:89]
  v_pk_add_f32 v[54:55], v[54:55], v[90:91]
  v_pk_add_f32 v[56:57], v[56:57], v[92:93]
  v_pk_add_f32 v[58:59], v[58:59], v[94:95]
  v_pk_add_f32 v[60:61], v[60:61], v[96:97]
  v_pk_add_f32 v[62:63], v[62:63], v[98:99]
  v_pk_add_f32 v[64:65], v[64:65], v[100:101]
  buffer_load_dwordx4 v[66:69], v3, s[8:11], s46 offen offset:0 sc1
  buffer_load_dwordx4 v[70:73], v3, s[8:11], s46 offen offset:256 sc1
  buffer_load_dwordx4 v[74:77], v3, s[8:11], s46 offen offset:512 sc1
  buffer_load_dwordx4 v[78:81], v3, s[8:11], s46 offen offset:768 sc1
  buffer_load_dwordx4 v[82:85], v3, s[8:11], s46 offen offset:1024 sc1
  buffer_load_dwordx4 v[86:89], v3, s[8:11], s46 offen offset:1280 sc1
  buffer_load_dwordx4 v[90:93], v3, s[8:11], s46 offen offset:1536 sc1
  buffer_load_dwordx4 v[94:97], v3, s[8:11], s46 offen offset:1792 sc1
  buffer_load_dwordx4 v[98:101], v3, s[8:11], s46 offen offset:2048 sc1
  s_add_u32 s46, s46, 4718592
  s_waitcnt vmcnt(36)
  v_pk_add_f32 v[30:31], v[30:31], v[102:103]
  v_pk_add_f32 v[32:33], v[32:33], v[104:105]
  v_pk_add_f32 v[34:35], v[34:35], v[106:107]
  v_pk_add_f32 v[36:37], v[36:37], v[108:109]
  v_pk_add_f32 v[38:39], v[38:39], v[110:111]
  v_pk_add_f32 v[40:41], v[40:41], v[112:113]
  v_pk_add_f32 v[42:43], v[42:43], v[114:115]
  v_pk_add_f32 v[44:45], v[44:45], v[116:117]
  v_pk_add_f32 v[46:47], v[46:47], v[118:119]
  v_pk_add_f32 v[48:49], v[48:49], v[120:121]
  v_pk_add_f32 v[50:51], v[50:51], v[122:123]
  v_pk_add_f32 v[52:53], v[52:53], v[124:125]
  v_pk_add_f32 v[54:55], v[54:55], v[126:127]
  v_pk_add_f32 v[56:57], v[56:57], v[128:129]
  v_pk_add_f32 v[58:59], v[58:59], v[130:131]
  v_pk_add_f32 v[60:61], v[60:61], v[132:133]
  v_pk_add_f32 v[62:63], v[62:63], v[134:135]
  v_pk_add_f32 v[64:65], v[64:65], v[136:137]
  buffer_load_dwordx4 v[102:105], v3, s[8:11], s46 offen offset:0 sc1
  buffer_load_dwordx4 v[106:109], v3, s[8:11], s46 offen offset:256 sc1
  buffer_load_dwordx4 v[110:113], v3, s[8:11], s46 offen offset:512 sc1
  buffer_load_dwordx4 v[114:117], v3, s[8:11], s46 offen offset:768 sc1
  buffer_load_dwordx4 v[118:121], v3, s[8:11], s46 offen offset:1024 sc1
  buffer_load_dwordx4 v[122:125], v3, s[8:11], s46 offen offset:1280 sc1
  buffer_load_dwordx4 v[126:129], v3, s[8:11], s46 offen offset:1536 sc1
  buffer_load_dwordx4 v[130:133], v3, s[8:11], s46 offen offset:1792 sc1
  buffer_load_dwordx4 v[134:137], v3, s[8:11], s46 offen offset:2048 sc1
  s_add_u32 s46, s46, 4718592
  s_waitcnt vmcnt(36)
  v_pk_add_f32 v[30:31], v[30:31], v[138:139]
  v_pk_add_f32 v[32:33], v[32:33], v[140:141]
  v_pk_add_f32 v[34:35], v[34:35], v[142:143]
  v_pk_add_f32 v[36:37], v[36:37], v[144:145]
  v_pk_add_f32 v[38:39], v[38:39], v[146:147]
  v_pk_add_f32 v[40:41], v[40:41], v[148:149]
  v_pk_add_f32 v[42:43], v[42:43], v[150:151]
  v_pk_add_f32 v[44:45], v[44:45], v[152:153]
  v_pk_add_f32 v[46:47], v[46:47], v[154:155]
  v_pk_add_f32 v[48:49], v[48:49], v[156:157]
  v_pk_add_f32 v[50:51], v[50:51], v[158:159]
  v_pk_add_f32 v[52:53], v[52:53], v[160:161]
  v_pk_add_f32 v[54:55], v[54:55], v[162:163]
  v_pk_add_f32 v[56:57], v[56:57], v[164:165]
  v_pk_add_f32 v[58:59], v[58:59], v[166:167]
  v_pk_add_f32 v[60:61], v[60:61], v[168:169]
  v_pk_add_f32 v[62:63], v[62:63], v[170:171]
  v_pk_add_f32 v[64:65], v[64:65], v[172:173]
  buffer_load_dwordx4 v[138:141], v3, s[8:11], s46 offen offset:0 sc1
  buffer_load_dwordx4 v[142:145], v3, s[8:11], s46 offen offset:256 sc1
  buffer_load_dwordx4 v[146:149], v3, s[8:11], s46 offen offset:512 sc1
  buffer_load_dwordx4 v[150:153], v3, s[8:11], s46 offen offset:768 sc1
  buffer_load_dwordx4 v[154:157], v3, s[8:11], s46 offen offset:1024 sc1
  buffer_load_dwordx4 v[158:161], v3, s[8:11], s46 offen offset:1280 sc1
  buffer_load_dwordx4 v[162:165], v3, s[8:11], s46 offen offset:1536 sc1
  buffer_load_dwordx4 v[166:169], v3, s[8:11], s46 offen offset:1792 sc1
  buffer_load_dwordx4 v[170:173], v3, s[8:11], s46 offen offset:2048 sc1
  s_add_u32 s46, s46, 4718592
  s_waitcnt vmcnt(36)
  v_pk_add_f32 v[30:31], v[30:31], v[174:175]
  v_pk_add_f32 v[32:33], v[32:33], v[176:177]
  v_pk_add_f32 v[34:35], v[34:35], v[178:179]
  v_pk_add_f32 v[36:37], v[36:37], v[180:181]
  v_pk_add_f32 v[38:39], v[38:39], v[182:183]
  v_pk_add_f32 v[40:41], v[40:41], v[184:185]
  v_pk_add_f32 v[42:43], v[42:43], v[186:187]
  v_pk_add_f32 v[44:45], v[44:45], v[188:189]
  v_pk_add_f32 v[46:47], v[46:47], v[190:191]
  v_pk_add_f32 v[48:49], v[48:49], v[192:193]
  v_pk_add_f32 v[50:51], v[50:51], v[194:195]
  v_pk_add_f32 v[52:53], v[52:53], v[196:197]
  v_pk_add_f32 v[54:55], v[54:55], v[198:199]
  v_pk_add_f32 v[56:57], v[56:57], v[200:201]
  v_pk_add_f32 v[58:59], v[58:59], v[202:203]
  v_pk_add_f32 v[60:61], v[60:61], v[204:205]
  v_pk_add_f32 v[62:63], v[62:63], v[206:207]
  v_pk_add_f32 v[64:65], v[64:65], v[208:209]
  s_waitcnt vmcnt(27)
  v_pk_add_f32 v[30:31], v[30:31], v[210:211]
  v_pk_add_f32 v[32:33], v[32:33], v[212:213]
  v_pk_add_f32 v[34:35], v[34:35], v[214:215]
  v_pk_add_f32 v[36:37], v[36:37], v[216:217]
  v_pk_add_f32 v[38:39], v[38:39], v[218:219]
  v_pk_add_f32 v[40:41], v[40:41], v[220:221]
  v_pk_add_f32 v[42:43], v[42:43], v[222:223]
  v_pk_add_f32 v[44:45], v[44:45], v[224:225]
  v_pk_add_f32 v[46:47], v[46:47], v[226:227]
  v_pk_add_f32 v[48:49], v[48:49], v[228:229]
  v_pk_add_f32 v[50:51], v[50:51], v[230:231]
  v_pk_add_f32 v[52:53], v[52:53], v[232:233]
  v_pk_add_f32 v[54:55], v[54:55], v[234:235]
  v_pk_add_f32 v[56:57], v[56:57], v[236:237]
  v_pk_add_f32 v[58:59], v[58:59], v[238:239]
  v_pk_add_f32 v[60:61], v[60:61], v[240:241]
  v_pk_add_f32 v[62:63], v[62:63], v[242:243]
  v_pk_add_f32 v[64:65], v[64:65], v[244:245]
  s_waitcnt vmcnt(18)
  v_pk_add_f32 v[30:31], v[30:31], v[66:67]
  v_pk_add_f32 v[32:33], v[32:33], v[68:69]
  v_pk_add_f32 v[34:35], v[34:35], v[70:71]
  v_pk_add_f32 v[36:37], v[36:37], v[72:73]
  v_pk_add_f32 v[38:39], v[38:39], v[74:75]
  v_pk_add_f32 v[40:41], v[40:41], v[76:77]
  v_pk_add_f32 v[42:43], v[42:43], v[78:79]
  v_pk_add_f32 v[44:45], v[44:45], v[80:81]
  v_pk_add_f32 v[46:47], v[46:47], v[82:83]
  v_pk_add_f32 v[48:49], v[48:49], v[84:85]
  v_pk_add_f32 v[50:51], v[50:51], v[86:87]
  v_pk_add_f32 v[52:53], v[52:53], v[88:89]
  v_pk_add_f32 v[54:55], v[54:55], v[90:91]
  v_pk_add_f32 v[56:57], v[56:57], v[92:93]
  v_pk_add_f32 v[58:59], v[58:59], v[94:95]
  v_pk_add_f32 v[60:61], v[60:61], v[96:97]
  v_pk_add_f32 v[62:63], v[62:63], v[98:99]
  v_pk_add_f32 v[64:65], v[64:65], v[100:101]
  s_waitcnt vmcnt(9)
  v_pk_add_f32 v[30:31], v[30:31], v[102:103]
  v_pk_add_f32 v[32:33], v[32:33], v[104:105]
  v_pk_add_f32 v[34:35], v[34:35], v[106:107]
  v_pk_add_f32 v[36:37], v[36:37], v[108:109]
  v_pk_add_f32 v[38:39], v[38:39], v[110:111]
  v_pk_add_f32 v[40:41], v[40:41], v[112:113]
  v_pk_add_f32 v[42:43], v[42:43], v[114:115]
  v_pk_add_f32 v[44:45], v[44:45], v[116:117]
  v_pk_add_f32 v[46:47], v[46:47], v[118:119]
  v_pk_add_f32 v[48:49], v[48:49], v[120:121]
  v_pk_add_f32 v[50:51], v[50:51], v[122:123]
  v_pk_add_f32 v[52:53], v[52:53], v[124:125]
  v_pk_add_f32 v[54:55], v[54:55], v[126:127]
  v_pk_add_f32 v[56:57], v[56:57], v[128:129]
  v_pk_add_f32 v[58:59], v[58:59], v[130:131]
  v_pk_add_f32 v[60:61], v[60:61], v[132:133]
  v_pk_add_f32 v[62:63], v[62:63], v[134:135]
  v_pk_add_f32 v[64:65], v[64:65], v[136:137]
  s_waitcnt vmcnt(0)
  v_pk_add_f32 v[30:31], v[30:31], v[138:139]
  v_pk_add_f32 v[32:33], v[32:33], v[140:141]
  v_pk_add_f32 v[34:35], v[34:35], v[142:143]
  v_pk_add_f32 v[36:37], v[36:37], v[144:145]
  v_pk_add_f32 v[38:39], v[38:39], v[146:147]
  v_pk_add_f32 v[40:41], v[40:41], v[148:149]
  v_pk_add_f32 v[42:43], v[42:43], v[150:151]
  v_pk_add_f32 v[44:45], v[44:45], v[152:153]
  v_pk_add_f32 v[46:47], v[46:47], v[154:155]
  v_pk_add_f32 v[48:49], v[48:49], v[156:157]
  v_pk_add_f32 v[50:51], v[50:51], v[158:159]
  v_pk_add_f32 v[52:53], v[52:53], v[160:161]
  v_pk_add_f32 v[54:55], v[54:55], v[162:163]
  v_pk_add_f32 v[56:57], v[56:57], v[164:165]
  v_pk_add_f32 v[58:59], v[58:59], v[166:167]
  v_pk_add_f32 v[60:61], v[60:61], v[168:169]
  v_pk_add_f32 v[62:63], v[62:63], v[170:171]
  v_pk_add_f32 v[64:65], v[64:65], v[172:173]
  v_cvt_pk_bf16_f32 v10, v30, v31
  v_cvt_pk_bf16_f32 v11, v32, v33
  v_cvt_pk_bf16_f32 v12, v34, v35
  v_cvt_pk_bf16_f32 v13, v36, v37
  v_cvt_pk_bf16_f32 v14, v38, v39
  v_cvt_pk_bf16_f32 v15, v40, v41
  v_cvt_pk_bf16_f32 v16, v42, v43
  v_cvt_pk_bf16_f32 v17, v44, v45
  v_cvt_pk_bf16_f32 v18, v46, v47
  v_cvt_pk_bf16_f32 v19, v48, v49
  v_cvt_pk_bf16_f32 v20, v50, v51
  v_cvt_pk_bf16_f32 v21, v52, v53
  v_cvt_pk_bf16_f32 v22, v54, v55
  v_cvt_pk_bf16_f32 v23, v56, v57
  v_cvt_pk_bf16_f32 v24, v58, v59
  v_cvt_pk_bf16_f32 v25, v60, v61
  v_cvt_pk_bf16_f32 v26, v62, v63
  v_cvt_pk_bf16_f32 v27, v64, v65
  buffer_store_dwordx2 v[10:11], v2, s[8:11], s44 offen offset:0 sc1
  buffer_store_dwordx2 v[12:13], v2, s[8:11], s44 offen offset:128 sc1
  buffer_store_dwordx2 v[14:15], v2, s[8:11], s44 offen offset:256 sc1
  buffer_store_dwordx2 v[16:17], v2, s[8:11], s44 offen offset:384 sc1
  buffer_store_dwordx2 v[18:19], v2, s[8:11], s44 offen offset:512 sc1
  buffer_store_dwordx2 v[20:21], v2, s[8:11], s44 offen offset:640 sc1
  buffer_store_dwordx2 v[22:23], v2, s[8:11], s44 offen offset:768 sc1
  buffer_store_dwordx2 v[24:25], v2, s[8:11], s44 offen offset:896 sc1
  buffer_store_dwordx2 v[26:27], v2, s[8:11], s44 offen offset:1024 sc1
  s_mov_b32 s46, 0x3ae38e39
  s_mov_b32 s47, 0x3727c5ac
  v_lshlrev_b32 v30, 16, v10
  v_and_b32 v31, 0xffff0000, v10
  v_lshlrev_b32 v32, 16, v11
  v_and_b32 v33, 0xffff0000, v11
  v_pk_add_f32 v[4:5], v[30:31], v[32:33]
  v_lshlrev_b32 v34, 16, v12
  v_and_b32 v35, 0xffff0000, v12
  v_pk_add_f32 v[4:5], v[4:5], v[34:35]
  v_lshlrev_b32 v36, 16, v13
  v_and_b32 v37, 0xffff0000, v13
  v_pk_add_f32 v[4:5], v[4:5], v[36:37]
  v_lshlrev_b32 v38, 16, v14
  v_and_b32 v39, 0xffff0000, v14
  v_pk_add_f32 v[4:5], v[4:5], v[38:39]
  v_lshlrev_b32 v40, 16, v15
  v_and_b32 v41, 0xffff0000, v15
  v_pk_add_f32 v[4:5], v[4:5], v[40:41]
  v_lshlrev_b32 v42, 16, v16
  v_and_b32 v43, 0xffff0000, v16
  v_pk_add_f32 v[4:5], v[4:5], v[42:43]
  v_lshlrev_b32 v44, 16, v17
  v_and_b32 v45, 0xffff0000, v17
  v_pk_add_f32 v[4:5], v[4:5], v[44:45]
  v_lshlrev_b32 v46, 16, v18
  v_and_b32 v47, 0xffff0000, v18
  v_pk_add_f32 v[4:5], v[4:5], v[46:47]
  v_lshlrev_b32 v48, 16, v19
  v_and_b32 v49, 0xffff0000, v19
  v_pk_add_f32 v[4:5], v[4:5], v[48:49]
  v_lshlrev_b32 v50, 16, v20
  v_and_b32 v51, 0xffff0000, v20
  v_pk_add_f32 v[4:5], v[4:5], v[50:51]
  v_lshlrev_b32 v52, 16, v21
  v_and_b32 v53, 0xffff0000, v21
  v_pk_add_f32 v[4:5], v[4:5], v[52:53]
  v_lshlrev_b32 v54, 16, v22
  v_and_b32 v55, 0xffff0000, v22
  v_pk_add_f32 v[4:5], v[4:5], v[54:55]
  v_lshlrev_b32 v56, 16, v23
  v_and_b32 v57, 0xffff0000, v23
  v_pk_add_f32 v[4:5], v[4:5], v[56:57]
  v_lshlrev_b32 v58, 16, v24
  v_and_b32 v59, 0xffff0000, v24
  v_pk_add_f32 v[4:5], v[4:5], v[58:59]
  v_lshlrev_b32 v60, 16, v25
  v_and_b32 v61, 0xffff0000, v25
  v_pk_add_f32 v[4:5], v[4:5], v[60:61]
  v_lshlrev_b32 v62, 16, v26
  v_and_b32 v63, 0xffff0000, v26
  v_pk_add_f32 v[4:5], v[4:5], v[62:63]
  v_lshlrev_b32 v64, 16, v27
  v_and_b32 v65, 0xffff0000, v27
  v_pk_add_f32 v[4:5], v[4:5], v[64:65]
  v_add_f32 v4, v4, v5
  s_nop 1
  v_add_f32_dpp v4, v4, v4 row_ror:8 row_mask:0xf bank_mask:0xf
  s_nop 1
  v_add_f32_dpp v4, v4, v4 row_ror:4 row_mask:0xf bank_mask:0xf
  s_nop 1
  v_add_f32_dpp v4, v4, v4 row_ror:2 row_mask:0xf bank_mask:0xf
  s_nop 1
  v_add_f32_dpp v4, v4, v4 row_ror:1 row_mask:0xf bank_mask:0xf
  v_mul_f32 v4, s46, v4
  v_mov_b32 v6, 0
  v_mov_b32 v7, 0
  v_mov_b32 v5, v4
  v_pk_add_f32 v[30:31], v[30:31], v[4:5] neg_lo:[0,1] neg_hi:[0,1]
  v_pk_fma_f32 v[6:7], v[30:31], v[30:31], v[6:7]
  v_pk_add_f32 v[32:33], v[32:33], v[4:5] neg_lo:[0,1] neg_hi:[0,1]
  v_pk_fma_f32 v[6:7], v[32:33], v[32:33], v[6:7]
  v_pk_add_f32 v[34:35], v[34:35], v[4:5] neg_lo:[0,1] neg_hi:[0,1]
  v_pk_fma_f32 v[6:7], v[34:35], v[34:35], v[6:7]
  v_pk_add_f32 v[36:37], v[36:37], v[4:5] neg_lo:[0,1] neg_hi:[0,1]
  v_pk_fma_f32 v[6:7], v[36:37], v[36:37], v[6:7]
  v_pk_add_f32 v[38:39], v[38:39], v[4:5] neg_lo:[0,1] neg_hi:[0,1]
  v_pk_fma_f32 v[6:7], v[38:39], v[38:39], v[6:7]
  v_pk_add_f32 v[40:41], v[40:41], v[4:5] neg_lo:[0,1] neg_hi:[0,1]
  v_pk_fma_f32 v[6:7], v[40:41], v[40:41], v[6:7]
  v_pk_add_f32 v[42:43], v[42:43], v[4:5] neg_lo:[0,1] neg_hi:[0,1]
  v_pk_fma_f32 v[6:7], v[42:43], v[42:43], v[6:7]
  v_pk_add_f32 v[44:45], v[44:45], v[4:5] neg_lo:[0,1] neg_hi:[0,1]
  v_pk_fma_f32 v[6:7], v[44:45], v[44:45], v[6:7]
  v_pk_add_f32 v[46:47], v[46:47], v[4:5] neg_lo:[0,1] neg_hi:[0,1]
  v_pk_fma_f32 v[6:7], v[46:47], v[46:47], v[6:7]
  v_pk_add_f32 v[48:49], v[48:49], v[4:5] neg_lo:[0,1] neg_hi:[0,1]
  v_pk_fma_f32 v[6:7], v[48:49], v[48:49], v[6:7]
  v_pk_add_f32 v[50:51], v[50:51], v[4:5] neg_lo:[0,1] neg_hi:[0,1]
  v_pk_fma_f32 v[6:7], v[50:51], v[50:51], v[6:7]
  v_pk_add_f32 v[52:53], v[52:53], v[4:5] neg_lo:[0,1] neg_hi:[0,1]
  v_pk_fma_f32 v[6:7], v[52:53], v[52:53], v[6:7]
  v_pk_add_f32 v[54:55], v[54:55], v[4:5] neg_lo:[0,1] neg_hi:[0,1]
  v_pk_fma_f32 v[6:7], v[54:55], v[54:55], v[6:7]
  v_pk_add_f32 v[56:57], v[56:57], v[4:5] neg_lo:[0,1] neg_hi:[0,1]
  v_pk_fma_f32 v[6:7], v[56:57], v[56:57], v[6:7]
  v_pk_add_f32 v[58:59], v[58:59], v[4:5] neg_lo:[0,1] neg_hi:[0,1]
  v_pk_fma_f32 v[6:7], v[58:59], v[58:59], v[6:7]
  v_pk_add_f32 v[60:61], v[60:61], v[4:5] neg_lo:[0,1] neg_hi:[0,1]
  v_pk_fma_f32 v[6:7], v[60:61], v[60:61], v[6:7]
  v_pk_add_f32 v[62:63], v[62:63], v[4:5] neg_lo:[0,1] neg_hi:[0,1]
  v_pk_fma_f32 v[6:7], v[62:63], v[62:63], v[6:7]
  v_pk_add_f32 v[64:65], v[64:65], v[4:5] neg_lo:[0,1] neg_hi:[0,1]
  v_pk_fma_f32 v[6:7], v[64:65], v[64:65], v[6:7]
  v_add_f32 v6, v6, v7
  s_nop 1
  v_add_f32_dpp v6, v6, v6 row_ror:8 row_mask:0xf bank_mask:0xf
  s_nop 1
  v_add_f32_dpp v6, v6, v6 row_ror:4 row_mask:0xf bank_mask:0xf
  s_nop 1
  v_add_f32_dpp v6, v6, v6 row_ror:2 row_mask:0xf bank_mask:0xf
  s_nop 1
  v_add_f32_dpp v6, v6, v6 row_ror:1 row_mask:0xf bank_mask:0xf
  v_mov_b32 v7, s47
  v_fma_f32 v6, v6, s46, v7
  v_rsq_f32 v6, v6
  s_nop 0
  v_mov_b32 v7, v6
  v_pk_mul_f32 v[30:31], v[30:31], v[6:7]
  v_cvt_pk_bf16_f32 v10, v30, v31
  v_pk_mul_f32 v[32:33], v[32:33], v[6:7]
  v_cvt_pk_bf16_f32 v11, v32, v33
  v_pk_mul_f32 v[34:35], v[34:35], v[6:7]
  v_cvt_pk_bf16_f32 v12, v34, v35
  v_pk_mul_f32 v[36:37], v[36:37], v[6:7]
  v_cvt_pk_bf16_f32 v13, v36, v37
  v_pk_mul_f32 v[38:39], v[38:39], v[6:7]
  v_cvt_pk_bf16_f32 v14, v38, v39
  v_pk_mul_f32 v[40:41], v[40:41], v[6:7]
  v_cvt_pk_bf16_f32 v15, v40, v41
  v_pk_mul_f32 v[42:43], v[42:43], v[6:7]
  v_cvt_pk_bf16_f32 v16, v42, v43
  v_pk_mul_f32 v[44:45], v[44:45], v[6:7]
  v_cvt_pk_bf16_f32 v17, v44, v45
  v_pk_mul_f32 v[46:47], v[46:47], v[6:7]
  v_cvt_pk_bf16_f32 v18, v46, v47
  v_pk_mul_f32 v[48:49], v[48:49], v[6:7]
  v_cvt_pk_bf16_f32 v19, v48, v49
  v_pk_mul_f32 v[50:51], v[50:51], v[6:7]
  v_cvt_pk_bf16_f32 v20, v50, v51
  v_pk_mul_f32 v[52:53], v[52:53], v[6:7]
  v_cvt_pk_bf16_f32 v21, v52, v53
  v_pk_mul_f32 v[54:55], v[54:55], v[6:7]
  v_cvt_pk_bf16_f32 v22, v54, v55
  v_pk_mul_f32 v[56:57], v[56:57], v[6:7]
  v_cvt_pk_bf16_f32 v23, v56, v57
  v_pk_mul_f32 v[58:59], v[58:59], v[6:7]
  v_cvt_pk_bf16_f32 v24, v58, v59
  v_pk_mul_f32 v[60:61], v[60:61], v[6:7]
  v_cvt_pk_bf16_f32 v25, v60, v61
  v_pk_mul_f32 v[62:63], v[62:63], v[6:7]
  v_cvt_pk_bf16_f32 v26, v62, v63
  v_pk_mul_f32 v[64:65], v[64:65], v[6:7]
  v_cvt_pk_bf16_f32 v27, v64, v65
  v_lshlrev_b32 v30, 16, v10
  v_and_b32 v31, 0xffff0000, v10
  v_lshlrev_b32 v32, 16, v11
  v_and_b32 v33, 0xffff0000, v11
  v_pk_add_f32 v[4:5], v[30:31], v[32:33]
  v_lshlrev_b32 v34, 16, v12
  v_and_b32 v35, 0xffff0000, v12
  v_pk_add_f32 v[4:5], v[4:5], v[34:35]
  v_lshlrev_b32 v36, 16, v13
  v_and_b32 v37, 0xffff0000, v13
  v_pk_add_f32 v[4:5], v[4:5], v[36:37]
  v_lshlrev_b32 v38, 16, v14
  v_and_b32 v39, 0xffff0000, v14
  v_pk_add_f32 v[4:5], v[4:5], v[38:39]
  v_lshlrev_b32 v40, 16, v15
  v_and_b32 v41, 0xffff0000, v15
  v_pk_add_f32 v[4:5], v[4:5], v[40:41]
  v_lshlrev_b32 v42, 16, v16
  v_and_b32 v43, 0xffff0000, v16
  v_pk_add_f32 v[4:5], v[4:5], v[42:43]
  v_lshlrev_b32 v44, 16, v17
  v_and_b32 v45, 0xffff0000, v17
  v_pk_add_f32 v[4:5], v[4:5], v[44:45]
  v_lshlrev_b32 v46, 16, v18
  v_and_b32 v47, 0xffff0000, v18
  v_pk_add_f32 v[4:5], v[4:5], v[46:47]
  v_lshlrev_b32 v48, 16, v19
  v_and_b32 v49, 0xffff0000, v19
  v_pk_add_f32 v[4:5], v[4:5], v[48:49]
  v_lshlrev_b32 v50, 16, v20
  v_and_b32 v51, 0xffff0000, v20
  v_pk_add_f32 v[4:5], v[4:5], v[50:51]
  v_lshlrev_b32 v52, 16, v21
  v_and_b32 v53, 0xffff0000, v21
  v_pk_add_f32 v[4:5], v[4:5], v[52:53]
  v_lshlrev_b32 v54, 16, v22
  v_and_b32 v55, 0xffff0000, v22
  v_pk_add_f32 v[4:5], v[4:5], v[54:55]
  v_lshlrev_b32 v56, 16, v23
  v_and_b32 v57, 0xffff0000, v23
  v_pk_add_f32 v[4:5], v[4:5], v[56:57]
  v_lshlrev_b32 v58, 16, v24
  v_and_b32 v59, 0xffff0000, v24
  v_pk_add_f32 v[4:5], v[4:5], v[58:59]
  v_lshlrev_b32 v60, 16, v25
  v_and_b32 v61, 0xffff0000, v25
  v_pk_add_f32 v[4:5], v[4:5], v[60:61]
  v_lshlrev_b32 v62, 16, v26
  v_and_b32 v63, 0xffff0000, v26
  v_pk_add_f32 v[4:5], v[4:5], v[62:63]
  v_lshlrev_b32 v64, 16, v27
  v_and_b32 v65, 0xffff0000, v27
  v_pk_add_f32 v[4:5], v[4:5], v[64:65]
  v_add_f32 v4, v4, v5
  s_nop 1
  v_add_f32_dpp v4, v4, v4 row_ror:8 row_mask:0xf bank_mask:0xf
  s_nop 1
  v_add_f32_dpp v4, v4, v4 row_ror:4 row_mask:0xf bank_mask:0xf
  s_nop 1
  v_add_f32_dpp v4, v4, v4 row_ror:2 row_mask:0xf bank_mask:0xf
  s_nop 1
  v_add_f32_dpp v4, v4, v4 row_ror:1 row_mask:0xf bank_mask:0xf
  v_mul_f32 v4, s46, v4
  v_mov_b32 v6, 0
  v_mov_b32 v7, 0
  v_mov_b32 v5, v4
  v_pk_add_f32 v[30:31], v[30:31], v[4:5] neg_lo:[0,1] neg_hi:[0,1]
  v_pk_fma_f32 v[6:7], v[30:31], v[30:31], v[6:7]
  v_pk_add_f32 v[32:33], v[32:33], v[4:5] neg_lo:[0,1] neg_hi:[0,1]
  v_pk_fma_f32 v[6:7], v[32:33], v[32:33], v[6:7]
  v_pk_add_f32 v[34:35], v[34:35], v[4:5] neg_lo:[0,1] neg_hi:[0,1]
  v_pk_fma_f32 v[6:7], v[34:35], v[34:35], v[6:7]
  v_pk_add_f32 v[36:37], v[36:37], v[4:5] neg_lo:[0,1] neg_hi:[0,1]
  v_pk_fma_f32 v[6:7], v[36:37], v[36:37], v[6:7]
  v_pk_add_f32 v[38:39], v[38:39], v[4:5] neg_lo:[0,1] neg_hi:[0,1]
  v_pk_fma_f32 v[6:7], v[38:39], v[38:39], v[6:7]
  v_pk_add_f32 v[40:41], v[40:41], v[4:5] neg_lo:[0,1] neg_hi:[0,1]
  v_pk_fma_f32 v[6:7], v[40:41], v[40:41], v[6:7]
  v_pk_add_f32 v[42:43], v[42:43], v[4:5] neg_lo:[0,1] neg_hi:[0,1]
  v_pk_fma_f32 v[6:7], v[42:43], v[42:43], v[6:7]
  v_pk_add_f32 v[44:45], v[44:45], v[4:5] neg_lo:[0,1] neg_hi:[0,1]
  v_pk_fma_f32 v[6:7], v[44:45], v[44:45], v[6:7]
  v_pk_add_f32 v[46:47], v[46:47], v[4:5] neg_lo:[0,1] neg_hi:[0,1]
  v_pk_fma_f32 v[6:7], v[46:47], v[46:47], v[6:7]
  v_pk_add_f32 v[48:49], v[48:49], v[4:5] neg_lo:[0,1] neg_hi:[0,1]
  v_pk_fma_f32 v[6:7], v[48:49], v[48:49], v[6:7]
  v_pk_add_f32 v[50:51], v[50:51], v[4:5] neg_lo:[0,1] neg_hi:[0,1]
  v_pk_fma_f32 v[6:7], v[50:51], v[50:51], v[6:7]
  v_pk_add_f32 v[52:53], v[52:53], v[4:5] neg_lo:[0,1] neg_hi:[0,1]
  v_pk_fma_f32 v[6:7], v[52:53], v[52:53], v[6:7]
  v_pk_add_f32 v[54:55], v[54:55], v[4:5] neg_lo:[0,1] neg_hi:[0,1]
  v_pk_fma_f32 v[6:7], v[54:55], v[54:55], v[6:7]
  v_pk_add_f32 v[56:57], v[56:57], v[4:5] neg_lo:[0,1] neg_hi:[0,1]
  v_pk_fma_f32 v[6:7], v[56:57], v[56:57], v[6:7]
  v_pk_add_f32 v[58:59], v[58:59], v[4:5] neg_lo:[0,1] neg_hi:[0,1]
  v_pk_fma_f32 v[6:7], v[58:59], v[58:59], v[6:7]
  v_pk_add_f32 v[60:61], v[60:61], v[4:5] neg_lo:[0,1] neg_hi:[0,1]
  v_pk_fma_f32 v[6:7], v[60:61], v[60:61], v[6:7]
  v_pk_add_f32 v[62:63], v[62:63], v[4:5] neg_lo:[0,1] neg_hi:[0,1]
  v_pk_fma_f32 v[6:7], v[62:63], v[62:63], v[6:7]
  v_pk_add_f32 v[64:65], v[64:65], v[4:5] neg_lo:[0,1] neg_hi:[0,1]
  v_pk_fma_f32 v[6:7], v[64:65], v[64:65], v[6:7]
  v_add_f32 v6, v6, v7
  s_nop 1
  v_add_f32_dpp v6, v6, v6 row_ror:8 row_mask:0xf bank_mask:0xf
  s_nop 1
  v_add_f32_dpp v6, v6, v6 row_ror:4 row_mask:0xf bank_mask:0xf
  s_nop 1
  v_add_f32_dpp v6, v6, v6 row_ror:2 row_mask:0xf bank_mask:0xf
  s_nop 1
  v_add_f32_dpp v6, v6, v6 row_ror:1 row_mask:0xf bank_mask:0xf
  v_mov_b32 v7, s47
  v_fma_f32 v6, v6, s46, v7
  v_rsq_f32 v6, v6
  s_nop 0
  v_mov_b32 v7, v6
  v_pk_mul_f32 v[30:31], v[30:31], v[6:7]
  v_cvt_pk_bf16_f32 v10, v30, v31
  v_pk_mul_f32 v[32:33], v[32:33], v[6:7]
  v_cvt_pk_bf16_f32 v11, v32, v33
  v_pk_mul_f32 v[34:35], v[34:35], v[6:7]
  v_cvt_pk_bf16_f32 v12, v34, v35
  v_pk_mul_f32 v[36:37], v[36:37], v[6:7]
  v_cvt_pk_bf16_f32 v13, v36, v37
  v_pk_mul_f32 v[38:39], v[38:39], v[6:7]
  v_cvt_pk_bf16_f32 v14, v38, v39
  v_pk_mul_f32 v[40:41], v[40:41], v[6:7]
  v_cvt_pk_bf16_f32 v15, v40, v41
  v_pk_mul_f32 v[42:43], v[42:43], v[6:7]
  v_cvt_pk_bf16_f32 v16, v42, v43
  v_pk_mul_f32 v[44:45], v[44:45], v[6:7]
  v_cvt_pk_bf16_f32 v17, v44, v45
  v_pk_mul_f32 v[46:47], v[46:47], v[6:7]
  v_cvt_pk_bf16_f32 v18, v46, v47
  v_pk_mul_f32 v[48:49], v[48:49], v[6:7]
  v_cvt_pk_bf16_f32 v19, v48, v49
  v_pk_mul_f32 v[50:51], v[50:51], v[6:7]
  v_cvt_pk_bf16_f32 v20, v50, v51
  v_pk_mul_f32 v[52:53], v[52:53], v[6:7]
  v_cvt_pk_bf16_f32 v21, v52, v53
  v_pk_mul_f32 v[54:55], v[54:55], v[6:7]
  v_cvt_pk_bf16_f32 v22, v54, v55
  v_pk_mul_f32 v[56:57], v[56:57], v[6:7]
  v_cvt_pk_bf16_f32 v23, v56, v57
  v_pk_mul_f32 v[58:59], v[58:59], v[6:7]
  v_cvt_pk_bf16_f32 v24, v58, v59
  v_pk_mul_f32 v[60:61], v[60:61], v[6:7]
  v_cvt_pk_bf16_f32 v25, v60, v61
  v_pk_mul_f32 v[62:63], v[62:63], v[6:7]
  v_cvt_pk_bf16_f32 v26, v62, v63
  v_pk_mul_f32 v[64:65], v[64:65], v[6:7]
  v_cvt_pk_bf16_f32 v27, v64, v65
  buffer_store_dwordx2 v[10:11], v2, s[8:11], s45 offen offset:0 sc1
  buffer_store_dwordx2 v[12:13], v2, s[8:11], s45 offen offset:128 sc1
  buffer_store_dwordx2 v[14:15], v2, s[8:11], s45 offen offset:256 sc1
  buffer_store_dwordx2 v[16:17], v2, s[8:11], s45 offen offset:384 sc1
  buffer_store_dwordx2 v[18:19], v2, s[8:11], s45 offen offset:512 sc1
  buffer_store_dwordx2 v[20:21], v2, s[8:11], s45 offen offset:640 sc1
  buffer_store_dwordx2 v[22:23], v2, s[8:11], s45 offen offset:768 sc1
  buffer_store_dwordx2 v[24:25], v2, s[8:11], s45 offen offset:896 sc1
  buffer_store_dwordx2 v[26:27], v2, s[8:11], s45 offen offset:1024 sc1
  s_lshl_b32 s75, s6, 10
  s_add_u32 s75, s75, 71970816
  v_lshlrev_b32 v2, 7, v0
  v_mov_b32 v3, 1
  s_waitcnt vmcnt(0)
  s_mov_b64 exec, 0xff
  buffer_atomic_add v3, v2, s[8:11], s75 offen sc1
  s_mov_b64 exec, -1
  s_add_u32 s6, s6, 1
  s_cmp_lt_u32 s6, 16
  s_cbranch_scc1 LLOOP
  s_branch CHW
HASE:
  s_mul_i32 s68, s76, 171
  s_lshr_b32 s68, s68, 10
  s_mul_i32 s69, s68, 6
  s_sub_u32 s69, s76, s69
  s_mov_b32 s95, 12
  s_mov_b32 s98, 2
  s_cmp_ge_u32 s77, 192
  s_cbranch_scc1 NOWO
  s_and_b32 s74, s77, 7
  s_lshr_b32 s93, s77, 5
  s_cmp_ge_u32 s77, 96
  s_cselect_b32 s98, 1, 0
  s_add_u32 s95, s98, 14
  s_mul_i32 s44, s98, 3
  s_sub_u32 s93, s93, s44
  s_load_dwordx2 s[12:13], s[0:1], 40
  s_mov_b32 s14, 4718592
  s_mov_b32 s15, 0x00020000
  s_mul_i32 s40, s74, 589824
  s_mul_i32 s41, s93, 384
  s_add_u32 s40, s40, s41
  s_add_u32 s41, s40, 192
  s_and_b32 s48, s21, 1
  s_mul_i32 s48, s48, 3
  v_add_u32 v63, 0, v0
  v_mul_u32_u24 v62, 5462, v63
  v_lshrrev_b32 v62, 16, v62
  v_mul_u32_u24 v2, 12, v62
  v_sub_u32 v63, v63, v2
  v_bfe_u32 v2, v62, 2, 1
  v_lshlrev_b32 v2, 1, v2
  v_xor_b32 v63, v63, v2
  s_lshl_b32 s44, s21, 4
  v_add_u32 v62, s44, v62
  v_mul_u32_u24 v62, 1152, v62
  v_lshl_add_u32 v2, v63, 4, v62
  v_add_u32 v63, 64, v0
  v_mul_u32_u24 v62, 5462, v63
  v_lshrrev_b32 v62, 16, v62
  v_mul_u32_u24 v3, 12, v62
  v_sub_u32 v63, v63, v3
  v_bfe_u32 v3, v62, 2, 1
  v_lshlrev_b32 v3, 1, v3
  v_xor_b32 v63, v63, v3
  s_lshl_b32 s44, s21, 4
  v_add_u32 v62, s44, v62
  v_mul_u32_u24 v62, 1152, v62
  v_lshl_add_u32 v3, v63, 4, v62
  v_add_u32 v63, 128, v0
  v_mul_u32_u24 v62, 5462, v63
  v_lshrrev_b32 v62, 16, v62
  v_mul_u32_u24 v4, 12, v62
  v_sub_u32 v63, v63, v4
  v_bfe_u32 v4, v62, 2, 1
  v_lshlrev_b32 v4, 1, v4
  v_xor_b32 v63, v63, v4
  s_lshl_b32 s44, s21, 4
  v_add_u32 v62, s44, v62
  v_mul_u32_u24 v62, 1152, v62
  v_lshl_add_u32 v4, v63, 4, v62
  v_add_u32 v63, 0, v0
  v_mul_u32_u24 v62, 5462, v63
  v_lshrrev_b32 v62, 16, v62
  v_mul_u32_u24 v5, 12, v62
  v_sub_u32 v63, v63, v5
  v_bfe_u32 v5, v62, 2, 1
  v_lshlrev_b32 v5, 1, v5
  v_xor_b32 v63, v63, v5
  s_lshl_b32 s44, s21, 4
  v_add_u32 v62, s44, v62
  v_mul_u32_u24 v62, 1152, v62
  v_lshl_add_u32 v5, v63, 4, v62
  v_add_u32 v63, 64, v0
  v_mul_u32_u24 v62, 5462, v63
  v_lshrrev_b32 v62, 16, v62
  v_mul_u32_u24 v6, 12, v62
  v_sub_u32 v63, v63, v6
  v_bfe_u32 v6, v62, 2, 1
  v_lshlrev_b32 v6, 1, v6
  v_xor_b32 v63, v63, v6
  s_lshl_b32 s44, s21, 4
  v_add_u32 v62, s44, v62
  v_mul_u32_u24 v62, 1152, v62
  v_lshl_add_u32 v6, v63, 4, v62
  v_add_u32 v63, 128, v0
  v_mul_u32_u24 v62, 5462, v63
  v_lshrrev_b32 v62, 16, v62
  v_mul_u32_u24 v7, 12, v62
  v_sub_u32 v63, v63, v7
  v_bfe_u32 v7, v62, 2, 1
  v_lshlrev_b32 v7, 1, v7
  v_xor_b32 v63, v63, v7
  s_lshl_b32 s44, s21, 4
  v_add_u32 v62, s44, v62
  v_mul_u32_u24 v62, 1152, v62
  v_lshl_add_u32 v7, v63, 4, v62
  v_bfe_u32 v62, v0, 2, 4
  v_mul_u32_u24 v62, 192, v62
  v_bfe_u32 v63, v0, 0, 2
  v_mul_u32_u24 v63, 8, v63
  v_add_u32 v62, v62, v63
  v_add_u32 v62, 0, v62
  s_add_u32 s44, s48, 0
  v_bfe_u32 v63, v0, 4, 1
  v_xor_b32 v63, s44, v63
  v_lshl_add_u32 v8, v63, 5, v62
  s_add_u32 s44, s48, 1
  v_bfe_u32 v63, v0, 4, 1
  v_xor_b32 v63, s44, v63
  v_lshl_add_u32 v9, v63, 5, v62
  s_add_u32 s44, s48, 2
  v_bfe_u32 v63, v0, 4, 1
  v_xor_b32 v63, s44, v63
  v_lshl_add_u32 v10, v63, 5, v62
  v_bfe_u32 v62, v0, 2, 4
  v_mul_u32_u24 v62, 192, v62
  v_bfe_u32 v63, v0, 0, 2
  v_mul_u32_u24 v63, 8, v63
  v_add_u32 v62, v62, v63
  v_add_u32 v62, 12288, v62
  s_add_u32 s44, s48, 0
  v_bfe_u32 v63, v0, 4, 1
  v_xor_b32 v63, s44, v63
  v_lshl_add_u32 v11, v63, 5, v62
  s_add_u32 s44, s48, 1
  v_bfe_u32 v63, v0, 4, 1
  v_xor_b32 v63, s44, v63
  v_lshl_add_u32 v12, v63, 5, v62
  s_add_u32 s44, s48, 2
  v_bfe_u32 v63, v0, 4, 1
  v_xor_b32 v63, s44, v63
  v_lshl_add_u32 v13, v63, 5, v62
  s_lshr_b32 s44, s21, 1
  s_mul_i32 s44, s44, 12288
  s_waitcnt lgkmcnt(0)
  v_add_u32 v8, s44, v8
  v_add_u32 v11, 49152, v8
  v_add_u32 v9, s44, v9
  v_add_u32 v12, 49152, v9
  v_add_u32 v10, s44, v10
  v_add_u32 v13, 49152, v10
  s_barrier
  s_mul_i32 s44, s21, 3072
  s_add_u32 m0, s44, 0
  s_nop 0
  buffer_load_dwordx4 v2, s[12:15], s40 offen  lds
  s_add_u32 m0, s44, 1024
  s_nop 0
  buffer_load_dwordx4 v3, s[12:15], s40 offen  lds
  s_add_u32 m0, s44, 2048
  s_nop 0
  buffer_load_dwordx4 v4, s[12:15], s40 offen  lds
  s_add_u32 s40, s40, 73728
  s_mul_i32 s44, s21, 3072
  s_add_u32 m0, s44, 12288
  s_nop 0
  buffer_load_dwordx4 v5, s[12:15], s41 offen  lds
  s_add_u32 m0, s44, 13312
  s_nop 0
  buffer_load_dwordx4 v6, s[12:15], s41 offen  lds
  s_add_u32 m0, s44, 14336
  s_nop 0
  buffer_load_dwordx4 v7, s[12:15], s41 offen  lds
  s_add_u32 s41, s41, 73728
  s_mul_i32 s44, s21, 3072
  s_add_u32 m0, s44, 24576
  s_nop 0
  buffer_load_dwordx4 v2, s[12:15], s40 offen  lds
  s_add_u32 m0, s44, 25600
  s_nop 0
  buffer_load_dwordx4 v3, s[12:15], s40 offen  lds
  s_add_u32 m0, s44, 26624
  s_nop 0
  buffer_load_dwordx4 v4, s[12:15], s40 offen  lds
  s_add_u32 s40, s40, 73728
  s_mul_i32 s44, s21, 3072
  s_add_u32 m0, s44, 36864
  s_nop 0
  buffer_load_dwordx4 v5, s[12:15], s41 offen  lds
  s_add_u32 m0, s44, 37888
  s_nop 0
  buffer_load_dwordx4 v6, s[12:15], s41 offen  lds
  s_add_u32 m0, s44, 38912
  s_nop 0
  buffer_load_dwordx4 v7, s[12:15], s41 offen  lds
  s_add_u32 s41, s41, 73728
  s_mul_i32 s44, s21, 3072
  s_add_u32 m0, s44, 49152
  s_nop 0
  buffer_load_dwordx4 v2, s[12:15], s40 offen  lds
  s_add_u32 m0, s44, 50176
  s_nop 0
  buffer_load_dwordx4 v3, s[12:15], s40 offen  lds
  s_add_u32 m0, s44, 51200
  s_nop 0
  buffer_load_dwordx4 v4, s[12:15], s40 offen  lds
  s_add_u32 s40, s40, 73728
  s_mul_i32 s44, s21, 3072
  s_add_u32 m0, s44, 61440
  s_nop 0
  buffer_load_dwordx4 v5, s[12:15], s41 offen  lds
  s_add_u32 m0, s44, 62464
  s_nop 0
  buffer_load_dwordx4 v6, s[12:15], s41 offen  lds
  s_add_u32 m0, s44, 63488
  s_nop 0
  buffer_load_dwordx4 v7, s[12:15], s41 offen  lds
  s_add_u32 s41, s41, 73728
  s_mul_i32 s44, s21, 3072
  s_add_u32 m0, s44, 73728
  s_nop 0
  buffer_load_dwordx4 v2, s[12:15], s40 offen  lds
  s_add_u32 m0, s44, 74752
  s_nop 0
  buffer_load_dwordx4 v3, s[12:15], s40 offen  lds
  s_add_u32 m0, s44, 75776
  s_nop 0
  buffer_load_dwordx4 v4, s[12:15], s40 offen  lds
  s_add_u32 s40, s40, 73728
  s_mul_i32 s44, s21, 3072
  s_add_u32 m0, s44, 86016
  s_nop 0
  buffer_load_dwordx4 v5, s[12:15], s41 offen  lds
  s_add_u32 m0, s44, 87040
  s_nop 0
  buffer_load_dwordx4 v6, s[12:15], s41 offen  lds
  s_add_u32 m0, s44, 88064
  s_nop 0
  buffer_load_dwordx4 v7, s[12:15], s41 offen  lds
  s_add_u32 s41, s41, 73728
  s_waitcnt vmcnt(0)
  s_barrier
  ds_read_b64_tr_b16 a[0:1], v8 offset:0
  ds_read_b64_tr_b16 a[2:3], v8 offset:3072
  ds_read_b64_tr_b16 a[64:65], v9 offset:0
  ds_read_b64_tr_b16 a[66:67], v9 offset:3072
  ds_read_b64_tr_b16 a[128:129], v10 offset:0
  ds_read_b64_tr_b16 a[130:131], v10 offset:3072
  ds_read_b64_tr_b16 a[4:5], v8 offset:6144
  ds_read_b64_tr_b16 a[6:7], v8 offset:9216
  ds_read_b64_tr_b16 a[68:69], v9 offset:6144
  ds_read_b64_tr_b16 a[70:71], v9 offset:9216
  ds_read_b64_tr_b16 a[132:133], v10 offset:6144
  ds_read_b64_tr_b16 a[134:135], v10 offset:9216
  ds_read_b64_tr_b16 a[8:9], v8 offset:24576
  ds_read_b64_tr_b16 a[10:11], v8 offset:27648
  ds_read_b64_tr_b16 a[72:73], v9 offset:24576
  ds_read_b64_tr_b16 a[74:75], v9 offset:27648
  ds_read_b64_tr_b16 a[136:137], v10 offset:24576
  ds_read_b64_tr_b16 a[138:139], v10 offset:27648
  ds_read_b64_tr_b16 a[12:13], v8 offset:30720
  ds_read_b64_tr_b16 a[14:15], v8 offset:33792
  ds_read_b64_tr_b16 a[76:77], v9 offset:30720
  ds_read_b64_tr_b16 a[78:79], v9 offset:33792
  ds_read_b64_tr_b16 a[140:141], v10 offset:30720
  ds_read_b64_tr_b16 a[142:143], v10 offset:33792
  ds_read_b64_tr_b16 a[16:17], v11 offset:0
  ds_read_b64_tr_b16 a[18:19], v11 offset:3072
  ds_read_b64_tr_b16 a[80:81], v12 offset:0
  ds_read_b64_tr_b16 a[82:83], v12 offset:3072
  ds_read_b64_tr_b16 a[144:145], v13 offset:0
  ds_read_b64_tr_b16 a[146:147], v13 offset:3072
  ds_read_b64_tr_b16 a[20:21], v11 offset:6144
  ds_read_b64_tr_b16 a[22:23], v11 offset:9216
  ds_read_b64_tr_b16 a[84:85], v12 offset:6144
  ds_read_b64_tr_b16 a[86:87], v12 offset:9216
  ds_read_b64_tr_b16 a[148:149], v13 offset:6144
  ds_read_b64_tr_b16 a[150:151], v13 offset:9216
  ds_read_b64_tr_b16 a[24:25], v11 offset:24576
  ds_read_b64_tr_b16 a[26:27], v11 offset:27648
  ds_read_b64_tr_b16 a[88:89], v12 offset:24576
  ds_read_b64_tr_b16 a[90:91], v12 offset:27648
  ds_read_b64_tr_b16 a[152:153], v13 offset:24576
  ds_read_b64_tr_b16 a[154:155], v13 offset:27648
  ds_read_b64_tr_b16 a[28:29], v11 offset:30720
  ds_read_b64_tr_b16 a[30:31], v11 offset:33792
  ds_read_b64_tr_b16 a[92:93], v12 offset:30720
  ds_read_b64_tr_b16 a[94:95], v12 offset:33792
  ds_read_b64_tr_b16 a[156:157], v13 offset:30720
  ds_read_b64_tr_b16 a[158:159], v13 offset:33792
  s_waitcnt lgkmcnt(0)
  s_barrier
  s_mul_i32 s44, s21, 3072
  s_add_u32 m0, s44, 0
  s_nop 0
  buffer_load_dwordx4 v2, s[12:15], s40 offen  lds
  s_add_u32 m0, s44, 1024
  s_nop 0
  buffer_load_dwordx4 v3, s[12:15], s40 offen  lds
  s_add_u32 m0, s44, 2048
  s_nop 0
  buffer_load_dwordx4 v4, s[12:15], s40 offen  lds
  s_add_u32 s40, s40, 73728
  s_mul_i32 s44, s21, 3072
  s_add_u32 m0, s44, 12288
  s_nop 0
  buffer_load_dwordx4 v5, s[12:15], s41 offen  lds
  s_add_u32 m0, s44, 13312
  s_nop 0
  buffer_load_dwordx4 v6, s[12:15], s41 offen  lds
  s_add_u32 m0, s44, 14336
  s_nop 0
  buffer_load_dwordx4 v7, s[12:15], s41 offen  lds
  s_add_u32 s41, s41, 73728
  s_mul_i32 s44, s21, 3072
  s_add_u32 m0, s44, 24576
  s_nop 0
  buffer_load_dwordx4 v2, s[12:15], s40 offen  lds
  s_add_u32 m0, s44, 25600
  s_nop 0
  buffer_load_dwordx4 v3, s[12:15], s40 offen  lds
  s_add_u32 m0, s44, 26624
  s_nop 0
  buffer_load_dwordx4 v4, s[12:15], s40 offen  lds
  s_add_u32 s40, s40, 73728
  s_mul_i32 s44, s21, 3072
  s_add_u32 m0, s44, 36864
  s_nop 0
  buffer_load_dwordx4 v5, s[12:15], s41 offen  lds
  s_add_u32 m0, s44, 37888
  s_nop 0
  buffer_load_dwordx4 v6, s[12:15], s41 offen  lds
  s_add_u32 m0, s44, 38912
  s_nop 0
  buffer_load_dwordx4 v7, s[12:15], s41 offen  lds
  s_add_u32 s41, s41, 73728
  s_mul_i32 s44, s21, 3072
  s_add_u32 m0, s44, 49152
  s_nop 0
  buffer_load_dwordx4 v2, s[12:15], s40 offen  lds
  s_add_u32 m0, s44, 50176
  s_nop 0
  buffer_load_dwordx4 v3, s[12:15], s40 offen  lds
  s_add_u32 m0, s44, 51200
  s_nop 0
  buffer_load_dwordx4 v4, s[12:15], s40 offen  lds
  s_add_u32 s40, s40, 73728
  s_mul_i32 s44, s21, 3072
  s_add_u32 m0, s44, 61440
  s_nop 0
  buffer_load_dwordx4 v5, s[12:15], s41 offen  lds
  s_add_u32 m0, s44, 62464
  s_nop 0
  buffer_load_dwordx4 v6, s[12:15], s41 offen  lds
  s_add_u32 m0, s44, 63488
  s_nop 0
  buffer_load_dwordx4 v7, s[12:15], s41 offen  lds
  s_add_u32 s41, s41, 73728
  s_mul_i32 s44, s21, 3072
  s_add_u32 m0, s44, 73728
  s_nop 0
  buffer_load_dwordx4 v2, s[12:15], s40 offen  lds
  s_add_u32 m0, s44, 74752
  s_nop 0
  buffer_load_dwordx4 v3, s[12:15], s40 offen  lds
  s_add_u32 m0, s44, 75776
  s_nop 0
  buffer_load_dwordx4 v4, s[12:15], s40 offen  lds
  s_add_u32 s40, s40, 73728
  s_mul_i32 s44, s21, 3072
  s_add_u32 m0, s44, 86016
  s_nop 0
  buffer_load_dwordx4 v5, s[12:15], s41 offen  lds
  s_add_u32 m0, s44, 87040
  s_nop 0
  buffer_load_dwordx4 v6, s[12:15], s41 offen  lds
  s_add_u32 m0, s44, 88064
  s_nop 0
  buffer_load_dwordx4 v7, s[12:15], s41 offen  lds
  s_add_u32 s41, s41, 73728
  s_waitcnt vmcnt(0)
  s_barrier
  ds_read_b64_tr_b16 a[32:33], v8 offset:0
  ds_read_b64_tr_b16 a[34:35], v8 offset:3072
  ds_read_b64_tr_b16 a[96:97], v9 offset:0
  ds_read_b64_tr_b16 a[98:99], v9 offset:3072
  ds_read_b64_tr_b16 a[160:161], v10 offset:0
  ds_read_b64_tr_b16 a[162:163], v10 offset:3072
  ds_read_b64_tr_b16 a[36:37], v8 offset:6144
  ds_read_b64_tr_b16 a[38:39], v8 offset:9216
  ds_read_b64_tr_b16 a[100:101], v9 offset:6144
  ds_read_b64_tr_b16 a[102:103], v9 offset:9216
  ds_read_b64_tr_b16 a[164:165], v10 offset:6144
  ds_read_b64_tr_b16 a[166:167], v10 offset:9216
  ds_read_b64_tr_b16 a[40:41], v8 offset:24576
  ds_read_b64_tr_b16 a[42:43], v8 offset:27648
  ds_read_b64_tr_b16 a[104:105], v9 offset:24576
  ds_read_b64_tr_b16 a[106:107], v9 offset:27648
  ds_read_b64_tr_b16 a[168:169], v10 offset:24576
  ds_read_b64_tr_b16 a[170:171], v10 offset:27648
  ds_read_b64_tr_b16 a[44:45], v8 offset:30720
  ds_read_b64_tr_b16 a[46:47], v8 offset:33792
  ds_read_b64_tr_b16 a[108:109], v9 offset:30720
  ds_read_b64_tr_b16 a[110:111], v9 offset:33792
  ds_read_b64_tr_b16 a[172:173], v10 offset:30720
  ds_read_b64_tr_b16 a[174:175], v10 offset:33792
  ds_read_b64_tr_b16 a[48:49], v11 offset:0
  ds_read_b64_tr_b16 a[50:51], v11 offset:3072
  ds_read_b64_tr_b16 a[112:113], v12 offset:0
  ds_read_b64_tr_b16 a[114:115], v12 offset:3072
  ds_read_b64_tr_b16 a[176:177], v13 offset:0
  ds_read_b64_tr_b16 a[178:179], v13 offset:3072
  ds_read_b64_tr_b16 a[52:53], v11 offset:6144
  ds_read_b64_tr_b16 a[54:55], v11 offset:9216
  ds_read_b64_tr_b16 a[116:117], v12 offset:6144
  ds_read_b64_tr_b16 a[118:119], v12 offset:9216
  ds_read_b64_tr_b16 a[180:181], v13 offset:6144
  ds_read_b64_tr_b16 a[182:183], v13 offset:9216
  ds_read_b64_tr_b16 a[56:57], v11 offset:24576
  ds_read_b64_tr_b16 a[58:59], v11 offset:27648
  ds_read_b64_tr_b16 a[120:121], v12 offset:24576
  ds_read_b64_tr_b16 a[122:123], v12 offset:27648
  ds_read_b64_tr_b16 a[184:185], v13 offset:24576
  ds_read_b64_tr_b16 a[186:187], v13 offset:27648
  ds_read_b64_tr_b16 a[60:61], v11 offset:30720
  ds_read_b64_tr_b16 a[62:63], v11 offset:33792
  ds_read_b64_tr_b16 a[124:125], v12 offset:30720
  ds_read_b64_tr_b16 a[126:127], v12 offset:33792
  ds_read_b64_tr_b16 a[188:189], v13 offset:30720
  ds_read_b64_tr_b16 a[190:191], v13 offset:33792
  s_waitcnt lgkmcnt(0)
  s_cmp_lt_u32 s77, 96
  s_cbranch_scc1 WODONE
NOWO:
  s_sub_u32 s7, s77, 96
  s_lshl_b32 s7, s7, 2
  s_add_u32 s7, s7, s21
  s_load_dwordx2 s[12:13], s[0:1], 80
  s_mov_b32 s14, 18874368
  s_mov_b32 s15, 0x00020000
  s_mul_i32 s47, s21, 24576
  v_bfe_u32 v2, v0, 4, 2
  v_mul_u32_u24 v2, 2, v2
  v_and_b32 v3, 7, v0
  v_xor_b32 v2, v2, v3
  v_lshlrev_b32 v2, 4, v2
  v_lshrrev_b32 v3, 3, v0
  v_lshl_add_u32 v2, v3, 12, v2
  v_add_u32 v3, 32768, v2
  v_add_u32 v4, 65536, v2
  v_add_u32 v5, 98304, v2
  v_bfe_u32 v10, v0, 2, 4
  v_mul_u32_u24 v10, 128, v10
  v_bfe_u32 v11, v0, 0, 2
  v_mul_u32_u24 v11, 8, v11
  v_add_u32 v10, v10, v11
  v_add_u32 v10, s47, v10
  v_bfe_u32 v11, v0, 3, 2
  v_xor_b32 v11, 0, v11
  v_lshl_add_u32 v6, v11, 5, v10
  v_bfe_u32 v11, v0, 3, 2
  v_xor_b32 v11, 1, v11
  v_lshl_add_u32 v7, v11, 5, v10
  v_bfe_u32 v11, v0, 3, 2
  v_xor_b32 v11, 2, v11
  v_lshl_add_u32 v8, v11, 5, v10
  v_bfe_u32 v11, v0, 3, 2
  v_xor_b32 v11, 3, v11
  v_lshl_add_u32 v9, v11, 5, v10
  v_lshlrev_b32 v10, 4, v0
  s_waitcnt lgkmcnt(0)
  s_barrier
  s_add_u32 s44, s7, 0
  s_min_u32 s44, s44, 4607
  s_lshr_b32 s45, s44, 5
  s_and_b32 s44, s44, 31
  s_lshl_b32 s40, s45, 17
  s_lshl_b32 s41, s44, 7
  s_add_u32 s40, s40, s41
  s_mul_i32 s44, s44, 589824
  s_lshl_b32 s41, s45, 10
  s_add_u32 s44, s44, s41
  s_add_u32 s60, s44, 184549376
  s_add_u32 m0, s47, 0
  s_nop 0
  buffer_load_dwordx4 v2, s[12:15], s40 offen lds
  s_add_u32 m0, s47, 1024
  s_nop 0
  buffer_load_dwordx4 v3, s[12:15], s40 offen lds
  s_add_u32 m0, s47, 2048
  s_nop 0
  buffer_load_dwordx4 v4, s[12:15], s40 offen lds
  s_add_u32 m0, s47, 3072
  s_nop 0
  buffer_load_dwordx4 v5, s[12:15], s40 offen lds
  s_add_u32 s44, s7, 480
  s_min_u32 s44, s44, 4607
  s_lshr_b32 s45, s44, 5
  s_and_b32 s44, s44, 31
  s_lshl_b32 s40, s45, 17
  s_lshl_b32 s41, s44, 7
  s_add_u32 s40, s40, s41
  s_mul_i32 s44, s44, 589824
  s_lshl_b32 s41, s45, 10
  s_add_u32 s44, s44, s41
  s_add_u32 s61, s44, 184549376
  s_add_u32 m0, s47, 4096
  s_nop 0
  buffer_load_dwordx4 v2, s[12:15], s40 offen lds
  s_add_u32 m0, s47, 5120
  s_nop 0
  buffer_load_dwordx4 v3, s[12:15], s40 offen lds
  s_add_u32 m0, s47, 6144
  s_nop 0
  buffer_load_dwordx4 v4, s[12:15], s40 offen lds
  s_add_u32 m0, s47, 7168
  s_nop 0
  buffer_load_dwordx4 v5, s[12:15], s40 offen lds
  s_add_u32 s44, s7, 960
  s_min_u32 s44, s44, 4607
  s_lshr_b32 s45, s44, 5
  s_and_b32 s44, s44, 31
  s_lshl_b32 s40, s45, 17
  s_lshl_b32 s41, s44, 7
  s_add_u32 s40, s40, s41
  s_mul_i32 s44, s44, 589824
  s_lshl_b32 s41, s45, 10
  s_add_u32 s44, s44, s41
  s_add_u32 s62, s44, 184549376
  s_add_u32 m0, s47, 8192
  s_nop 0
  buffer_load_dwordx4 v2, s[12:15], s40 offen lds
  s_add_u32 m0, s47, 9216
  s_nop 0
  buffer_load_dwordx4 v3, s[12:15], s40 offen lds
  s_add_u32 m0, s47, 10240
  s_nop 0
  buffer_load_dwordx4 v4, s[12:15], s40 offen lds
  s_add_u32 m0, s47, 11264
  s_nop 0
  buffer_load_dwordx4 v5, s[12:15], s40 offen lds
  s_add_u32 s44, s7, 1440
  s_min_u32 s44, s44, 4607
  s_lshr_b32 s45, s44, 5
  s_and_b32 s44, s44, 31
  s_lshl_b32 s40, s45, 17
  s_lshl_b32 s41, s44, 7
  s_add_u32 s40, s40, s41
  s_mul_i32 s44, s44, 589824
  s_lshl_b32 s41, s45, 10
  s_add_u32 s44, s44, s41
  s_add_u32 s63, s44, 184549376
  s_add_u32 m0, s47, 12288
  s_nop 0
  buffer_load_dwordx4 v2, s[12:15], s40 offen lds
  s_add_u32 m0, s47, 13312
  s_nop 0
  buffer_load_dwordx4 v3, s[12:15], s40 offen lds
  s_add_u32 m0, s47, 14336
  s_nop 0
  buffer_load_dwordx4 v4, s[12:15], s40 offen lds
  s_add_u32 m0, s47, 15360
  s_nop 0
  buffer_load_dwordx4 v5, s[12:15], s40 offen lds
  s_add_u32 s44, s7, 1920
  s_min_u32 s44, s44, 4607
  s_lshr_b32 s45, s44, 5
  s_and_b32 s44, s44, 31
  s_lshl_b32 s40, s45, 17
  s_lshl_b32 s41, s44, 7
  s_add_u32 s40, s40, s41
  s_mul_i32 s44, s44, 589824
  s_lshl_b32 s41, s45, 10
  s_add_u32 s44, s44, s41
  s_add_u32 s64, s44, 184549376
  s_add_u32 m0, s47, 16384
  s_nop 0
  buffer_load_dwordx4 v2, s[12:15], s40 offen lds
  s_add_u32 m0, s47, 17408
  s_nop 0
  buffer_load_dwordx4 v3, s[12:15], s40 offen lds
  s_add_u32 m0, s47, 18432
  s_nop 0
  buffer_load_dwordx4 v4, s[12:15], s40 offen lds
  s_add_u32 m0, s47, 19456
  s_nop 0
  buffer_load_dwordx4 v5, s[12:15], s40 offen lds
  s_waitcnt vmcnt(0)
  ds_read_b64_tr_b16 v[16:17], v6 offset:0
  ds_read_b64_tr_b16 v[18:19], v6 offset:2048
  ds_read_b64_tr_b16 v[20:21], v7 offset:0
  ds_read_b64_tr_b16 v[22:23], v7 offset:2048
  ds_read_b64_tr_b16 v[24:25], v8 offset:0
  ds_read_b64_tr_b16 v[26:27], v8 offset:2048
  ds_read_b64_tr_b16 v[28:29], v9 offset:0
  ds_read_b64_tr_b16 v[30:31], v9 offset:2048
  s_waitcnt lgkmcnt(0)
  buffer_store_dwordx4 v[16:19], v10, s[8:11], s60 offen sc1
  s_add_u32 s60, s60, 147456
  buffer_store_dwordx4 v[20:23], v10, s[8:11], s60 offen sc1
  s_add_u32 s60, s60, 147456
  buffer_store_dwordx4 v[24:27], v10, s[8:11], s60 offen sc1
  s_add_u32 s60, s60, 147456
  buffer_store_dwordx4 v[28:31], v10, s[8:11], s60 offen sc1
  s_add_u32 s60, s60, 147456
  ds_read_b64_tr_b16 v[32:33], v6 offset:4096
  ds_read_b64_tr_b16 v[34:35], v6 offset:6144
  ds_read_b64_tr_b16 v[36:37], v7 offset:4096
  ds_read_b64_tr_b16 v[38:39], v7 offset:6144
  ds_read_b64_tr_b16 v[40:41], v8 offset:4096
  ds_read_b64_tr_b16 v[42:43], v8 offset:6144
  ds_read_b64_tr_b16 v[44:45], v9 offset:4096
  ds_read_b64_tr_b16 v[46:47], v9 offset:6144
  s_waitcnt lgkmcnt(0)
  buffer_store_dwordx4 v[32:35], v10, s[8:11], s61 offen sc1
  s_add_u32 s61, s61, 147456
  buffer_store_dwordx4 v[36:39], v10, s[8:11], s61 offen sc1
  s_add_u32 s61, s61, 147456
  buffer_store_dwordx4 v[40:43], v10, s[8:11], s61 offen sc1
  s_add_u32 s61, s61, 147456
  buffer_store_dwordx4 v[44:47], v10, s[8:11], s61 offen sc1
  s_add_u32 s61, s61, 147456
  ds_read_b64_tr_b16 v[48:49], v6 offset:8192
  ds_read_b64_tr_b16 v[50:51], v6 offset:10240
  ds_read_b64_tr_b16 v[52:53], v7 offset:8192
  ds_read_b64_tr_b16 v[54:55], v7 offset:10240
  ds_read_b64_tr_b16 v[56:57], v8 offset:8192
  ds_read_b64_tr_b16 v[58:59], v8 offset:10240
  ds_read_b64_tr_b16 v[60:61], v9 offset:8192
  ds_read_b64_tr_b16 v[62:63], v9 offset:10240
  s_waitcnt lgkmcnt(0)
  buffer_store_dwordx4 v[48:51], v10, s[8:11], s62 offen sc1
  s_add_u32 s62, s62, 147456
  buffer_store_dwordx4 v[52:55], v10, s[8:11], s62 offen sc1
  s_add_u32 s62, s62, 147456
  buffer_store_dwordx4 v[56:59], v10, s[8:11], s62 offen sc1
  s_add_u32 s62, s62, 147456
  buffer_store_dwordx4 v[60:63], v10, s[8:11], s62 offen sc1
  s_add_u32 s62, s62, 147456
  ds_read_b64_tr_b16 v[64:65], v6 offset:12288
  ds_read_b64_tr_b16 v[66:67], v6 offset:14336
  ds_read_b64_tr_b16 v[68:69], v7 offset:12288
  ds_read_b64_tr_b16 v[70:71], v7 offset:14336
  ds_read_b64_tr_b16 v[72:73], v8 offset:12288
  ds_read_b64_tr_b16 v[74:75], v8 offset:14336
  ds_read_b64_tr_b16 v[76:77], v9 offset:12288
  ds_read_b64_tr_b16 v[78:79], v9 offset:14336
  s_waitcnt lgkmcnt(0)
  buffer_store_dwordx4 v[64:67], v10, s[8:11], s63 offen sc1
  s_add_u32 s63, s63, 147456
  buffer_store_dwordx4 v[68:71], v10, s[8:11], s63 offen sc1
  s_add_u32 s63, s63, 147456
  buffer_store_dwordx4 v[72:75], v10, s[8:11], s63 offen sc1
  s_add_u32 s63, s63, 147456
  buffer_store_dwordx4 v[76:79], v10, s[8:11], s63 offen sc1
  s_add_u32 s63, s63, 147456
  ds_read_b64_tr_b16 v[80:81], v6 offset:16384
  ds_read_b64_tr_b16 v[82:83], v6 offset:18432
  ds_read_b64_tr_b16 v[84:85], v7 offset:16384
  ds_read_b64_tr_b16 v[86:87], v7 offset:18432
  ds_read_b64_tr_b16 v[88:89], v8 offset:16384
  ds_read_b64_tr_b16 v[90:91], v8 offset:18432
  ds_read_b64_tr_b16 v[92:93], v9 offset:16384
  ds_read_b64_tr_b16 v[94:95], v9 offset:18432
  s_waitcnt lgkmcnt(0)
  buffer_store_dwordx4 v[80:83], v10, s[8:11], s64 offen sc1
  s_add_u32 s64, s64, 147456
  buffer_store_dwordx4 v[84:87], v10, s[8:11], s64 offen sc1
  s_add_u32 s64, s64, 147456
  buffer_store_dwordx4 v[88:91], v10, s[8:11], s64 offen sc1
  s_add_u32 s64, s64, 147456
  buffer_store_dwordx4 v[92:95], v10, s[8:11], s64 offen sc1
  s_add_u32 s64, s64, 147456
  s_add_u32 s44, s7, 2400
  s_min_u32 s44, s44, 4607
  s_lshr_b32 s45, s44, 5
  s_and_b32 s44, s44, 31
  s_lshl_b32 s40, s45, 17
  s_lshl_b32 s41, s44, 7
  s_add_u32 s40, s40, s41
  s_mul_i32 s44, s44, 589824
  s_lshl_b32 s41, s45, 10
  s_add_u32 s44, s44, s41
  s_add_u32 s60, s44, 184549376
  s_add_u32 m0, s47, 0
  s_nop 0
  buffer_load_dwordx4 v2, s[12:15], s40 offen lds
  s_add_u32 m0, s47, 1024
  s_nop 0
  buffer_load_dwordx4 v3, s[12:15], s40 offen lds
  s_add_u32 m0, s47, 2048
  s_nop 0
  buffer_load_dwordx4 v4, s[12:15], s40 offen lds
  s_add_u32 m0, s47, 3072
  s_nop 0
  buffer_load_dwordx4 v5, s[12:15], s40 offen lds
  s_add_u32 s44, s7, 2880
  s_min_u32 s44, s44, 4607
  s_lshr_b32 s45, s44, 5
  s_and_b32 s44, s44, 31
  s_lshl_b32 s40, s45, 17
  s_lshl_b32 s41, s44, 7
  s_add_u32 s40, s40, s41
  s_mul_i32 s44, s44, 589824
  s_lshl_b32 s41, s45, 10
  s_add_u32 s44, s44, s41
  s_add_u32 s61, s44, 184549376
  s_add_u32 m0, s47, 4096
  s_nop 0
  buffer_load_dwordx4 v2, s[12:15], s40 offen lds
  s_add_u32 m0, s47, 5120
  s_nop 0
  buffer_load_dwordx4 v3, s[12:15], s40 offen lds
  s_add_u32 m0, s47, 6144
  s_nop 0
  buffer_load_dwordx4 v4, s[12:15], s40 offen lds
  s_add_u32 m0, s47, 7168
  s_nop 0
  buffer_load_dwordx4 v5, s[12:15], s40 offen lds
  s_add_u32 s44, s7, 3360
  s_min_u32 s44, s44, 4607
  s_lshr_b32 s45, s44, 5
  s_and_b32 s44, s44, 31
  s_lshl_b32 s40, s45, 17
  s_lshl_b32 s41, s44, 7
  s_add_u32 s40, s40, s41
  s_mul_i32 s44, s44, 589824
  s_lshl_b32 s41, s45, 10
  s_add_u32 s44, s44, s41
  s_add_u32 s62, s44, 184549376
  s_add_u32 m0, s47, 8192
  s_nop 0
  buffer_load_dwordx4 v2, s[12:15], s40 offen lds
  s_add_u32 m0, s47, 9216
  s_nop 0
  buffer_load_dwordx4 v3, s[12:15], s40 offen lds
  s_add_u32 m0, s47, 10240
  s_nop 0
  buffer_load_dwordx4 v4, s[12:15], s40 offen lds
  s_add_u32 m0, s47, 11264
  s_nop 0
  buffer_load_dwordx4 v5, s[12:15], s40 offen lds
  s_add_u32 s44, s7, 3840
  s_min_u32 s44, s44, 4607
  s_lshr_b32 s45, s44, 5
  s_and_b32 s44, s44, 31
  s_lshl_b32 s40, s45, 17
  s_lshl_b32 s41, s44, 7
  s_add_u32 s40, s40, s41
  s_mul_i32 s44, s44, 589824
  s_lshl_b32 s41, s45, 10
  s_add_u32 s44, s44, s41
  s_add_u32 s63, s44, 184549376
  s_add_u32 m0, s47, 12288
  s_nop 0
  buffer_load_dwordx4 v2, s[12:15], s40 offen lds
  s_add_u32 m0, s47, 13312
  s_nop 0
  buffer_load_dwordx4 v3, s[12:15], s40 offen lds
  s_add_u32 m0, s47, 14336
  s_nop 0
  buffer_load_dwordx4 v4, s[12:15], s40 offen lds
  s_add_u32 m0, s47, 15360
  s_nop 0
  buffer_load_dwordx4 v5, s[12:15], s40 offen lds
  s_add_u32 s44, s7, 4320
  s_min_u32 s44, s44, 4607
  s_lshr_b32 s45, s44, 5
  s_and_b32 s44, s44, 31
  s_lshl_b32 s40, s45, 17
  s_lshl_b32 s41, s44, 7
  s_add_u32 s40, s40, s41
  s_mul_i32 s44, s44, 589824
  s_lshl_b32 s41, s45, 10
  s_add_u32 s44, s44, s41
  s_add_u32 s64, s44, 184549376
  s_add_u32 m0, s47, 16384
  s_nop 0
  buffer_load_dwordx4 v2, s[12:15], s40 offen lds
  s_add_u32 m0, s47, 17408
  s_nop 0
  buffer_load_dwordx4 v3, s[12:15], s40 offen lds
  s_add_u32 m0, s47, 18432
  s_nop 0
  buffer_load_dwordx4 v4, s[12:15], s40 offen lds
  s_add_u32 m0, s47, 19456
  s_nop 0
  buffer_load_dwordx4 v5, s[12:15], s40 offen lds
  s_waitcnt vmcnt(0)
  ds_read_b64_tr_b16 v[16:17], v6 offset:0
  ds_read_b64_tr_b16 v[18:19], v6 offset:2048
  ds_read_b64_tr_b16 v[20:21], v7 offset:0
  ds_read_b64_tr_b16 v[22:23], v7 offset:2048
  ds_read_b64_tr_b16 v[24:25], v8 offset:0
  ds_read_b64_tr_b16 v[26:27], v8 offset:2048
  ds_read_b64_tr_b16 v[28:29], v9 offset:0
  ds_read_b64_tr_b16 v[30:31], v9 offset:2048
  s_waitcnt lgkmcnt(0)
  buffer_store_dwordx4 v[16:19], v10, s[8:11], s60 offen sc1
  s_add_u32 s60, s60, 147456
  buffer_store_dwordx4 v[20:23], v10, s[8:11], s60 offen sc1
  s_add_u32 s60, s60, 147456
  buffer_store_dwordx4 v[24:27], v10, s[8:11], s60 offen sc1
  s_add_u32 s60, s60, 147456
  buffer_store_dwordx4 v[28:31], v10, s[8:11], s60 offen sc1
  s_add_u32 s60, s60, 147456
  ds_read_b64_tr_b16 v[32:33], v6 offset:4096
  ds_read_b64_tr_b16 v[34:35], v6 offset:6144
  ds_read_b64_tr_b16 v[36:37], v7 offset:4096
  ds_read_b64_tr_b16 v[38:39], v7 offset:6144
  ds_read_b64_tr_b16 v[40:41], v8 offset:4096
  ds_read_b64_tr_b16 v[42:43], v8 offset:6144
  ds_read_b64_tr_b16 v[44:45], v9 offset:4096
  ds_read_b64_tr_b16 v[46:47], v9 offset:6144
  s_waitcnt lgkmcnt(0)
  buffer_store_dwordx4 v[32:35], v10, s[8:11], s61 offen sc1
  s_add_u32 s61, s61, 147456
  buffer_store_dwordx4 v[36:39], v10, s[8:11], s61 offen sc1
  s_add_u32 s61, s61, 147456
  buffer_store_dwordx4 v[40:43], v10, s[8:11], s61 offen sc1
  s_add_u32 s61, s61, 147456
  buffer_store_dwordx4 v[44:47], v10, s[8:11], s61 offen sc1
  s_add_u32 s61, s61, 147456
  ds_read_b64_tr_b16 v[48:49], v6 offset:8192
  ds_read_b64_tr_b16 v[50:51], v6 offset:10240
  ds_read_b64_tr_b16 v[52:53], v7 offset:8192
  ds_read_b64_tr_b16 v[54:55], v7 offset:10240
  ds_read_b64_tr_b16 v[56:57], v8 offset:8192
  ds_read_b64_tr_b16 v[58:59], v8 offset:10240
  ds_read_b64_tr_b16 v[60:61], v9 offset:8192
  ds_read_b64_tr_b16 v[62:63], v9 offset:10240
  s_waitcnt lgkmcnt(0)
  buffer_store_dwordx4 v[48:51], v10, s[8:11], s62 offen sc1
  s_add_u32 s62, s62, 147456
  buffer_store_dwordx4 v[52:55], v10, s[8:11], s62 offen sc1
  s_add_u32 s62, s62, 147456
  buffer_store_dwordx4 v[56:59], v10, s[8:11], s62 offen sc1
  s_add_u32 s62, s62, 147456
  buffer_store_dwordx4 v[60:63], v10, s[8:11], s62 offen sc1
  s_add_u32 s62, s62, 147456
  ds_read_b64_tr_b16 v[64:65], v6 offset:12288
  ds_read_b64_tr_b16 v[66:67], v6 offset:14336
  ds_read_b64_tr_b16 v[68:69], v7 offset:12288
  ds_read_b64_tr_b16 v[70:71], v7 offset:14336
  ds_read_b64_tr_b16 v[72:73], v8 offset:12288
  ds_read_b64_tr_b16 v[74:75], v8 offset:14336
  ds_read_b64_tr_b16 v[76:77], v9 offset:12288
  ds_read_b64_tr_b16 v[78:79], v9 offset:14336
  s_waitcnt lgkmcnt(0)
  buffer_store_dwordx4 v[64:67], v10, s[8:11], s63 offen sc1
  s_add_u32 s63, s63, 147456
  buffer_store_dwordx4 v[68:71], v10, s[8:11], s63 offen sc1
  s_add_u32 s63, s63, 147456
  buffer_store_dwordx4 v[72:75], v10, s[8:11], s63 offen sc1
  s_add_u32 s63, s63, 147456
  buffer_store_dwordx4 v[76:79], v10, s[8:11], s63 offen sc1
  s_add_u32 s63, s63, 147456
  ds_read_b64_tr_b16 v[80:81], v6 offset:16384
  ds_read_b64_tr_b16 v[82:83], v6 offset:18432
  ds_read_b64_tr_b16 v[84:85], v7 offset:16384
  ds_read_b64_tr_b16 v[86:87], v7 offset:18432
  ds_read_b64_tr_b16 v[88:89], v8 offset:16384
  ds_read_b64_tr_b16 v[90:91], v8 offset:18432
  ds_read_b64_tr_b16 v[92:93], v9 offset:16384
  ds_read_b64_tr_b16 v[94:95], v9 offset:18432
  s_waitcnt lgkmcnt(0)
  buffer_store_dwordx4 v[80:83], v10, s[8:11], s64 offen sc1
  s_add_u32 s64, s64, 147456
  buffer_store_dwordx4 v[84:87], v10, s[8:11], s64 offen sc1
  s_add_u32 s64, s64, 147456
  buffer_store_dwordx4 v[88:91], v10, s[8:11], s64 offen sc1
  s_add_u32 s64, s64, 147456
  buffer_store_dwordx4 v[92:95], v10, s[8:11], s64 offen sc1
  s_add_u32 s64, s64, 147456
  s_mov_b32 s75, 252
  s_waitcnt vmcnt(0)
  s_barrier
  s_cmp_lg_u32 s21, 0
  s_cbranch_scc1 S_15
  v_mov_b32 v251, 1
  s_mov_b64 exec, 1
  buffer_atomic_add v251, off, s[16:19], s75 offset:0 sc1
  s_mov_b64 exec, -1
S_15:
WODONE:
  s_load_dwordx2 s[56:57], s[0:1], 64
  s_mov_b32 s58, 18874368
  s_mov_b32 s59, 0x00020000
  s_mul_i32 s70, s69, 192
  s_add_u32 s70, s70, 96468992
  s_lshl_b32 s71, s68, 8
  s_and_b32 s72, s21, 1
  s_lshl_b32 s72, s72, 2
  s_lshr_b32 s73, s21, 1
  s_mul_i32 s73, s73, 3
  s_lshl_b32 s44, s72, 5
  s_add_u32 s44, s44, s71
  v_lshrrev_b32 v2, 4, v0
  v_lshl_add_u32 v250, v2, 3, s44
  v_add_u32 v247, 0, v0
  v_mul_u32_u24 v246, 5462, v247
  v_lshrrev_b32 v246, 16, v246
  v_mul_u32_u24 v176, 12, v246
  v_sub_u32 v247, v247, v176
  v_bfe_u32 v176, v246, 2, 1
  v_lshlrev_b32 v176, 1, v176
  v_xor_b32 v247, v247, v176
  s_lshl_b32 s44, s21, 4
  v_add_u32 v246, s44, v246
  v_mul_u32_u24 v246, 1152, v246
  v_lshl_add_u32 v176, v247, 4, v246
  v_add_u32 v247, 64, v0
  v_mul_u32_u24 v246, 5462, v247
  v_lshrrev_b32 v246, 16, v246
  v_mul_u32_u24 v177, 12, v246
  v_sub_u32 v247, v247, v177
  v_bfe_u32 v177, v246, 2, 1
  v_lshlrev_b32 v177, 1, v177
  v_xor_b32 v247, v247, v177
  s_lshl_b32 s44, s21, 4
  v_add_u32 v246, s44, v246
  v_mul_u32_u24 v246, 1152, v246
  v_lshl_add_u32 v177, v247, 4, v246
  v_add_u32 v247, 128, v0
  v_mul_u32_u24 v246, 5462, v247
  v_lshrrev_b32 v246, 16, v246
  v_mul_u32_u24 v178, 12, v246
  v_sub_u32 v247, v247, v178
  v_bfe_u32 v178, v246, 2, 1
  v_lshlrev_b32 v178, 1, v178
  v_xor_b32 v247, v247, v178
  s_lshl_b32 s44, s21, 4
  v_add_u32 v246, s44, v246
  v_mul_u32_u24 v246, 1152, v246
  v_lshl_add_u32 v178, v247, 4, v246
  v_add_u32 v247, 0, v0
  v_mul_u32_u24 v246, 4096, v247
  v_lshrrev_b32 v246, 16, v246
  v_mul_u32_u24 v179, 16, v246
  v_sub_u32 v247, v247, v179
  v_bfe_u32 v179, v246, 0, 3
  v_lshlrev_b32 v179, 1, v179
  v_xor_b32 v247, v247, v179
  s_lshl_b32 s44, s21, 4
  v_add_u32 v246, s44, v246
  v_mul_u32_u24 v246, 9216, v246
  v_lshl_add_u32 v179, v247, 4, v246
  v_add_u32 v247, 64, v0
  v_mul_u32_u24 v246, 4096, v247
  v_lshrrev_b32 v246, 16, v246
  v_mul_u32_u24 v180, 16, v246
  v_sub_u32 v247, v247, v180
  v_bfe_u32 v180, v246, 0, 3
  v_lshlrev_b32 v180, 1, v180
  v_xor_b32 v247, v247, v180
  s_lshl_b32 s44, s21, 4
  v_add_u32 v246, s44, v246
  v_mul_u32_u24 v246, 9216, v246
  v_lshl_add_u32 v180, v247, 4, v246
  v_add_u32 v247, 128, v0
  v_mul_u32_u24 v246, 4096, v247
  v_lshrrev_b32 v246, 16, v246
  v_mul_u32_u24 v181, 16, v246
  v_sub_u32 v247, v247, v181
  v_bfe_u32 v181, v246, 0, 3
  v_lshlrev_b32 v181, 1, v181
  v_xor_b32 v247, v247, v181
  s_lshl_b32 s44, s21, 4
  v_add_u32 v246, s44, v246
  v_mul_u32_u24 v246, 9216, v246
  v_lshl_add_u32 v181, v247, 4, v246
  v_add_u32 v247, 192, v0
  v_mul_u32_u24 v246, 4096, v247
  v_lshrrev_b32 v246, 16, v246
  v_mul_u32_u24 v182, 16, v246
  v_sub_u32 v247, v247, v182
  v_bfe_u32 v182, v246, 0, 3
  v_lshlrev_b32 v182, 1, v182
  v_xor_b32 v247, v247, v182
  s_lshl_b32 s44, s21, 4
  v_add_u32 v246, s44, v246
  v_mul_u32_u24 v246, 9216, v246
  v_lshl_add_u32 v182, v247, 4, v246
  v_bfe_u32 v246, v0, 2, 4
  v_mul_u32_u24 v246, 192, v246
  v_bfe_u32 v247, v0, 0, 2
  v_mul_u32_u24 v247, 8, v247
  v_add_u32 v246, v246, v247
  v_add_u32 v246, 106496, v246
  s_add_u32 s44, s73, 0
  v_bfe_u32 v247, v0, 4, 1
  v_xor_b32 v247, s44, v247
  v_lshl_add_u32 v183, v247, 5, v246
  s_add_u32 s44, s73, 1
  v_bfe_u32 v247, v0, 4, 1
  v_xor_b32 v247, s44, v247
  v_lshl_add_u32 v184, v247, 5, v246
  s_add_u32 s44, s73, 2
  v_bfe_u32 v247, v0, 4, 1
  v_xor_b32 v247, s44, v247
  v_lshl_add_u32 v185, v247, 5, v246
  v_bfe_u32 v246, v0, 2, 4
  v_mul_u32_u24 v246, 256, v246
  v_bfe_u32 v247, v0, 0, 2
  v_mul_u32_u24 v247, 8, v247
  v_add_u32 v246, v246, v247
  v_add_u32 v246, 118784, v246
  s_add_u32 s44, s72, 0
  v_bfe_u32 v247, v0, 2, 3
  v_xor_b32 v247, s44, v247
  v_lshl_add_u32 v186, v247, 5, v246
  s_add_u32 s44, s72, 1
  v_bfe_u32 v247, v0, 2, 3
  v_xor_b32 v247, s44, v247
  v_lshl_add_u32 v187, v247, 5, v246
  s_add_u32 s44, s72, 2
  v_bfe_u32 v247, v0, 2, 3
  v_xor_b32 v247, s44, v247
  v_lshl_add_u32 v188, v247, 5, v246
  s_add_u32 s44, s72, 3
  v_bfe_u32 v247, v0, 2, 3
  v_xor_b32 v247, s44, v247
  v_lshl_add_u32 v189, v247, 5, v246
  s_waitcnt lgkmcnt(0)
  s_load_dwordx2 s[24:25], s[0:1], 72
  s_mov_b32 s26, 9216
  s_mov_b32 s27, 0x00020000
  v_lshlrev_b32 v1, 4, v0
  s_waitcnt lgkmcnt(0)
  buffer_load_dwordx2 v[8:9], v250, s[24:27], 0 offen offset:0
  buffer_load_dwordx2 v[10:11], v250, s[24:27], 0 offen offset:32
  buffer_load_dwordx2 v[12:13], v250, s[24:27], 0 offen offset:64
  buffer_load_dwordx2 v[14:15], v250, s[24:27], 0 offen offset:96
  s_waitcnt vmcnt(0)
  v_lshlrev_b32 v16, 16, v8
  v_and_b32 v17, 0xffff0000, v8
  v_lshlrev_b32 v18, 16, v9
  v_and_b32 v19, 0xffff0000, v9
  v_lshlrev_b32 v20, 16, v10
  v_and_b32 v21, 0xffff0000, v10
  v_lshlrev_b32 v22, 16, v11
  v_and_b32 v23, 0xffff0000, v11
  v_lshlrev_b32 v24, 16, v12
  v_and_b32 v25, 0xffff0000, v12
  v_lshlrev_b32 v26, 16, v13
  v_and_b32 v27, 0xffff0000, v13
  v_lshlrev_b32 v28, 16, v14
  v_and_b32 v29, 0xffff0000, v14
  v_lshlrev_b32 v30, 16, v15
  v_and_b32 v31, 0xffff0000, v15
  v_accvgpr_write_b32 a192, v16
  v_accvgpr_write_b32 a193, v17
  v_accvgpr_write_b32 a194, v18
  v_accvgpr_write_b32 a195, v19
  v_accvgpr_write_b32 a196, v16
  v_accvgpr_write_b32 a197, v17
  v_accvgpr_write_b32 a198, v18
  v_accvgpr_write_b32 a199, v19
  v_accvgpr_write_b32 a200, v16
  v_accvgpr_write_b32 a201, v17
  v_accvgpr_write_b32 a202, v18
  v_accvgpr_write_b32 a203, v19
  v_accvgpr_write_b32 a204, v20
  v_accvgpr_write_b32 a205, v21
  v_accvgpr_write_b32 a206, v22
  v_accvgpr_write_b32 a207, v23
  v_accvgpr_write_b32 a208, v20
  v_accvgpr_write_b32 a209, v21
  v_accvgpr_write_b32 a210, v22
  v_accvgpr_write_b32 a211, v23
  v_accvgpr_write_b32 a212, v20
  v_accvgpr_write_b32 a213, v21
  v_accvgpr_write_b32 a214, v22
  v_accvgpr_write_b32 a215, v23
  v_accvgpr_write_b32 a216, v24
  v_accvgpr_write_b32 a217, v25
  v_accvgpr_write_b32 a218, v26
  v_accvgpr_write_b32 a219, v27
  v_accvgpr_write_b32 a220, v24
  v_accvgpr_write_b32 a221, v25
  v_accvgpr_write_b32 a222, v26
  v_accvgpr_write_b32 a223, v27
  v_accvgpr_write_b32 a224, v24
  v_accvgpr_write_b32 a225, v25
  v_accvgpr_write_b32 a226, v26
  v_accvgpr_write_b32 a227, v27
  v_accvgpr_write_b32 a228, v28
  v_accvgpr_write_b32 a229, v29
  v_accvgpr_write_b32 a230, v30
  v_accvgpr_write_b32 a231, v31
  v_accvgpr_write_b32 a232, v28
  v_accvgpr_write_b32 a233, v29
  v_accvgpr_write_b32 a234, v30
  v_accvgpr_write_b32 a235, v31
  v_accvgpr_write_b32 a236, v28
  v_accvgpr_write_b32 a237, v29
  v_accvgpr_write_b32 a238, v30
  v_accvgpr_write_b32 a239, v31
  s_mov_b32 s6, 0
  s_cmp_lg_u32 s21, 0
  s_cbranch_scc1 W_16_ok
  s_mov_b32 s79, 0
W_16:
  buffer_load_dword v251, off, s[16:19], s6 offset:0 sc1
  s_add_u32 s79, s79, 1
  s_cmp_gt_u32 s79, 0x40000
  s_cbranch_scc1 BG_END
  s_waitcnt vmcnt(0)
  v_readfirstlane_b32 s78, v251
  s_bfe_u32 s78, s78, 0x80000
  s_cmp_eq_u32 s78, 32
  s_cbranch_scc1 W_16_ok
  s_sleep 8
  s_branch W_16
W_16_ok:
  s_barrier
  s_mov_b32 s94, 0
  s_cmp_ge_u32 s77, 192
  s_cbranch_scc1 ILOOP
  v_lshlrev_b32 v2, 2, v0
  s_mov_b32 s79, 0
AW:
  buffer_load_dword v3, v2, s[16:19], 0 offen offset:8 sc1
  s_add_u32 s79, s79, 1
  s_cmp_gt_u32 s79, 0x40000
  s_cbranch_scc1 BG_END
  s_waitcnt vmcnt(0)
  v_and_b32 v3, 0x200, v3
  v_cmp_ne_u32 vcc, 0, v3
  s_sleep 32
  s_and_b32 s5, vcc_lo, 0xffff
  s_cmp_lg_u32 s5, 0xffff
  s_cbranch_scc1 AW
ILOOP:
  s_cmp_eq_u32 s6, 16
  s_cbranch_scc1 DOE
  s_and_b32 s5, s6, 1
  s_cmp_lg_u32 s5, s98
  s_cbranch_scc1 DOW
  s_lshl_b32 s5, s6, 2
  s_add_u32 s75, s5, 8
  s_bfe_u32 s22, s77, 0x20003
  s_add_u32 s22, s22, s5
  s_lshl_b32 s23, s74, 2
  s_add_u32 s23, s23, s21
  v_lshlrev_b32 v1, 4, v0
  s_lshl_b32 s44, s22, 17
  s_lshl_b32 s45, s23, 12
  s_add_u32 s44, s44, s45
  s_lshl_b32 s45, s44, 1
  s_add_u32 s46, s45, 4194304
  buffer_load_dwordx4 v[8:11], v1, s[8:11], s46 offen offset:0 sc1
  buffer_load_dwordx4 v[12:15], v1, s[8:11], s46 offen offset:1024 sc1
  buffer_load_dwordx4 v[16:19], v1, s[8:11], s46 offen offset:2048 sc1
  buffer_load_dwordx4 v[20:23], v1, s[8:11], s46 offen offset:3072 sc1
  s_add_u32 s46, s45, 4198400
  buffer_load_dwordx4 v[24:27], v1, s[8:11], s46 offen offset:0 sc1
  buffer_load_dwordx4 v[28:31], v1, s[8:11], s46 offen offset:1024 sc1
  buffer_load_dwordx4 v[32:35], v1, s[8:11], s46 offen offset:2048 sc1
  buffer_load_dwordx4 v[36:39], v1, s[8:11], s46 offen offset:3072 sc1
  s_add_u32 s46, s45, 20971520
  buffer_load_dwordx4 v[40:43], v1, s[8:11], s46 offen offset:0 sc1
  buffer_load_dwordx4 v[44:47], v1, s[8:11], s46 offen offset:1024 sc1
  buffer_load_dwordx4 v[48:51], v1, s[8:11], s46 offen offset:2048 sc1
  buffer_load_dwordx4 v[52:55], v1, s[8:11], s46 offen offset:3072 sc1
  s_add_u32 s46, s45, 20975616
  buffer_load_dwordx4 v[56:59], v1, s[8:11], s46 offen offset:0 sc1
  buffer_load_dwordx4 v[60:63], v1, s[8:11], s46 offen offset:1024 sc1
  buffer_load_dwordx4 v[64:67], v1, s[8:11], s46 offen offset:2048 sc1
  buffer_load_dwordx4 v[68:71], v1, s[8:11], s46 offen offset:3072 sc1
  s_add_u32 s46, s45, 37748736
  buffer_load_dwordx4 v[88:91], v1, s[8:11], s46 offen offset:0 sc1
  buffer_load_dwordx4 v[92:95], v1, s[8:11], s46 offen offset:1024 sc1
  buffer_load_dwordx4 v[96:99], v1, s[8:11], s46 offen offset:2048 sc1
  buffer_load_dwordx4 v[100:103], v1, s[8:11], s46 offen offset:3072 sc1
  s_add_u32 s46, s45, 37752832
  buffer_load_dwordx4 v[104:107], v1, s[8:11], s46 offen offset:0 sc1
  buffer_load_dwordx4 v[108:111], v1, s[8:11], s46 offen offset:1024 sc1
  buffer_load_dwordx4 v[112:115], v1, s[8:11], s46 offen offset:2048 sc1
  buffer_load_dwordx4 v[116:119], v1, s[8:11], s46 offen offset:3072 sc1
  v_and_b32 v2, 15, v0
  v_lshrrev_b32 v3, 4, v0
  v_lshlrev_b32 v3, 2, v3
  v_sub_u32 v2, v2, v3
  v_cmp_le_i32_e64 s[60:61], 0, v2
  v_cmp_le_i32_e64 s[62:63], 1, v2
  v_cmp_le_i32_e64 s[64:65], 2, v2
  v_cmp_le_i32_e64 s[66:67], 3, v2
  v_mov_b32 v3, 0xf149f2ca
  s_mov_b32 s47, 0x3e0293ee
  s_waitcnt vmcnt(8)
  v_mfma_f32_16x16x32_bf16 v[144:147], v[40:43], v[8:11], 0
  v_mfma_f32_16x16x32_bf16 v[148:151], v[40:43], v[12:15], 0
  v_mfma_f32_16x16x32_bf16 v[152:155], v[44:47], v[12:15], 0
  v_mfma_f32_16x16x32_bf16 v[144:147], v[48:51], v[16:19], v[144:147]
  v_mfma_f32_16x16x32_bf16 v[148:151], v[48:51], v[20:23], v[148:151]
  v_mfma_f32_16x16x32_bf16 v[152:155], v[52:55], v[20:23], v[152:155]
  v_mfma_f32_16x16x32_bf16 v[144:147], v[56:59], v[24:27], v[144:147]
  v_mfma_f32_16x16x32_bf16 v[148:151], v[56:59], v[28:31], v[148:151]
  v_mfma_f32_16x16x32_bf16 v[152:155], v[60:63], v[28:31], v[152:155]
  v_mfma_f32_16x16x32_bf16 v[144:147], v[64:67], v[32:35], v[144:147]
  v_mfma_f32_16x16x32_bf16 v[148:151], v[64:67], v[36:39], v[148:151]
  v_mfma_f32_16x16x32_bf16 v[152:155], v[68:71], v[36:39], v[152:155]
  s_lshl_b32 s5, s23, 7
  s_add_u32 s5, s5, 71958528
  v_mov_b32 v4, 0
  s_mov_b32 s79, 0
WC:
  buffer_load_ubyte v5, v4, s[8:11], s5 offen sc1
  s_add_u32 s79, s79, 1
  s_cmp_gt_u32 s79, 0x40000
  s_cbranch_scc1 BG_END
  s_waitcnt vmcnt(0)
  v_cmp_ge_u32 vcc, s22, v5
  s_nop 1
  s_cbranch_vccz WC_ok
  v_readfirstlane_b32 s78, v5
  s_add_u32 s78, s78, 1
  s_cmp_ge_u32 s78, s22
  s_cbranch_scc1 WC_s
  s_sleep 40
WC_s:
  s_sleep 8
  s_branch WC
WC_ok:
  s_add_u32 s46, s44, 54525952
  buffer_load_dwordx4 v[72:75], v1, s[8:11], s46 offen offset:0 sc1
  buffer_load_dwordx4 v[76:79], v1, s[8:11], s46 offen offset:1024 sc1
  buffer_load_dwordx4 v[80:83], v1, s[8:11], s46 offen offset:2048 sc1
  buffer_load_dwordx4 v[84:87], v1, s[8:11], s46 offen offset:3072 sc1
  s_add_u32 s46, s44, 62914560
  buffer_load_dwordx4 v[120:123], v1, s[8:11], s46 offen offset:0 sc1
  buffer_load_dwordx4 v[124:127], v1, s[8:11], s46 offen offset:1024 sc1
  buffer_load_dwordx4 v[128:131], v1, s[8:11], s46 offen offset:2048 sc1
  buffer_load_dwordx4 v[132:135], v1, s[8:11], s46 offen offset:3072 sc1
  s_waitcnt vmcnt(4)
  v_mfma_f32_16x16x32_bf16 v[136:139], v[72:75], v[8:11], 0
  v_mfma_f32_16x16x32_bf16 v[140:143], v[72:75], v[12:15], 0
  v_mfma_f32_16x16x32_bf16 v[136:139], v[76:79], v[16:19], v[136:139]
  v_mfma_f32_16x16x32_bf16 v[140:143], v[76:79], v[20:23], v[140:143]
  v_mfma_f32_16x16x32_bf16 v[136:139], v[80:83], v[24:27], v[136:139]
  v_mfma_f32_16x16x32_bf16 v[140:143], v[80:83], v[28:31], v[140:143]
  v_mfma_f32_16x16x32_bf16 v[136:139], v[84:87], v[32:35], v[136:139]
  v_mfma_f32_16x16x32_bf16 v[140:143], v[84:87], v[36:39], v[140:143]
  s_nop 7
  v_cndmask_b32_e64 v144, v3, v144, s[60:61]
  v_cndmask_b32_e64 v152, v3, v152, s[60:61]
  v_cndmask_b32_e64 v145, v3, v145, s[62:63]
  v_cndmask_b32_e64 v153, v3, v153, s[62:63]
  v_cndmask_b32_e64 v146, v3, v146, s[64:65]
  v_cndmask_b32_e64 v154, v3, v154, s[64:65]
  v_cndmask_b32_e64 v147, v3, v147, s[66:67]
  v_cndmask_b32_e64 v155, v3, v155, s[66:67]
  v_max_f32 v4, v136, v137
  v_max3_f32 v4, v138, v139, v4
  v_max3_f32 v4, v144, v145, v4
  v_max3_f32 v4, v146, v147, v4
  v_max_f32 v5, v140, v141
  v_max3_f32 v5, v142, v143, v5
  v_max3_f32 v5, v148, v149, v5
  v_max3_f32 v5, v150, v151, v5
  v_max3_f32 v5, v152, v153, v5
  v_max3_f32 v5, v154, v155, v5
  v_mov_b32 v6, v4
  v_mov_b32 v7, v5
  s_nop 1
  v_permlane16_swap_b32 v4, v6
  v_permlane16_swap_b32 v5, v7
  v_max_f32 v4, v4, v6
  v_max_f32 v5, v5, v7
  v_mov_b32 v6, v4
  v_mov_b32 v7, v5
  s_nop 1
  v_permlane32_swap_b32 v4, v6
  v_permlane32_swap_b32 v5, v7
  v_max_f32 v4, v4, v6
  v_max_f32 v5, v5, v7
  v_mul_f32 v4, s47, v4
  v_mul_f32 v5, s47, v5
  v_fma_f32 v136, v136, s47, -v4
  v_fma_f32 v137, v137, s47, -v4
  v_fma_f32 v138, v138, s47, -v4
  v_fma_f32 v139, v139, s47, -v4
  v_fma_f32 v144, v144, s47, -v4
  v_fma_f32 v145, v145, s47, -v4
  v_fma_f32 v146, v146, s47, -v4
  v_fma_f32 v147, v147, s47, -v4
  v_exp_f32 v136, v136
  v_exp_f32 v137, v137
  v_exp_f32 v138, v138
  v_exp_f32 v139, v139
  v_exp_f32 v144, v144
  v_exp_f32 v145, v145
  v_exp_f32 v146, v146
  v_exp_f32 v147, v147
  v_fma_f32 v140, v140, s47, -v5
  v_fma_f32 v141, v141, s47, -v5
  v_fma_f32 v142, v142, s47, -v5
  v_fma_f32 v143, v143, s47, -v5
  v_fma_f32 v148, v148, s47, -v5
  v_fma_f32 v149, v149, s47, -v5
  v_fma_f32 v150, v150, s47, -v5
  v_fma_f32 v151, v151, s47, -v5
  v_fma_f32 v152, v152, s47, -v5
  v_fma_f32 v153, v153, s47, -v5
  v_fma_f32 v154, v154, s47, -v5
  v_fma_f32 v155, v155, s47, -v5
  v_exp_f32 v140, v140
  v_exp_f32 v141, v141
  v_exp_f32 v142, v142
  v_exp_f32 v143, v143
  v_exp_f32 v148, v148
  v_exp_f32 v149, v149
  v_exp_f32 v150, v150
  v_exp_f32 v151, v151
  v_exp_f32 v152, v152
  v_exp_f32 v153, v153
  v_exp_f32 v154, v154
  v_exp_f32 v155, v155
  v_add_f32 v4, v136, v137
  v_add_f32 v6, v138, v139
  v_add_f32 v4, v4, v6
  v_mul_f32 v4, 0.5, v4
  v_add_f32 v4, v4, v144
  v_add_f32 v4, v4, v145
  v_add_f32 v4, v4, v146
  v_add_f32 v4, v4, v147
  v_add_f32 v5, v140, v141
  v_add_f32 v6, v142, v143
  v_add_f32 v5, v5, v6
  v_mul_f32 v5, 0.5, v5
  v_add_f32 v5, v5, v148
  v_add_f32 v5, v5, v149
  v_add_f32 v5, v5, v150
  v_add_f32 v5, v5, v151
  v_add_f32 v5, v5, v152
  v_add_f32 v5, v5, v153
  v_add_f32 v5, v5, v154
  v_add_f32 v5, v5, v155
  v_mov_b32 v6, v4
  v_mov_b32 v7, v5
  s_nop 1
  v_permlane16_swap_b32 v4, v6
  v_permlane16_swap_b32 v5, v7
  v_add_f32 v4, v4, v6
  v_add_f32 v5, v5, v7
  v_mov_b32 v6, v4
  v_mov_b32 v7, v5
  s_nop 1
  v_permlane32_swap_b32 v4, v6
  v_permlane32_swap_b32 v5, v7
  v_add_f32 v4, v4, v6
  v_add_f32 v5, v5, v7
  v_rcp_f32 v4, v4
  v_rcp_f32 v5, v5
  v_mov_b32 v162, 0
  v_mov_b32 v163, 0
  v_mul_f32 v136, v4, v136
  v_mul_f32 v137, v4, v137
  v_mul_f32 v138, v4, v138
  v_mul_f32 v139, v4, v139
  v_mul_f32 v144, v4, v144
  v_mul_f32 v145, v4, v145
  v_mul_f32 v146, v4, v146
  v_mul_f32 v147, v4, v147
  v_cvt_pk_bf16_f32 v156, v136, v137
  v_cvt_pk_bf16_f32 v157, v138, v139
  v_cvt_pk_bf16_f32 v160, v144, v145
  v_cvt_pk_bf16_f32 v161, v146, v147
  v_mul_f32 v140, v5, v140
  v_mul_f32 v141, v5, v141
  v_mul_f32 v142, v5, v142
  v_mul_f32 v143, v5, v143
  v_mul_f32 v148, v5, v148
  v_mul_f32 v149, v5, v149
  v_mul_f32 v150, v5, v150
  v_mul_f32 v151, v5, v151
  v_mul_f32 v152, v5, v152
  v_mul_f32 v153, v5, v153
  v_mul_f32 v154, v5, v154
  v_mul_f32 v155, v5, v155
  v_cvt_pk_bf16_f32 v158, v140, v141
  v_cvt_pk_bf16_f32 v159, v142, v143
  v_cvt_pk_bf16_f32 v164, v148, v149
  v_cvt_pk_bf16_f32 v165, v150, v151
  v_cvt_pk_bf16_f32 v166, v152, v153
  v_cvt_pk_bf16_f32 v167, v154, v155
  s_waitcnt vmcnt(0)
  s_nop 0
  v_mfma_f32_16x16x16_bf16 v[8:11], v[120:121], v[156:157], 0
  v_mfma_f32_16x16x16_bf16 v[12:15], v[120:121], v[158:159], 0
  v_mfma_f32_16x16x16_bf16 v[16:19], v[124:125], v[156:157], 0
  v_mfma_f32_16x16x16_bf16 v[20:23], v[124:125], v[158:159], 0
  v_mfma_f32_16x16x16_bf16 v[24:27], v[128:129], v[156:157], 0
  v_mfma_f32_16x16x16_bf16 v[28:31], v[128:129], v[158:159], 0
  v_mfma_f32_16x16x16_bf16 v[32:35], v[132:133], v[156:157], 0
  v_mfma_f32_16x16x16_bf16 v[36:39], v[132:133], v[158:159], 0
  v_mfma_f32_16x16x16_bf16 v[40:43], v[122:123], v[156:157], 0
  v_mfma_f32_16x16x16_bf16 v[44:47], v[122:123], v[158:159], 0
  v_mfma_f32_16x16x16_bf16 v[48:51], v[126:127], v[156:157], 0
  v_mfma_f32_16x16x16_bf16 v[52:55], v[126:127], v[158:159], 0
  v_mfma_f32_16x16x16_bf16 v[56:59], v[130:131], v[156:157], 0
  v_mfma_f32_16x16x16_bf16 v[60:63], v[130:131], v[158:159], 0
  v_mfma_f32_16x16x16_bf16 v[64:67], v[134:135], v[156:157], 0
  v_mfma_f32_16x16x16_bf16 v[68:71], v[134:135], v[158:159], 0
  v_mfma_f32_16x16x32_bf16 v[8:11], v[88:91], v[160:163], v[8:11]
  v_mfma_f32_16x16x32_bf16 v[12:15], v[88:91], v[164:167], v[12:15]
  v_mfma_f32_16x16x32_bf16 v[16:19], v[96:99], v[160:163], v[16:19]
  v_mfma_f32_16x16x32_bf16 v[20:23], v[96:99], v[164:167], v[20:23]
  v_mfma_f32_16x16x32_bf16 v[24:27], v[104:107], v[160:163], v[24:27]
  v_mfma_f32_16x16x32_bf16 v[28:31], v[104:107], v[164:167], v[28:31]
  v_mfma_f32_16x16x32_bf16 v[32:35], v[112:115], v[160:163], v[32:35]
  v_mfma_f32_16x16x32_bf16 v[36:39], v[112:115], v[164:167], v[36:39]
  v_mfma_f32_16x16x32_bf16 v[40:43], v[92:95], v[160:163], v[40:43]
  v_mfma_f32_16x16x32_bf16 v[44:47], v[92:95], v[164:167], v[44:47]
  v_mfma_f32_16x16x32_bf16 v[48:51], v[100:103], v[160:163], v[48:51]
  v_mfma_f32_16x16x32_bf16 v[52:55], v[100:103], v[164:167], v[52:55]
  v_mfma_f32_16x16x32_bf16 v[56:59], v[108:111], v[160:163], v[56:59]
  v_mfma_f32_16x16x32_bf16 v[60:63], v[108:111], v[164:167], v[60:63]
  v_mfma_f32_16x16x32_bf16 v[64:67], v[116:119], v[160:163], v[64:67]
  v_mfma_f32_16x16x32_bf16 v[68:71], v[116:119], v[164:167], v[68:71]
  s_lshl_b32 s44, s21, 12
  v_add_u32 v2, s44, v1
  s_mul_i32 s44, s74, 4718592
  s_mul_i32 s45, s22, 73728
  s_add_u32 s44, s44, s45
  s_mul_i32 s45, s93, 768
  s_add_u32 s44, s44, s45
  s_mul_i32 s45, s21, 192
  s_add_u32 s44, s44, s45
  s_add_u32 s44, s44, 134217728
  s_add_u32 s45, s44, 36864
  v_cvt_pk_bf16_f32 v72, v8, v9
  v_cvt_pk_bf16_f32 v73, v10, v11
  v_cvt_pk_bf16_f32 v74, v16, v17
  v_cvt_pk_bf16_f32 v75, v18, v19
  ds_write_b128 v2, v[72:75] offset:0
  v_cvt_pk_bf16_f32 v76, v12, v13
  v_cvt_pk_bf16_f32 v77, v14, v15
  v_cvt_pk_bf16_f32 v78, v20, v21
  v_cvt_pk_bf16_f32 v79, v22, v23
  ds_write_b128 v2, v[76:79] offset:16384
  v_cvt_pk_bf16_f32 v80, v24, v25
  v_cvt_pk_bf16_f32 v81, v26, v27
  v_cvt_pk_bf16_f32 v82, v32, v33
  v_cvt_pk_bf16_f32 v83, v34, v35
  ds_write_b128 v2, v[80:83] offset:1024
  v_cvt_pk_bf16_f32 v84, v28, v29
  v_cvt_pk_bf16_f32 v85, v30, v31
  v_cvt_pk_bf16_f32 v86, v36, v37
  v_cvt_pk_bf16_f32 v87, v38, v39
  ds_write_b128 v2, v[84:87] offset:17408
  v_cvt_pk_bf16_f32 v88, v40, v41
  v_cvt_pk_bf16_f32 v89, v42, v43
  v_cvt_pk_bf16_f32 v90, v48, v49
  v_cvt_pk_bf16_f32 v91, v50, v51
  ds_write_b128 v2, v[88:91] offset:2048
  v_cvt_pk_bf16_f32 v92, v44, v45
  v_cvt_pk_bf16_f32 v93, v46, v47
  v_cvt_pk_bf16_f32 v94, v52, v53
  v_cvt_pk_bf16_f32 v95, v54, v55
  ds_write_b128 v2, v[92:95] offset:18432
  v_cvt_pk_bf16_f32 v96, v56, v57
  v_cvt_pk_bf16_f32 v97, v58, v59
  v_cvt_pk_bf16_f32 v98, v64, v65
  v_cvt_pk_bf16_f32 v99, v66, v67
  ds_write_b128 v2, v[96:99] offset:3072
  v_cvt_pk_bf16_f32 v100, v60, v61
  v_cvt_pk_bf16_f32 v101, v62, v63
  v_cvt_pk_bf16_f32 v102, v68, v69
  v_cvt_pk_bf16_f32 v103, v70, v71
  ds_write_b128 v2, v[100:103] offset:19456
  v_bfe_u32 v2, v0, 0, 4
  v_mul_u32_u24 v2, 2304, v2
  v_bfe_u32 v3, v0, 4, 2
  v_mul_u32_u24 v3, 16, v3
  v_add_u32 v2, v2, v3
  s_waitcnt lgkmcnt(0)
  s_barrier
  ds_read_b128 v[8:11], v1 offset:0
  ds_read_b128 v[12:15], v1 offset:16384
  ds_read_b128 v[16:19], v1 offset:1024
  ds_read_b128 v[20:23], v1 offset:17408
  ds_read_b128 v[24:27], v1 offset:2048
  ds_read_b128 v[28:31], v1 offset:18432
  ds_read_b128 v[32:35], v1 offset:3072
  ds_read_b128 v[36:39], v1 offset:19456
  ds_read_b128 v[40:43], v1 offset:4096
  ds_read_b128 v[44:47], v1 offset:20480
  s_waitcnt lgkmcnt(8)
  v_mfma_f32_16x16x32_bf16 v[136:139], a[0:3], v[8:11], 0
  v_mfma_f32_16x16x32_bf16 v[140:143], a[0:3], v[12:15], 0
  v_mfma_f32_16x16x32_bf16 v[144:147], a[64:67], v[8:11], 0
  v_mfma_f32_16x16x32_bf16 v[148:151], a[64:67], v[12:15], 0
  v_mfma_f32_16x16x32_bf16 v[152:155], a[128:131], v[8:11], 0
  v_mfma_f32_16x16x32_bf16 v[156:159], a[128:131], v[12:15], 0
  ds_read_b128 v[48:51], v1 offset:5120
  ds_read_b128 v[52:55], v1 offset:21504
  s_waitcnt lgkmcnt(8)
  v_mfma_f32_16x16x32_bf16 v[136:139], a[4:7], v[16:19], v[136:139]
  v_mfma_f32_16x16x32_bf16 v[140:143], a[4:7], v[20:23], v[140:143]
  v_mfma_f32_16x16x32_bf16 v[144:147], a[68:71], v[16:19], v[144:147]
  v_mfma_f32_16x16x32_bf16 v[148:151], a[68:71], v[20:23], v[148:151]
  v_mfma_f32_16x16x32_bf16 v[152:155], a[132:135], v[16:19], v[152:155]
  v_mfma_f32_16x16x32_bf16 v[156:159], a[132:135], v[20:23], v[156:159]
  ds_read_b128 v[56:59], v1 offset:6144
  ds_read_b128 v[60:63], v1 offset:22528
  s_waitcnt lgkmcnt(8)
  v_mfma_f32_16x16x32_bf16 v[136:139], a[8:11], v[24:27], v[136:139]
  v_mfma_f32_16x16x32_bf16 v[140:143], a[8:11], v[28:31], v[140:143]
  v_mfma_f32_16x16x32_bf16 v[144:147], a[72:75], v[24:27], v[144:147]
  v_mfma_f32_16x16x32_bf16 v[148:151], a[72:75], v[28:31], v[148:151]
  v_mfma_f32_16x16x32_bf16 v[152:155], a[136:139], v[24:27], v[152:155]
  v_mfma_f32_16x16x32_bf16 v[156:159], a[136:139], v[28:31], v[156:159]
  ds_read_b128 v[64:67], v1 offset:7168
  ds_read_b128 v[68:71], v1 offset:23552
  s_waitcnt lgkmcnt(8)
  v_mfma_f32_16x16x32_bf16 v[136:139], a[12:15], v[32:35], v[136:139]
  v_mfma_f32_16x16x32_bf16 v[140:143], a[12:15], v[36:39], v[140:143]
  v_mfma_f32_16x16x32_bf16 v[144:147], a[76:79], v[32:35], v[144:147]
  v_mfma_f32_16x16x32_bf16 v[148:151], a[76:79], v[36:39], v[148:151]
  v_mfma_f32_16x16x32_bf16 v[152:155], a[140:143], v[32:35], v[152:155]
  v_mfma_f32_16x16x32_bf16 v[156:159], a[140:143], v[36:39], v[156:159]
  ds_read_b128 v[72:75], v1 offset:8192
  ds_read_b128 v[76:79], v1 offset:24576
  s_waitcnt lgkmcnt(8)
  v_mfma_f32_16x16x32_bf16 v[136:139], a[16:19], v[40:43], v[136:139]
  v_mfma_f32_16x16x32_bf16 v[140:143], a[16:19], v[44:47], v[140:143]
  v_mfma_f32_16x16x32_bf16 v[144:147], a[80:83], v[40:43], v[144:147]
  v_mfma_f32_16x16x32_bf16 v[148:151], a[80:83], v[44:47], v[148:151]
  v_mfma_f32_16x16x32_bf16 v[152:155], a[144:147], v[40:43], v[152:155]
  v_mfma_f32_16x16x32_bf16 v[156:159], a[144:147], v[44:47], v[156:159]
  ds_read_b128 v[80:83], v1 offset:9216
  ds_read_b128 v[84:87], v1 offset:25600
  s_waitcnt lgkmcnt(8)
  v_mfma_f32_16x16x32_bf16 v[136:139], a[20:23], v[48:51], v[136:139]
  v_mfma_f32_16x16x32_bf16 v[140:143], a[20:23], v[52:55], v[140:143]
  v_mfma_f32_16x16x32_bf16 v[144:147], a[84:87], v[48:51], v[144:147]
  v_mfma_f32_16x16x32_bf16 v[148:151], a[84:87], v[52:55], v[148:151]
  v_mfma_f32_16x16x32_bf16 v[152:155], a[148:151], v[48:51], v[152:155]
  v_mfma_f32_16x16x32_bf16 v[156:159], a[148:151], v[52:55], v[156:159]
  ds_read_b128 v[88:91], v1 offset:10240
  ds_read_b128 v[92:95], v1 offset:26624
  s_waitcnt lgkmcnt(8)
  v_mfma_f32_16x16x32_bf16 v[136:139], a[24:27], v[56:59], v[136:139]
  v_mfma_f32_16x16x32_bf16 v[140:143], a[24:27], v[60:63], v[140:143]
  v_mfma_f32_16x16x32_bf16 v[144:147], a[88:91], v[56:59], v[144:147]
  v_mfma_f32_16x16x32_bf16 v[148:151], a[88:91], v[60:63], v[148:151]
  v_mfma_f32_16x16x32_bf16 v[152:155], a[152:155], v[56:59], v[152:155]
  v_mfma_f32_16x16x32_bf16 v[156:159], a[152:155], v[60:63], v[156:159]
  ds_read_b128 v[96:99], v1 offset:11264
  ds_read_b128 v[100:103], v1 offset:27648
  s_waitcnt lgkmcnt(8)
  v_mfma_f32_16x16x32_bf16 v[136:139], a[28:31], v[64:67], v[136:139]
  v_mfma_f32_16x16x32_bf16 v[140:143], a[28:31], v[68:71], v[140:143]
  v_mfma_f32_16x16x32_bf16 v[144:147], a[92:95], v[64:67], v[144:147]
  v_mfma_f32_16x16x32_bf16 v[148:151], a[92:95], v[68:71], v[148:151]
  v_mfma_f32_16x16x32_bf16 v[152:155], a[156:159], v[64:67], v[152:155]
  v_mfma_f32_16x16x32_bf16 v[156:159], a[156:159], v[68:71], v[156:159]
  ds_read_b128 v[104:107], v1 offset:12288
  ds_read_b128 v[108:111], v1 offset:28672
  s_waitcnt lgkmcnt(8)
  v_mfma_f32_16x16x32_bf16 v[136:139], a[32:35], v[72:75], v[136:139]
  v_mfma_f32_16x16x32_bf16 v[140:143], a[32:35], v[76:79], v[140:143]
  v_mfma_f32_16x16x32_bf16 v[144:147], a[96:99], v[72:75], v[144:147]
  v_mfma_f32_16x16x32_bf16 v[148:151], a[96:99], v[76:79], v[148:151]
  v_mfma_f32_16x16x32_bf16 v[152:155], a[160:163], v[72:75], v[152:155]
  v_mfma_f32_16x16x32_bf16 v[156:159], a[160:163], v[76:79], v[156:159]
  ds_read_b128 v[112:115], v1 offset:13312
  ds_read_b128 v[116:119], v1 offset:29696
  s_waitcnt lgkmcnt(8)
  v_mfma_f32_16x16x32_bf16 v[136:139], a[36:39], v[80:83], v[136:139]
  v_mfma_f32_16x16x32_bf16 v[140:143], a[36:39], v[84:87], v[140:143]
  v_mfma_f32_16x16x32_bf16 v[144:147], a[100:103], v[80:83], v[144:147]
  v_mfma_f32_16x16x32_bf16 v[148:151], a[100:103], v[84:87], v[148:151]
  v_mfma_f32_16x16x32_bf16 v[152:155], a[164:167], v[80:83], v[152:155]
  v_mfma_f32_16x16x32_bf16 v[156:159], a[164:167], v[84:87], v[156:159]
  ds_read_b128 v[120:123], v1 offset:14336
  ds_read_b128 v[124:127], v1 offset:30720
  s_waitcnt lgkmcnt(8)
  v_mfma_f32_16x16x32_bf16 v[136:139], a[40:43], v[88:91], v[136:139]
  v_mfma_f32_16x16x32_bf16 v[140:143], a[40:43], v[92:95], v[140:143]
  v_mfma_f32_16x16x32_bf16 v[144:147], a[104:107], v[88:91], v[144:147]
  v_mfma_f32_16x16x32_bf16 v[148:151], a[104:107], v[92:95], v[148:151]
  v_mfma_f32_16x16x32_bf16 v[152:155], a[168:171], v[88:91], v[152:155]
  v_mfma_f32_16x16x32_bf16 v[156:159], a[168:171], v[92:95], v[156:159]
  ds_read_b128 v[128:131], v1 offset:15360
  ds_read_b128 v[132:135], v1 offset:31744
  s_waitcnt lgkmcnt(8)
  v_mfma_f32_16x16x32_bf16 v[136:139], a[44:47], v[96:99], v[136:139]
  v_mfma_f32_16x16x32_bf16 v[140:143], a[44:47], v[100:103], v[140:143]
  v_mfma_f32_16x16x32_bf16 v[144:147], a[108:111], v[96:99], v[144:147]
  v_mfma_f32_16x16x32_bf16 v[148:151], a[108:111], v[100:103], v[148:151]
  v_mfma_f32_16x16x32_bf16 v[152:155], a[172:175], v[96:99], v[152:155]
  v_mfma_f32_16x16x32_bf16 v[156:159], a[172:175], v[100:103], v[156:159]
  s_waitcnt lgkmcnt(6)
  v_mfma_f32_16x16x32_bf16 v[136:139], a[48:51], v[104:107], v[136:139]
  v_mfma_f32_16x16x32_bf16 v[140:143], a[48:51], v[108:111], v[140:143]
  v_mfma_f32_16x16x32_bf16 v[144:147], a[112:115], v[104:107], v[144:147]
  v_mfma_f32_16x16x32_bf16 v[148:151], a[112:115], v[108:111], v[148:151]
  v_mfma_f32_16x16x32_bf16 v[152:155], a[176:179], v[104:107], v[152:155]
  v_mfma_f32_16x16x32_bf16 v[156:159], a[176:179], v[108:111], v[156:159]
  s_waitcnt lgkmcnt(4)
  v_mfma_f32_16x16x32_bf16 v[136:139], a[52:55], v[112:115], v[136:139]
  v_mfma_f32_16x16x32_bf16 v[140:143], a[52:55], v[116:119], v[140:143]
  v_mfma_f32_16x16x32_bf16 v[144:147], a[116:119], v[112:115], v[144:147]
  v_mfma_f32_16x16x32_bf16 v[148:151], a[116:119], v[116:119], v[148:151]
  v_mfma_f32_16x16x32_bf16 v[152:155], a[180:183], v[112:115], v[152:155]
  v_mfma_f32_16x16x32_bf16 v[156:159], a[180:183], v[116:119], v[156:159]
  s_waitcnt lgkmcnt(2)
  v_mfma_f32_16x16x32_bf16 v[136:139], a[56:59], v[120:123], v[136:139]
  v_mfma_f32_16x16x32_bf16 v[140:143], a[56:59], v[124:127], v[140:143]
  v_mfma_f32_16x16x32_bf16 v[144:147], a[120:123], v[120:123], v[144:147]
  v_mfma_f32_16x16x32_bf16 v[148:151], a[120:123], v[124:127], v[148:151]
  v_mfma_f32_16x16x32_bf16 v[152:155], a[184:187], v[120:123], v[152:155]
  v_mfma_f32_16x16x32_bf16 v[156:159], a[184:187], v[124:127], v[156:159]
  s_waitcnt lgkmcnt(0)
  v_mfma_f32_16x16x32_bf16 v[136:139], a[60:63], v[128:131], v[136:139]
  v_mfma_f32_16x16x32_bf16 v[140:143], a[60:63], v[132:135], v[140:143]
  v_mfma_f32_16x16x32_bf16 v[144:147], a[124:127], v[128:131], v[144:147]
  v_mfma_f32_16x16x32_bf16 v[148:151], a[124:127], v[132:135], v[148:151]
  v_mfma_f32_16x16x32_bf16 v[152:155], a[188:191], v[128:131], v[152:155]
  v_mfma_f32_16x16x32_bf16 v[156:159], a[188:191], v[132:135], v[156:159]
  s_nop 7
  buffer_store_dwordx4 v[136:139], v2, s[8:11], s44 offen offset:0 sc1
  buffer_store_dwordx4 v[140:143], v2, s[8:11], s45 offen offset:0 sc1
  buffer_store_dwordx4 v[144:147], v2, s[8:11], s44 offen offset:64 sc1
  buffer_store_dwordx4 v[148:151], v2, s[8:11], s45 offen offset:64 sc1
  buffer_store_dwordx4 v[152:155], v2, s[8:11], s44 offen offset:128 sc1
  buffer_store_dwordx4 v[156:159], v2, s[8:11], s45 offen offset:128 sc1
  s_lshl_b32 s75, s22, 7
  s_add_u32 s75, s75, 71962624
  s_waitcnt vmcnt(0)
  s_barrier
  s_cmp_lg_u32 s21, 0
  s_cbranch_scc1 S_17
  v_mov_b32 v251, 1
  s_mov_b64 exec, 1
  buffer_atomic_add v251, off, s[8:11], s75 offset:0 sc1
  s_mov_b64 exec, -1
S_17:
DOW:
  s_cmp_lg_u32 s6, s95
  s_cbranch_scc1 DOE
  s_mov_b32 s5, 252
  s_cmp_lg_u32 s21, 0
  s_cbranch_scc1 W_19_ok
  s_mov_b32 s79, 0
W_19:
  buffer_load_dword v251, off, s[16:19], s5 offset:0 sc1
  s_add_u32 s79, s79, 1
  s_cmp_gt_u32 s79, 0x40000
  s_cbranch_scc1 BG_END
  s_waitcnt vmcnt(0)
  v_readfirstlane_b32 s78, v251
  s_bfe_u32 s78, s78, 0x80000
  s_cmp_eq_u32 s78, 120
  s_cbranch_scc1 W_19_ok
  s_sleep 8
  s_branch W_19
W_19_ok:
  s_barrier
  v_mbcnt_lo_u32_b32 v0, -1, 0
  v_mbcnt_hi_u32_b32 v0, -1, v0
  s_lshr_b32 s82, s2, 5
  s_lshl_b32 s82, s82, 1
  s_and_b32 s44, s2, 1
  s_add_u32 s82, s82, s44
  s_bfe_u32 s83, s2, 0x20003
  s_bfe_u32 s84, s2, 0x20001
  s_lshl_b32 s44, s82, 2
  s_add_u32 s44, s44, s21
  s_mul_i32 s44, s44, 294912
  s_mul_i32 s45, s84, 36864
  s_add_u32 s44, s44, s45
  s_add_u32 s44, s44, 184549376
  v_lshlrev_b32 v252, 4, v0
  v_add_u32 v253, 147456, v252
  buffer_load_dwordx4 a[0:3], v252, s[8:11], s44 offen offset:0 sc1
  buffer_load_dwordx4 a[4:7], v253, s[8:11], s44 offen offset:0 sc1
  buffer_load_dwordx4 a[8:11], v252, s[8:11], s44 offen offset:1024 sc1
  buffer_load_dwordx4 a[12:15], v253, s[8:11], s44 offen offset:1024 sc1
  buffer_load_dwordx4 a[16:19], v252, s[8:11], s44 offen offset:2048 sc1
  buffer_load_dwordx4 a[20:23], v253, s[8:11], s44 offen offset:2048 sc1
  buffer_load_dwordx4 a[24:27], v252, s[8:11], s44 offen offset:3072 sc1
  buffer_load_dwordx4 a[28:31], v253, s[8:11], s44 offen offset:3072 sc1
  s_add_u32 s44, s44, 4096
  buffer_load_dwordx4 a[32:35], v252, s[8:11], s44 offen offset:0 sc1
  buffer_load_dwordx4 a[36:39], v253, s[8:11], s44 offen offset:0 sc1
  buffer_load_dwordx4 a[40:43], v252, s[8:11], s44 offen offset:1024 sc1
  buffer_load_dwordx4 a[44:47], v253, s[8:11], s44 offen offset:1024 sc1
  buffer_load_dwordx4 a[48:51], v252, s[8:11], s44 offen offset:2048 sc1
  buffer_load_dwordx4 a[52:55], v253, s[8:11], s44 offen offset:2048 sc1
  buffer_load_dwordx4 a[56:59], v252, s[8:11], s44 offen offset:3072 sc1
  buffer_load_dwordx4 a[60:63], v253, s[8:11], s44 offen offset:3072 sc1
  s_add_u32 s44, s44, 4096
  buffer_load_dwordx4 a[64:67], v252, s[8:11], s44 offen offset:0 sc1
  buffer_load_dwordx4 a[68:71], v253, s[8:11], s44 offen offset:0 sc1
  buffer_load_dwordx4 a[72:75], v252, s[8:11], s44 offen offset:1024 sc1
  buffer_load_dwordx4 a[76:79], v253, s[8:11], s44 offen offset:1024 sc1
  buffer_load_dwordx4 a[80:83], v252, s[8:11], s44 offen offset:2048 sc1
  buffer_load_dwordx4 a[84:87], v253, s[8:11], s44 offen offset:2048 sc1
  buffer_load_dwordx4 a[88:91], v252, s[8:11], s44 offen offset:3072 sc1
  buffer_load_dwordx4 a[92:95], v253, s[8:11], s44 offen offset:3072 sc1
  s_add_u32 s44, s44, 4096
  buffer_load_dwordx4 a[96:99], v252, s[8:11], s44 offen offset:0 sc1
  buffer_load_dwordx4 a[100:103], v253, s[8:11], s44 offen offset:0 sc1
  buffer_load_dwordx4 a[104:107], v252, s[8:11], s44 offen offset:1024 sc1
  buffer_load_dwordx4 a[108:111], v253, s[8:11], s44 offen offset:1024 sc1
  buffer_load_dwordx4 a[112:115], v252, s[8:11], s44 offen offset:2048 sc1
  buffer_load_dwordx4 a[116:119], v253, s[8:11], s44 offen offset:2048 sc1
  buffer_load_dwordx4 a[120:123], v252, s[8:11], s44 offen offset:3072 sc1
  buffer_load_dwordx4 a[124:127], v253, s[8:11], s44 offen offset:3072 sc1
  s_add_u32 s44, s44, 4096
  buffer_load_dwordx4 a[128:131], v252, s[8:11], s44 offen offset:0 sc1
  buffer_load_dwordx4 a[132:135], v253, s[8:11], s44 offen offset:0 sc1
  buffer_load_dwordx4 a[136:139], v252, s[8:11], s44 offen offset:1024 sc1
  buffer_load_dwordx4 a[140:143], v253, s[8:11], s44 offen offset:1024 sc1
  buffer_load_dwordx4 a[144:147], v252, s[8:11], s44 offen offset:2048 sc1
  buffer_load_dwordx4 a[148:151], v253, s[8:11], s44 offen offset:2048 sc1
  buffer_load_dwordx4 a[152:155], v252, s[8:11], s44 offen offset:3072 sc1
  buffer_load_dwordx4 a[156:159], v253, s[8:11], s44 offen offset:3072 sc1
  s_add_u32 s44, s44, 4096
  buffer_load_dwordx4 a[160:163], v252, s[8:11], s44 offen offset:0 sc1
  buffer_load_dwordx4 a[164:167], v253, s[8:11], s44 offen offset:0 sc1
  buffer_load_dwordx4 a[168:171], v252, s[8:11], s44 offen offset:1024 sc1
  buffer_load_dwordx4 a[172:175], v253, s[8:11], s44 offen offset:1024 sc1
  buffer_load_dwordx4 a[176:179], v252, s[8:11], s44 offen offset:2048 sc1
  buffer_load_dwordx4 a[180:183], v253, s[8:11], s44 offen offset:2048 sc1
  buffer_load_dwordx4 a[184:187], v252, s[8:11], s44 offen offset:3072 sc1
  buffer_load_dwordx4 a[188:191], v253, s[8:11], s44 offen offset:3072 sc1
  s_add_u32 s44, s44, 4096
  buffer_load_dwordx4 a[240:243], v252, s[8:11], s44 offen offset:0 sc1
  buffer_load_dwordx4 a[244:247], v253, s[8:11], s44 offen offset:0 sc1
  buffer_load_dwordx4 a[248:251], v252, s[8:11], s44 offen offset:1024 sc1
  buffer_load_dwordx4 a[252:255], v253, s[8:11], s44 offen offset:1024 sc1
  buffer_load_dwordx4 v[96:99], v252, s[8:11], s44 offen offset:2048 sc1
  buffer_load_dwordx4 v[100:103], v253, s[8:11], s44 offen offset:2048 sc1
  buffer_load_dwordx4 v[104:107], v252, s[8:11], s44 offen offset:3072 sc1
  buffer_load_dwordx4 v[108:111], v253, s[8:11], s44 offen offset:3072 sc1
  s_add_u32 s44, s44, 4096
  buffer_load_dwordx4 v[112:115], v252, s[8:11], s44 offen offset:0 sc1
  buffer_load_dwordx4 v[116:119], v253, s[8:11], s44 offen offset:0 sc1
  buffer_load_dwordx4 v[120:123], v252, s[8:11], s44 offen offset:1024 sc1
  buffer_load_dwordx4 v[124:127], v253, s[8:11], s44 offen offset:1024 sc1
  buffer_load_dwordx4 v[128:131], v252, s[8:11], s44 offen offset:2048 sc1
  buffer_load_dwordx4 v[132:135], v253, s[8:11], s44 offen offset:2048 sc1
  buffer_load_dwordx4 v[136:139], v252, s[8:11], s44 offen offset:3072 sc1
  buffer_load_dwordx4 v[140:143], v253, s[8:11], s44 offen offset:3072 sc1
  s_add_u32 s44, s44, 4096
  buffer_load_dwordx4 v[144:147], v252, s[8:11], s44 offen offset:0 sc1
  buffer_load_dwordx4 v[148:151], v253, s[8:11], s44 offen offset:0 sc1
  buffer_load_dwordx4 v[152:155], v252, s[8:11], s44 offen offset:1024 sc1
  buffer_load_dwordx4 v[156:159], v253, s[8:11], s44 offen offset:1024 sc1
  buffer_load_dwordx4 v[160:163], v252, s[8:11], s44 offen offset:2048 sc1
  buffer_load_dwordx4 v[164:167], v253, s[8:11], s44 offen offset:2048 sc1
  buffer_load_dwordx4 v[168:171], v252, s[8:11], s44 offen offset:3072 sc1
  buffer_load_dwordx4 v[172:175], v253, s[8:11], s44 offen offset:3072 sc1
  s_add_u32 s44, s44, 4096
DOE:
  s_cmp_lt_u32 s6, 15
  s_cselect_b32 s5, 2, 1
  s_add_u32 s5, s5, s94
  s_cmp_gt_u32 s5, s6
  s_cbranch_scc1 NOE
  s_lshl_b32 s5, s94, 3
  s_add_u32 s5, s5, s3
  s_lshl_b32 s5, s5, 7
  s_add_u32 s5, s5, 71970816
  s_barrier
  s_mul_i32 s44, s21, 4096
  s_add_u32 m0, s44, 118784
  s_nop 0
  buffer_load_dwordx4 v179, s[56:59], s71 offen  lds
  s_add_u32 m0, s44, 119808
  s_nop 0
  buffer_load_dwordx4 v180, s[56:59], s71 offen  lds
  s_add_u32 m0, s44, 120832
  s_nop 0
  buffer_load_dwordx4 v181, s[56:59], s71 offen  lds
  s_add_u32 m0, s44, 121856
  s_nop 0
  buffer_load_dwordx4 v182, s[56:59], s71 offen  lds
  s_add_u32 s71, s71, 589824
  s_mul_i32 s44, s21, 4096
  s_add_u32 m0, s44, 147456
  s_nop 0
  buffer_load_dwordx4 v179, s[56:59], s71 offen  lds
  s_add_u32 m0, s44, 148480
  s_nop 0
  buffer_load_dwordx4 v180, s[56:59], s71 offen  lds
  s_add_u32 m0, s44, 149504
  s_nop 0
  buffer_load_dwordx4 v181, s[56:59], s71 offen  lds
  s_add_u32 m0, s44, 150528
  s_nop 0
  buffer_load_dwordx4 v182, s[56:59], s71 offen  lds
  s_add_u32 s71, s71, 589824
  s_cmp_lg_u32 s21, 0
  s_cbranch_scc1 W_20_ok
  s_mov_b32 s79, 0
W_20:
  buffer_load_dword v251, off, s[8:11], s5 offset:0 sc1
  s_add_u32 s79, s79, 1
  s_cmp_gt_u32 s79, 0x40000
  s_cbranch_scc1 BG_END
  s_waitcnt vmcnt(0)
  v_readfirstlane_b32 s78, v251
  s_bfe_u32 s78, s78, 0x80000
  s_cmp_eq_u32 s78, 32
  s_cbranch_scc1 W_20_ok
  s_sleep 8
  s_branch W_20
W_20_ok:
  s_barrier
  s_mul_i32 s44, s21, 3072
  s_add_u32 m0, s44, 106496
  s_nop 0
  buffer_load_dwordx4 v176, s[8:11], s70 offen sc1 lds
  s_add_u32 m0, s44, 107520
  s_nop 0
  buffer_load_dwordx4 v177, s[8:11], s70 offen sc1 lds
  s_add_u32 m0, s44, 108544
  s_nop 0
  buffer_load_dwordx4 v178, s[8:11], s70 offen sc1 lds
  s_add_u32 s70, s70, 73728
  s_mul_i32 s44, s21, 3072
  s_add_u32 m0, s44, 135168
  s_nop 0
  buffer_load_dwordx4 v176, s[8:11], s70 offen sc1 lds
  s_add_u32 m0, s44, 136192
  s_nop 0
  buffer_load_dwordx4 v177, s[8:11], s70 offen sc1 lds
  s_add_u32 m0, s44, 137216
  s_nop 0
  buffer_load_dwordx4 v178, s[8:11], s70 offen sc1 lds
  s_add_u32 s70, s70, 73728
  s_waitcnt vmcnt(3)
  s_barrier
  ds_read_b64_tr_b16 v[190:191], v183 offset:0
  ds_read_b64_tr_b16 v[192:193], v183 offset:3072
  ds_read_b64_tr_b16 v[194:195], v184 offset:0
  ds_read_b64_tr_b16 v[196:197], v184 offset:3072
  ds_read_b64_tr_b16 v[198:199], v185 offset:0
  ds_read_b64_tr_b16 v[200:201], v185 offset:3072
  ds_read_b64_tr_b16 v[202:203], v186 offset:0
  ds_read_b64_tr_b16 v[204:205], v186 offset:4096
  ds_read_b64_tr_b16 v[206:207], v187 offset:0
  ds_read_b64_tr_b16 v[208:209], v187 offset:4096
  ds_read_b64_tr_b16 v[210:211], v188 offset:0
  ds_read_b64_tr_b16 v[212:213], v188 offset:4096
  ds_read_b64_tr_b16 v[214:215], v189 offset:0
  ds_read_b64_tr_b16 v[216:217], v189 offset:4096
  s_waitcnt lgkmcnt(0)
  v_mfma_f32_16x16x32_bf16 a[192:195], v[202:205], v[190:193], a[192:195]
  ds_read_b64_tr_b16 v[218:219], v183 offset:6144
  ds_read_b64_tr_b16 v[220:221], v183 offset:9216
  v_mfma_f32_16x16x32_bf16 a[196:199], v[202:205], v[194:197], a[196:199]
  ds_read_b64_tr_b16 v[222:223], v184 offset:6144
  ds_read_b64_tr_b16 v[224:225], v184 offset:9216
  v_mfma_f32_16x16x32_bf16 a[200:203], v[202:205], v[198:201], a[200:203]
  ds_read_b64_tr_b16 v[226:227], v185 offset:6144
  ds_read_b64_tr_b16 v[228:229], v185 offset:9216
  v_mfma_f32_16x16x32_bf16 a[204:207], v[206:209], v[190:193], a[204:207]
  ds_read_b64_tr_b16 v[230:231], v186 offset:8192
  v_mfma_f32_16x16x32_bf16 a[208:211], v[206:209], v[194:197], a[208:211]
  ds_read_b64_tr_b16 v[232:233], v186 offset:12288
  ds_read_b64_tr_b16 v[234:235], v187 offset:8192
  v_mfma_f32_16x16x32_bf16 a[212:215], v[206:209], v[198:201], a[212:215]
  ds_read_b64_tr_b16 v[236:237], v187 offset:12288
  ds_read_b64_tr_b16 v[238:239], v188 offset:8192
  v_mfma_f32_16x16x32_bf16 a[216:219], v[210:213], v[190:193], a[216:219]
  ds_read_b64_tr_b16 v[240:241], v188 offset:12288
  ds_read_b64_tr_b16 v[242:243], v189 offset:8192
  v_mfma_f32_16x16x32_bf16 a[220:223], v[210:213], v[194:197], a[220:223]
  ds_read_b64_tr_b16 v[244:245], v189 offset:12288
  v_mfma_f32_16x16x32_bf16 a[224:227], v[210:213], v[198:201], a[224:227]
  v_add_u32 v183, 28672, v183
  v_add_u32 v184, 28672, v184
  v_mfma_f32_16x16x32_bf16 a[228:231], v[214:217], v[190:193], a[228:231]
  v_add_u32 v185, 28672, v185
  v_add_u32 v186, 28672, v186
  v_mfma_f32_16x16x32_bf16 a[232:235], v[214:217], v[194:197], a[232:235]
  v_add_u32 v187, 28672, v187
  v_add_u32 v188, 28672, v188
  v_mfma_f32_16x16x32_bf16 a[236:239], v[214:217], v[198:201], a[236:239]
  v_add_u32 v189, 28672, v189
  s_waitcnt lgkmcnt(0)
  s_waitcnt vmcnt(0)
  s_barrier
  v_mfma_f32_16x16x32_bf16 a[192:195], v[230:233], v[218:221], a[192:195]
  ds_read_b64_tr_b16 v[190:191], v183 offset:0
  ds_read_b64_tr_b16 v[192:193], v183 offset:3072
  v_mfma_f32_16x16x32_bf16 a[196:199], v[230:233], v[222:225], a[196:199]
  ds_read_b64_tr_b16 v[194:195], v184 offset:0
  v_mfma_f32_16x16x32_bf16 a[200:203], v[230:233], v[226:229], a[200:203]
  ds_read_b64_tr_b16 v[196:197], v184 offset:3072
  v_mfma_f32_16x16x32_bf16 a[204:207], v[234:237], v[218:221], a[204:207]
  ds_read_b64_tr_b16 v[198:199], v185 offset:0
  v_mfma_f32_16x16x32_bf16 a[208:211], v[234:237], v[222:225], a[208:211]
  ds_read_b64_tr_b16 v[200:201], v185 offset:3072
  v_mfma_f32_16x16x32_bf16 a[212:215], v[234:237], v[226:229], a[212:215]
  ds_read_b64_tr_b16 v[202:203], v186 offset:0
  v_mfma_f32_16x16x32_bf16 a[216:219], v[238:241], v[218:221], a[216:219]
  ds_read_b64_tr_b16 v[204:205], v186 offset:4096
  ds_read_b64_tr_b16 v[206:207], v187 offset:0
  v_mfma_f32_16x16x32_bf16 a[220:223], v[238:241], v[222:225], a[220:223]
  ds_read_b64_tr_b16 v[208:209], v187 offset:4096
  v_mfma_f32_16x16x32_bf16 a[224:227], v[238:241], v[226:229], a[224:227]
  ds_read_b64_tr_b16 v[210:211], v188 offset:0
  v_mfma_f32_16x16x32_bf16 a[228:231], v[242:245], v[218:221], a[228:231]
  ds_read_b64_tr_b16 v[212:213], v188 offset:4096
  v_mfma_f32_16x16x32_bf16 a[232:235], v[242:245], v[222:225], a[232:235]
  ds_read_b64_tr_b16 v[214:215], v189 offset:0
  v_mfma_f32_16x16x32_bf16 a[236:239], v[242:245], v[226:229], a[236:239]
  ds_read_b64_tr_b16 v[216:217], v189 offset:4096
  s_waitcnt lgkmcnt(0)
  v_mfma_f32_16x16x32_bf16 a[192:195], v[202:205], v[190:193], a[192:195]
  ds_read_b64_tr_b16 v[218:219], v183 offset:6144
  ds_read_b64_tr_b16 v[220:221], v183 offset:9216
  v_mfma_f32_16x16x32_bf16 a[196:199], v[202:205], v[194:197], a[196:199]
  ds_read_b64_tr_b16 v[222:223], v184 offset:6144
  ds_read_b64_tr_b16 v[224:225], v184 offset:9216
  v_mfma_f32_16x16x32_bf16 a[200:203], v[202:205], v[198:201], a[200:203]
  ds_read_b64_tr_b16 v[226:227], v185 offset:6144
  ds_read_b64_tr_b16 v[228:229], v185 offset:9216
  v_mfma_f32_16x16x32_bf16 a[204:207], v[206:209], v[190:193], a[204:207]
  ds_read_b64_tr_b16 v[230:231], v186 offset:8192
  v_mfma_f32_16x16x32_bf16 a[208:211], v[206:209], v[194:197], a[208:211]
  ds_read_b64_tr_b16 v[232:233], v186 offset:12288
  ds_read_b64_tr_b16 v[234:235], v187 offset:8192
  v_mfma_f32_16x16x32_bf16 a[212:215], v[206:209], v[198:201], a[212:215]
  ds_read_b64_tr_b16 v[236:237], v187 offset:12288
  ds_read_b64_tr_b16 v[238:239], v188 offset:8192
  v_mfma_f32_16x16x32_bf16 a[216:219], v[210:213], v[190:193], a[216:219]
  ds_read_b64_tr_b16 v[240:241], v188 offset:12288
  ds_read_b64_tr_b16 v[242:243], v189 offset:8192
  v_mfma_f32_16x16x32_bf16 a[220:223], v[210:213], v[194:197], a[220:223]
  ds_read_b64_tr_b16 v[244:245], v189 offset:12288
  v_mfma_f32_16x16x32_bf16 a[224:227], v[210:213], v[198:201], a[224:227]
  v_add_u32 v183, 4294938624, v183
  v_add_u32 v184, 4294938624, v184
  v_mfma_f32_16x16x32_bf16 a[228:231], v[214:217], v[190:193], a[228:231]
  v_add_u32 v185, 4294938624, v185
  v_add_u32 v186, 4294938624, v186
  v_mfma_f32_16x16x32_bf16 a[232:235], v[214:217], v[194:197], a[232:235]
  v_add_u32 v187, 4294938624, v187
  v_add_u32 v188, 4294938624, v188
  v_mfma_f32_16x16x32_bf16 a[236:239], v[214:217], v[198:201], a[236:239]
  v_add_u32 v189, 4294938624, v189
  s_waitcnt lgkmcnt(0)
  v_mfma_f32_16x16x32_bf16 a[192:195], v[230:233], v[218:221], a[192:195]
  v_mfma_f32_16x16x32_bf16 a[196:199], v[230:233], v[222:225], a[196:199]
  v_mfma_f32_16x16x32_bf16 a[200:203], v[230:233], v[226:229], a[200:203]
  v_mfma_f32_16x16x32_bf16 a[204:207], v[234:237], v[218:221], a[204:207]
  v_mfma_f32_16x16x32_bf16 a[208:211], v[234:237], v[222:225], a[208:211]
  v_mfma_f32_16x16x32_bf16 a[212:215], v[234:237], v[226:229], a[212:215]
  v_mfma_f32_16x16x32_bf16 a[216:219], v[238:241], v[218:221], a[216:219]
  v_mfma_f32_16x16x32_bf16 a[220:223], v[238:241], v[222:225], a[220:223]
  v_mfma_f32_16x16x32_bf16 a[224:227], v[238:241], v[226:229], a[224:227]
  v_mfma_f32_16x16x32_bf16 a[228:231], v[242:245], v[218:221], a[228:231]
  v_mfma_f32_16x16x32_bf16 a[232:235], v[242:245], v[222:225], a[232:235]
  v_mfma_f32_16x16x32_bf16 a[236:239], v[242:245], v[226:229], a[236:239]
  s_add_u32 s94, s94, 1
  s_branch DOE
NOE:
  s_add_u32 s6, s6, 1
  s_cmp_lt_u32 s6, 17
  s_cbranch_scc1 ILOOP
  v_lshlrev_b32 v1, 4, v0
  s_nop 7
  s_nop 3
  v_accvgpr_read_b32 v24, a192
  v_accvgpr_read_b32 v25, a193
  v_accvgpr_read_b32 v26, a194
  v_accvgpr_read_b32 v27, a195
  v_accvgpr_read_b32 v28, a196
  v_accvgpr_read_b32 v29, a197
  v_accvgpr_read_b32 v30, a198
  v_accvgpr_read_b32 v31, a199
  v_accvgpr_read_b32 v32, a200
  v_accvgpr_read_b32 v33, a201
  v_accvgpr_read_b32 v34, a202
  v_accvgpr_read_b32 v35, a203
  v_accvgpr_read_b32 v36, a204
  v_accvgpr_read_b32 v37, a205
  v_accvgpr_read_b32 v38, a206
  v_accvgpr_read_b32 v39, a207
  v_accvgpr_read_b32 v40, a208
  v_accvgpr_read_b32 v41, a209
  v_accvgpr_read_b32 v42, a210
  v_accvgpr_read_b32 v43, a211
  v_accvgpr_read_b32 v44, a212
  v_accvgpr_read_b32 v45, a213
  v_accvgpr_read_b32 v46, a214
  v_accvgpr_read_b32 v47, a215
  v_accvgpr_read_b32 v48, a216
  v_accvgpr_read_b32 v49, a217
  v_accvgpr_read_b32 v50, a218
  v_accvgpr_read_b32 v51, a219
  v_accvgpr_read_b32 v52, a220
  v_accvgpr_read_b32 v53, a221
  v_accvgpr_read_b32 v54, a222
  v_accvgpr_read_b32 v55, a223
  v_accvgpr_read_b32 v56, a224
  v_accvgpr_read_b32 v57, a225
  v_accvgpr_read_b32 v58, a226
  v_accvgpr_read_b32 v59, a227
  v_accvgpr_read_b32 v60, a228
  v_accvgpr_read_b32 v61, a229
  v_accvgpr_read_b32 v62, a230
  v_accvgpr_read_b32 v63, a231
  v_accvgpr_read_b32 v64, a232
  v_accvgpr_read_b32 v65, a233
  v_accvgpr_read_b32 v66, a234
  v_accvgpr_read_b32 v67, a235
  v_accvgpr_read_b32 v68, a236
  v_accvgpr_read_b32 v69, a237
  v_accvgpr_read_b32 v70, a238
  v_accvgpr_read_b32 v71, a239
  s_mul_i32 s44, s69, 6
  s_add_u32 s44, s44, s73
  s_mul_i32 s44, s44, 147456
  s_lshl_b32 s45, s68, 3
  s_add_u32 s45, s45, s72
  s_lshl_b32 s45, s45, 9
  s_add_u32 s44, s44, s45
  s_add_u32 s44, s44, 100663296
  s_mov_b32 s45, 0xbdd2d3e8
  v_mov_b32 v3, 0xc0135761
  v_mul_f32 v16, v24, v24
  v_fma_f32 v16, v16, s45, v3
  v_mul_f32 v16, v16, v24
  v_mul_f32 v17, v25, v25
  v_fma_f32 v17, v17, s45, v3
  v_mul_f32 v17, v17, v25
  v_mul_f32 v18, v26, v26
  v_fma_f32 v18, v18, s45, v3
  v_mul_f32 v18, v18, v26
  v_mul_f32 v19, v27, v27
  v_fma_f32 v19, v19, s45, v3
  v_mul_f32 v19, v19, v27
  v_mul_f32 v20, v36, v36
  v_fma_f32 v20, v20, s45, v3
  v_mul_f32 v20, v20, v36
  v_mul_f32 v21, v37, v37
  v_fma_f32 v21, v21, s45, v3
  v_mul_f32 v21, v21, v37
  v_mul_f32 v22, v38, v38
  v_fma_f32 v22, v22, s45, v3
  v_mul_f32 v22, v22, v38
  v_mul_f32 v23, v39, v39
  v_fma_f32 v23, v23, s45, v3
  v_mul_f32 v23, v23, v39
  v_exp_f32 v16, v16
  v_exp_f32 v17, v17
  v_exp_f32 v18, v18
  v_exp_f32 v19, v19
  v_exp_f32 v20, v20
  v_exp_f32 v21, v21
  v_exp_f32 v22, v22
  v_exp_f32 v23, v23
  v_add_f32 v16, 1.0, v16
  v_add_f32 v17, 1.0, v17
  v_add_f32 v18, 1.0, v18
  v_add_f32 v19, 1.0, v19
  v_add_f32 v20, 1.0, v20
  v_add_f32 v21, 1.0, v21
  v_add_f32 v22, 1.0, v22
  v_add_f32 v23, 1.0, v23
  v_rcp_f32 v16, v16
  v_rcp_f32 v17, v17
  v_rcp_f32 v18, v18
  v_rcp_f32 v19, v19
  v_rcp_f32 v20, v20
  v_rcp_f32 v21, v21
  v_rcp_f32 v22, v22
  v_rcp_f32 v23, v23
  v_mul_f32 v24, v16, v24
  v_mul_f32 v25, v17, v25
  v_mul_f32 v26, v18, v26
  v_mul_f32 v27, v19, v27
  v_mul_f32 v36, v20, v36
  v_mul_f32 v37, v21, v37
  v_mul_f32 v38, v22, v38
  v_mul_f32 v39, v23, v39
  v_cvt_pk_bf16_f32 v206, v24, v25
  v_cvt_pk_bf16_f32 v207, v26, v27
  v_cvt_pk_bf16_f32 v208, v36, v37
  v_cvt_pk_bf16_f32 v209, v38, v39
  buffer_store_dwordx4 v[206:209], v1, s[8:11], s44 offen offset:0 sc1
  v_mul_f32 v16, v48, v48
  v_fma_f32 v16, v16, s45, v3
  v_mul_f32 v16, v16, v48
  v_mul_f32 v17, v49, v49
  v_fma_f32 v17, v17, s45, v3
  v_mul_f32 v17, v17, v49
  v_mul_f32 v18, v50, v50
  v_fma_f32 v18, v18, s45, v3
  v_mul_f32 v18, v18, v50
  v_mul_f32 v19, v51, v51
  v_fma_f32 v19, v19, s45, v3
  v_mul_f32 v19, v19, v51
  v_mul_f32 v20, v60, v60
  v_fma_f32 v20, v20, s45, v3
  v_mul_f32 v20, v20, v60
  v_mul_f32 v21, v61, v61
  v_fma_f32 v21, v21, s45, v3
  v_mul_f32 v21, v21, v61
  v_mul_f32 v22, v62, v62
  v_fma_f32 v22, v22, s45, v3
  v_mul_f32 v22, v22, v62
  v_mul_f32 v23, v63, v63
  v_fma_f32 v23, v23, s45, v3
  v_mul_f32 v23, v23, v63
  v_exp_f32 v16, v16
  v_exp_f32 v17, v17
  v_exp_f32 v18, v18
  v_exp_f32 v19, v19
  v_exp_f32 v20, v20
  v_exp_f32 v21, v21
  v_exp_f32 v22, v22
  v_exp_f32 v23, v23
  v_add_f32 v16, 1.0, v16
  v_add_f32 v17, 1.0, v17
  v_add_f32 v18, 1.0, v18
  v_add_f32 v19, 1.0, v19
  v_add_f32 v20, 1.0, v20
  v_add_f32 v21, 1.0, v21
  v_add_f32 v22, 1.0, v22
  v_add_f32 v23, 1.0, v23
  v_rcp_f32 v16, v16
  v_rcp_f32 v17, v17
  v_rcp_f32 v18, v18
  v_rcp_f32 v19, v19
  v_rcp_f32 v20, v20
  v_rcp_f32 v21, v21
  v_rcp_f32 v22, v22
  v_rcp_f32 v23, v23
  v_mul_f32 v48, v16, v48
  v_mul_f32 v49, v17, v49
  v_mul_f32 v50, v18, v50
  v_mul_f32 v51, v19, v51
  v_mul_f32 v60, v20, v60
  v_mul_f32 v61, v21, v61
  v_mul_f32 v62, v22, v62
  v_mul_f32 v63, v23, v63
  v_cvt_pk_bf16_f32 v210, v48, v49
  v_cvt_pk_bf16_f32 v211, v50, v51
  v_cvt_pk_bf16_f32 v212, v60, v61
  v_cvt_pk_bf16_f32 v213, v62, v63
  buffer_store_dwordx4 v[210:213], v1, s[8:11], s44 offen offset:1024 sc1
  s_add_u32 s44, s44, 147456
  v_mul_f32 v16, v28, v28
  v_fma_f32 v16, v16, s45, v3
  v_mul_f32 v16, v16, v28
  v_mul_f32 v17, v29, v29
  v_fma_f32 v17, v17, s45, v3
  v_mul_f32 v17, v17, v29
  v_mul_f32 v18, v30, v30
  v_fma_f32 v18, v18, s45, v3
  v_mul_f32 v18, v18, v30
  v_mul_f32 v19, v31, v31
  v_fma_f32 v19, v19, s45, v3
  v_mul_f32 v19, v19, v31
  v_mul_f32 v20, v40, v40
  v_fma_f32 v20, v20, s45, v3
  v_mul_f32 v20, v20, v40
  v_mul_f32 v21, v41, v41
  v_fma_f32 v21, v21, s45, v3
  v_mul_f32 v21, v21, v41
  v_mul_f32 v22, v42, v42
  v_fma_f32 v22, v22, s45, v3
  v_mul_f32 v22, v22, v42
  v_mul_f32 v23, v43, v43
  v_fma_f32 v23, v23, s45, v3
  v_mul_f32 v23, v23, v43
  v_exp_f32 v16, v16
  v_exp_f32 v17, v17
  v_exp_f32 v18, v18
  v_exp_f32 v19, v19
  v_exp_f32 v20, v20
  v_exp_f32 v21, v21
  v_exp_f32 v22, v22
  v_exp_f32 v23, v23
  v_add_f32 v16, 1.0, v16
  v_add_f32 v17, 1.0, v17
  v_add_f32 v18, 1.0, v18
  v_add_f32 v19, 1.0, v19
  v_add_f32 v20, 1.0, v20
  v_add_f32 v21, 1.0, v21
  v_add_f32 v22, 1.0, v22
  v_add_f32 v23, 1.0, v23
  v_rcp_f32 v16, v16
  v_rcp_f32 v17, v17
  v_rcp_f32 v18, v18
  v_rcp_f32 v19, v19
  v_rcp_f32 v20, v20
  v_rcp_f32 v21, v21
  v_rcp_f32 v22, v22
  v_rcp_f32 v23, v23
  v_mul_f32 v28, v16, v28
  v_mul_f32 v29, v17, v29
  v_mul_f32 v30, v18, v30
  v_mul_f32 v31, v19, v31
  v_mul_f32 v40, v20, v40
  v_mul_f32 v41, v21, v41
  v_mul_f32 v42, v22, v42
  v_mul_f32 v43, v23, v43
  v_cvt_pk_bf16_f32 v214, v28, v29
  v_cvt_pk_bf16_f32 v215, v30, v31
  v_cvt_pk_bf16_f32 v216, v40, v41
  v_cvt_pk_bf16_f32 v217, v42, v43
  buffer_store_dwordx4 v[214:217], v1, s[8:11], s44 offen offset:0 sc1
  v_mul_f32 v16, v52, v52
  v_fma_f32 v16, v16, s45, v3
  v_mul_f32 v16, v16, v52
  v_mul_f32 v17, v53, v53
  v_fma_f32 v17, v17, s45, v3
  v_mul_f32 v17, v17, v53
  v_mul_f32 v18, v54, v54
  v_fma_f32 v18, v18, s45, v3
  v_mul_f32 v18, v18, v54
  v_mul_f32 v19, v55, v55
  v_fma_f32 v19, v19, s45, v3
  v_mul_f32 v19, v19, v55
  v_mul_f32 v20, v64, v64
  v_fma_f32 v20, v20, s45, v3
  v_mul_f32 v20, v20, v64
  v_mul_f32 v21, v65, v65
  v_fma_f32 v21, v21, s45, v3
  v_mul_f32 v21, v21, v65
  v_mul_f32 v22, v66, v66
  v_fma_f32 v22, v22, s45, v3
  v_mul_f32 v22, v22, v66
  v_mul_f32 v23, v67, v67
  v_fma_f32 v23, v23, s45, v3
  v_mul_f32 v23, v23, v67
  v_exp_f32 v16, v16
  v_exp_f32 v17, v17
  v_exp_f32 v18, v18
  v_exp_f32 v19, v19
  v_exp_f32 v20, v20
  v_exp_f32 v21, v21
  v_exp_f32 v22, v22
  v_exp_f32 v23, v23
  v_add_f32 v16, 1.0, v16
  v_add_f32 v17, 1.0, v17
  v_add_f32 v18, 1.0, v18
  v_add_f32 v19, 1.0, v19
  v_add_f32 v20, 1.0, v20
  v_add_f32 v21, 1.0, v21
  v_add_f32 v22, 1.0, v22
  v_add_f32 v23, 1.0, v23
  v_rcp_f32 v16, v16
  v_rcp_f32 v17, v17
  v_rcp_f32 v18, v18
  v_rcp_f32 v19, v19
  v_rcp_f32 v20, v20
  v_rcp_f32 v21, v21
  v_rcp_f32 v22, v22
  v_rcp_f32 v23, v23
  v_mul_f32 v52, v16, v52
  v_mul_f32 v53, v17, v53
  v_mul_f32 v54, v18, v54
  v_mul_f32 v55, v19, v55
  v_mul_f32 v64, v20, v64
  v_mul_f32 v65, v21, v65
  v_mul_f32 v66, v22, v66
  v_mul_f32 v67, v23, v67
  v_cvt_pk_bf16_f32 v218, v52, v53
  v_cvt_pk_bf16_f32 v219, v54, v55
  v_cvt_pk_bf16_f32 v220, v64, v65
  v_cvt_pk_bf16_f32 v221, v66, v67
  buffer_store_dwordx4 v[218:221], v1, s[8:11], s44 offen offset:1024 sc1
  s_add_u32 s44, s44, 147456
  v_mul_f32 v16, v32, v32
  v_fma_f32 v16, v16, s45, v3
  v_mul_f32 v16, v16, v32
  v_mul_f32 v17, v33, v33
  v_fma_f32 v17, v17, s45, v3
  v_mul_f32 v17, v17, v33
  v_mul_f32 v18, v34, v34
  v_fma_f32 v18, v18, s45, v3
  v_mul_f32 v18, v18, v34
  v_mul_f32 v19, v35, v35
  v_fma_f32 v19, v19, s45, v3
  v_mul_f32 v19, v19, v35
  v_mul_f32 v20, v44, v44
  v_fma_f32 v20, v20, s45, v3
  v_mul_f32 v20, v20, v44
  v_mul_f32 v21, v45, v45
  v_fma_f32 v21, v21, s45, v3
  v_mul_f32 v21, v21, v45
  v_mul_f32 v22, v46, v46
  v_fma_f32 v22, v22, s45, v3
  v_mul_f32 v22, v22, v46
  v_mul_f32 v23, v47, v47
  v_fma_f32 v23, v23, s45, v3
  v_mul_f32 v23, v23, v47
  v_exp_f32 v16, v16
  v_exp_f32 v17, v17
  v_exp_f32 v18, v18
  v_exp_f32 v19, v19
  v_exp_f32 v20, v20
  v_exp_f32 v21, v21
  v_exp_f32 v22, v22
  v_exp_f32 v23, v23
  v_add_f32 v16, 1.0, v16
  v_add_f32 v17, 1.0, v17
  v_add_f32 v18, 1.0, v18
  v_add_f32 v19, 1.0, v19
  v_add_f32 v20, 1.0, v20
  v_add_f32 v21, 1.0, v21
  v_add_f32 v22, 1.0, v22
  v_add_f32 v23, 1.0, v23
  v_rcp_f32 v16, v16
  v_rcp_f32 v17, v17
  v_rcp_f32 v18, v18
  v_rcp_f32 v19, v19
  v_rcp_f32 v20, v20
  v_rcp_f32 v21, v21
  v_rcp_f32 v22, v22
  v_rcp_f32 v23, v23
  v_mul_f32 v32, v16, v32
  v_mul_f32 v33, v17, v33
  v_mul_f32 v34, v18, v34
  v_mul_f32 v35, v19, v35
  v_mul_f32 v44, v20, v44
  v_mul_f32 v45, v21, v45
  v_mul_f32 v46, v22, v46
  v_mul_f32 v47, v23, v47
  v_cvt_pk_bf16_f32 v222, v32, v33
  v_cvt_pk_bf16_f32 v223, v34, v35
  v_cvt_pk_bf16_f32 v224, v44, v45
  v_cvt_pk_bf16_f32 v225, v46, v47
  buffer_store_dwordx4 v[222:225], v1, s[8:11], s44 offen offset:0 sc1
  v_mul_f32 v16, v56, v56
  v_fma_f32 v16, v16, s45, v3
  v_mul_f32 v16, v16, v56
  v_mul_f32 v17, v57, v57
  v_fma_f32 v17, v17, s45, v3
  v_mul_f32 v17, v17, v57
  v_mul_f32 v18, v58, v58
  v_fma_f32 v18, v18, s45, v3
  v_mul_f32 v18, v18, v58
  v_mul_f32 v19, v59, v59
  v_fma_f32 v19, v19, s45, v3
  v_mul_f32 v19, v19, v59
  v_mul_f32 v20, v68, v68
  v_fma_f32 v20, v20, s45, v3
  v_mul_f32 v20, v20, v68
  v_mul_f32 v21, v69, v69
  v_fma_f32 v21, v21, s45, v3
  v_mul_f32 v21, v21, v69
  v_mul_f32 v22, v70, v70
  v_fma_f32 v22, v22, s45, v3
  v_mul_f32 v22, v22, v70
  v_mul_f32 v23, v71, v71
  v_fma_f32 v23, v23, s45, v3
  v_mul_f32 v23, v23, v71
  v_exp_f32 v16, v16
  v_exp_f32 v17, v17
  v_exp_f32 v18, v18
  v_exp_f32 v19, v19
  v_exp_f32 v20, v20
  v_exp_f32 v21, v21
  v_exp_f32 v22, v22
  v_exp_f32 v23, v23
  v_add_f32 v16, 1.0, v16
  v_add_f32 v17, 1.0, v17
  v_add_f32 v18, 1.0, v18
  v_add_f32 v19, 1.0, v19
  v_add_f32 v20, 1.0, v20
  v_add_f32 v21, 1.0, v21
  v_add_f32 v22, 1.0, v22
  v_add_f32 v23, 1.0, v23
  v_rcp_f32 v16, v16
  v_rcp_f32 v17, v17
  v_rcp_f32 v18, v18
  v_rcp_f32 v19, v19
  v_rcp_f32 v20, v20
  v_rcp_f32 v21, v21
  v_rcp_f32 v22, v22
  v_rcp_f32 v23, v23
  v_mul_f32 v56, v16, v56
  v_mul_f32 v57, v17, v57
  v_mul_f32 v58, v18, v58
  v_mul_f32 v59, v19, v59
  v_mul_f32 v68, v20, v68
  v_mul_f32 v69, v21, v69
  v_mul_f32 v70, v22, v70
  v_mul_f32 v71, v23, v71
  v_cvt_pk_bf16_f32 v226, v56, v57
  v_cvt_pk_bf16_f32 v227, v58, v59
  v_cvt_pk_bf16_f32 v228, v68, v69
  v_cvt_pk_bf16_f32 v229, v70, v71
  buffer_store_dwordx4 v[226:229], v1, s[8:11], s44 offen offset:1024 sc1
  s_add_u32 s44, s44, 147456
  s_mul_i32 s75, s68, 57
  s_lshr_b32 s75, s75, 9
  s_lshl_b32 s75, s75, 1
  s_cmp_ge_u32 s69, 3
  s_addc_u32 s75, s75, 0
  s_lshl_b32 s75, s75, 9
  s_add_u32 s75, s75, 71987200
  v_lshlrev_b32 v2, 7, v0
  v_mov_b32 v3, 1
  s_waitcnt vmcnt(0)
  s_barrier
  s_cmp_lg_u32 s21, 0
  s_cbranch_scc1 DOF
  s_mov_b64 exec, 15
  buffer_atomic_add v3, v2, s[8:11], s75 offen sc1
  s_mov_b64 exec, -1
DOF:
  s_lshl_b32 s75, s84, 1
  s_lshr_b32 s5, s83, 1
  s_add_u32 s75, s75, s5
  s_lshl_b32 s75, s75, 2
  s_and_b32 s5, s82, 3
  s_add_u32 s75, s75, s5
  s_lshl_b32 s75, s75, 7
  s_add_u32 s75, s75, 71987200
  s_load_dwordx2 s[24:25], s[0:1], 88
  s_mov_b32 s26, 4096
  s_mov_b32 s27, 0x00020000
  s_load_dwordx2 s[28:29], s[0:1], 96
  s_mov_b32 s30, 2359296
  s_mov_b32 s31, 0x00020000
  v_lshlrev_b32 v1, 4, v0
  v_add_u32 v2, 0, v1
  v_add_u32 v3, 147456, v1
  v_add_u32 v4, 294912, v1
  v_add_u32 v5, 442368, v1
  v_add_u32 v6, 589824, v1
  v_add_u32 v7, 737280, v1
  v_add_u32 v8, 884736, v1
  v_add_u32 v9, 1032192, v1
  v_add_u32 v10, 1179648, v1
  v_add_u32 v11, 36864, v1
  v_add_u32 v12, 73728, v1
  v_add_u32 v13, 110592, v1
  s_mul_i32 s40, s83, 1327104
  s_mul_i32 s44, s84, 36864
  s_add_u32 s40, s40, s44
  s_lshl_b32 s44, s21, 10
  s_add_u32 s40, s40, s44
  s_add_u32 s40, s40, 100663296
  s_mul_i32 s47, s21, 9216
  s_cmp_lg_u32 s21, 0
  s_cbranch_scc1 W_21_ok
  s_mov_b32 s79, 0
W_21:
  buffer_load_dword v251, off, s[8:11], s75 offset:0 sc1
  s_add_u32 s79, s79, 1
  s_cmp_gt_u32 s79, 0x40000
  s_cbranch_scc1 BG_END
  s_waitcnt vmcnt(0)
  v_readfirstlane_b32 s78, v251
  s_bfe_u32 s78, s78, 0x80000
  s_cmp_eq_u32 s78, 27
  s_cbranch_scc1 W_21_ok
  s_sleep 2
  s_branch W_21
W_21_ok:
  s_barrier
  s_add_u32 m0, s47, 0
  s_nop 0
  buffer_load_dwordx4 v2, s[8:11], s40 offen sc1 lds
  s_add_u32 m0, s47, 1024
  s_nop 0
  buffer_load_dwordx4 v3, s[8:11], s40 offen sc1 lds
  s_add_u32 m0, s47, 2048
  s_nop 0
  buffer_load_dwordx4 v4, s[8:11], s40 offen sc1 lds
  s_add_u32 m0, s47, 3072
  s_nop 0
  buffer_load_dwordx4 v5, s[8:11], s40 offen sc1 lds
  s_add_u32 m0, s47, 4096
  s_nop 0
  buffer_load_dwordx4 v6, s[8:11], s40 offen sc1 lds
  s_add_u32 m0, s47, 5120
  s_nop 0
  buffer_load_dwordx4 v7, s[8:11], s40 offen sc1 lds
  s_add_u32 m0, s47, 6144
  s_nop 0
  buffer_load_dwordx4 v8, s[8:11], s40 offen sc1 lds
  s_add_u32 m0, s47, 7168
  s_nop 0
  buffer_load_dwordx4 v9, s[8:11], s40 offen sc1 lds
  s_add_u32 m0, s47, 8192
  s_nop 0
  buffer_load_dwordx4 v10, s[8:11], s40 offen sc1 lds
  s_add_u32 s40, s40, 4096
  s_add_u32 m0, s47, 36864
  s_nop 0
  buffer_load_dwordx4 v2, s[8:11], s40 offen sc1 lds
  s_add_u32 m0, s47, 37888
  s_nop 0
  buffer_load_dwordx4 v3, s[8:11], s40 offen sc1 lds
  s_add_u32 m0, s47, 38912
  s_nop 0
  buffer_load_dwordx4 v4, s[8:11], s40 offen sc1 lds
  s_add_u32 m0, s47, 39936
  s_nop 0
  buffer_load_dwordx4 v5, s[8:11], s40 offen sc1 lds
  s_add_u32 m0, s47, 40960
  s_nop 0
  buffer_load_dwordx4 v6, s[8:11], s40 offen sc1 lds
  s_add_u32 m0, s47, 41984
  s_nop 0
  buffer_load_dwordx4 v7, s[8:11], s40 offen sc1 lds
  s_add_u32 m0, s47, 43008
  s_nop 0
  buffer_load_dwordx4 v8, s[8:11], s40 offen sc1 lds
  s_add_u32 m0, s47, 44032
  s_nop 0
  buffer_load_dwordx4 v9, s[8:11], s40 offen sc1 lds
  s_add_u32 m0, s47, 45056
  s_nop 0
  buffer_load_dwordx4 v10, s[8:11], s40 offen sc1 lds
  s_add_u32 s40, s40, 4096
  s_add_u32 m0, s47, 73728
  s_nop 0
  buffer_load_dwordx4 v2, s[8:11], s40 offen sc1 lds
  s_add_u32 m0, s47, 74752
  s_nop 0
  buffer_load_dwordx4 v3, s[8:11], s40 offen sc1 lds
  s_add_u32 m0, s47, 75776
  s_nop 0
  buffer_load_dwordx4 v4, s[8:11], s40 offen sc1 lds
  s_add_u32 m0, s47, 76800
  s_nop 0
  buffer_load_dwordx4 v5, s[8:11], s40 offen sc1 lds
  s_add_u32 m0, s47, 77824
  s_nop 0
  buffer_load_dwordx4 v6, s[8:11], s40 offen sc1 lds
  s_add_u32 m0, s47, 78848
  s_nop 0
  buffer_load_dwordx4 v7, s[8:11], s40 offen sc1 lds
  s_add_u32 m0, s47, 79872
  s_nop 0
  buffer_load_dwordx4 v8, s[8:11], s40 offen sc1 lds
  s_add_u32 m0, s47, 80896
  s_nop 0
  buffer_load_dwordx4 v9, s[8:11], s40 offen sc1 lds
  s_add_u32 m0, s47, 81920
  s_nop 0
  buffer_load_dwordx4 v10, s[8:11], s40 offen sc1 lds
  s_add_u32 s40, s40, 4096
  s_add_u32 m0, s47, 110592
  s_nop 0
  buffer_load_dwordx4 v2, s[8:11], s40 offen sc1 lds
  s_add_u32 m0, s47, 111616
  s_nop 0
  buffer_load_dwordx4 v3, s[8:11], s40 offen sc1 lds
  s_add_u32 m0, s47, 112640
  s_nop 0
  buffer_load_dwordx4 v4, s[8:11], s40 offen sc1 lds
  s_add_u32 m0, s47, 113664
  s_nop 0
  buffer_load_dwordx4 v5, s[8:11], s40 offen sc1 lds
  s_add_u32 m0, s47, 114688
  s_nop 0
  buffer_load_dwordx4 v6, s[8:11], s40 offen sc1 lds
  s_add_u32 m0, s47, 115712
  s_nop 0
  buffer_load_dwordx4 v7, s[8:11], s40 offen sc1 lds
  s_add_u32 m0, s47, 116736
  s_nop 0
  buffer_load_dwordx4 v8, s[8:11], s40 offen sc1 lds
  s_add_u32 m0, s47, 117760
  s_nop 0
  buffer_load_dwordx4 v9, s[8:11], s40 offen sc1 lds
  s_add_u32 m0, s47, 118784
  s_nop 0
  buffer_load_dwordx4 v10, s[8:11], s40 offen sc1 lds
  s_add_u32 s40, s40, 4096
  s_waitcnt vmcnt(27)
  s_barrier
  ds_read_b128 v[24:27], v1 offset:0
  ds_read_b128 v[28:31], v1 offset:1024
  ds_read_b128 v[32:35], v1 offset:2048
  ds_read_b128 v[36:39], v1 offset:3072
  ds_read_b128 v[40:43], v1 offset:4096
  ds_read_b128 v[44:47], v1 offset:5120
  ds_read_b128 v[48:51], v1 offset:6144
  ds_read_b128 v[52:55], v1 offset:7168
  ds_read_b128 v[56:59], v1 offset:8192
  s_waitcnt lgkmcnt(8)
  v_mfma_f32_16x16x32_bf16 v[176:179], v[24:27], a[0:3], 0
  ds_read_b128 v[60:63], v1 offset:9216
  v_mfma_f32_16x16x32_bf16 v[180:183], v[24:27], a[4:7], 0
  s_waitcnt lgkmcnt(8)
  v_mfma_f32_16x16x32_bf16 v[184:187], v[28:31], a[0:3], 0
  ds_read_b128 v[64:67], v1 offset:10240
  v_mfma_f32_16x16x32_bf16 v[188:191], v[28:31], a[4:7], 0
  s_waitcnt lgkmcnt(8)
  v_mfma_f32_16x16x32_bf16 v[192:195], v[32:35], a[0:3], 0
  ds_read_b128 v[68:71], v1 offset:11264
  v_mfma_f32_16x16x32_bf16 v[196:199], v[32:35], a[4:7], 0
  s_waitcnt lgkmcnt(8)
  v_mfma_f32_16x16x32_bf16 v[200:203], v[36:39], a[0:3], 0
  ds_read_b128 v[72:75], v1 offset:12288
  v_mfma_f32_16x16x32_bf16 v[204:207], v[36:39], a[4:7], 0
  s_waitcnt lgkmcnt(8)
  v_mfma_f32_16x16x32_bf16 v[208:211], v[40:43], a[0:3], 0
  ds_read_b128 v[76:79], v1 offset:13312
  v_mfma_f32_16x16x32_bf16 v[212:215], v[40:43], a[4:7], 0
  s_waitcnt lgkmcnt(8)
  v_mfma_f32_16x16x32_bf16 v[216:219], v[44:47], a[0:3], 0
  ds_read_b128 v[80:83], v1 offset:14336
  v_mfma_f32_16x16x32_bf16 v[220:223], v[44:47], a[4:7], 0
  s_waitcnt lgkmcnt(8)
  v_mfma_f32_16x16x32_bf16 v[224:227], v[48:51], a[0:3], 0
  ds_read_b128 v[84:87], v1 offset:15360
  v_mfma_f32_16x16x32_bf16 v[228:231], v[48:51], a[4:7], 0
  s_waitcnt lgkmcnt(8)
  v_mfma_f32_16x16x32_bf16 v[232:235], v[52:55], a[0:3], 0
  ds_read_b128 v[88:91], v1 offset:16384
  v_mfma_f32_16x16x32_bf16 v[236:239], v[52:55], a[4:7], 0
  s_waitcnt lgkmcnt(8)
  v_mfma_f32_16x16x32_bf16 v[240:243], v[56:59], a[0:3], 0
  ds_read_b128 v[92:95], v1 offset:17408
  v_mfma_f32_16x16x32_bf16 v[244:247], v[56:59], a[4:7], 0
  s_waitcnt lgkmcnt(8)
  v_mfma_f32_16x16x32_bf16 v[176:179], v[60:63], a[8:11], v[176:179]
  ds_read_b128 v[24:27], v1 offset:18432
  v_mfma_f32_16x16x32_bf16 v[180:183], v[60:63], a[12:15], v[180:183]
  s_waitcnt lgkmcnt(8)
  v_mfma_f32_16x16x32_bf16 v[184:187], v[64:67], a[8:11], v[184:187]
  ds_read_b128 v[28:31], v1 offset:19456
  v_mfma_f32_16x16x32_bf16 v[188:191], v[64:67], a[12:15], v[188:191]
  s_waitcnt lgkmcnt(8)
  v_mfma_f32_16x16x32_bf16 v[192:195], v[68:71], a[8:11], v[192:195]
  ds_read_b128 v[32:35], v1 offset:20480
  v_mfma_f32_16x16x32_bf16 v[196:199], v[68:71], a[12:15], v[196:199]
  s_waitcnt lgkmcnt(8)
  v_mfma_f32_16x16x32_bf16 v[200:203], v[72:75], a[8:11], v[200:203]
  ds_read_b128 v[36:39], v1 offset:21504
  v_mfma_f32_16x16x32_bf16 v[204:207], v[72:75], a[12:15], v[204:207]
  s_waitcnt lgkmcnt(8)
  v_mfma_f32_16x16x32_bf16 v[208:211], v[76:79], a[8:11], v[208:211]
  ds_read_b128 v[40:43], v1 offset:22528
  v_mfma_f32_16x16x32_bf16 v[212:215], v[76:79], a[12:15], v[212:215]
  s_waitcnt lgkmcnt(8)
  v_mfma_f32_16x16x32_bf16 v[216:219], v[80:83], a[8:11], v[216:219]
  ds_read_b128 v[44:47], v1 offset:23552
  v_mfma_f32_16x16x32_bf16 v[220:223], v[80:83], a[12:15], v[220:223]
  s_waitcnt lgkmcnt(8)
  v_mfma_f32_16x16x32_bf16 v[224:227], v[84:87], a[8:11], v[224:227]
  ds_read_b128 v[48:51], v1 offset:24576
  v_mfma_f32_16x16x32_bf16 v[228:231], v[84:87], a[12:15], v[228:231]
  s_waitcnt lgkmcnt(8)
  v_mfma_f32_16x16x32_bf16 v[232:235], v[88:91], a[8:11], v[232:235]
  ds_read_b128 v[52:55], v1 offset:25600
  v_mfma_f32_16x16x32_bf16 v[236:239], v[88:91], a[12:15], v[236:239]
  s_waitcnt lgkmcnt(8)
  v_mfma_f32_16x16x32_bf16 v[240:243], v[92:95], a[8:11], v[240:243]
  ds_read_b128 v[56:59], v1 offset:26624
  v_mfma_f32_16x16x32_bf16 v[244:247], v[92:95], a[12:15], v[244:247]
  s_waitcnt lgkmcnt(8)
  v_mfma_f32_16x16x32_bf16 v[176:179], v[24:27], a[16:19], v[176:179]
  ds_read_b128 v[60:63], v1 offset:27648
  v_mfma_f32_16x16x32_bf16 v[180:183], v[24:27], a[20:23], v[180:183]
  s_waitcnt lgkmcnt(8)
  v_mfma_f32_16x16x32_bf16 v[184:187], v[28:31], a[16:19], v[184:187]
  ds_read_b128 v[64:67], v1 offset:28672
  v_mfma_f32_16x16x32_bf16 v[188:191], v[28:31], a[20:23], v[188:191]
  s_waitcnt lgkmcnt(8)
  v_mfma_f32_16x16x32_bf16 v[192:195], v[32:35], a[16:19], v[192:195]
  ds_read_b128 v[68:71], v1 offset:29696
  v_mfma_f32_16x16x32_bf16 v[196:199], v[32:35], a[20:23], v[196:199]
  s_waitcnt lgkmcnt(8)
  v_mfma_f32_16x16x32_bf16 v[200:203], v[36:39], a[16:19], v[200:203]
  ds_read_b128 v[72:75], v1 offset:30720
  v_mfma_f32_16x16x32_bf16 v[204:207], v[36:39], a[20:23], v[204:207]
  s_waitcnt lgkmcnt(8)
  v_mfma_f32_16x16x32_bf16 v[208:211], v[40:43], a[16:19], v[208:211]
  ds_read_b128 v[76:79], v1 offset:31744
  v_mfma_f32_16x16x32_bf16 v[212:215], v[40:43], a[20:23], v[212:215]
  s_waitcnt lgkmcnt(8)
  v_mfma_f32_16x16x32_bf16 v[216:219], v[44:47], a[16:19], v[216:219]
  ds_read_b128 v[80:83], v1 offset:32768
  v_mfma_f32_16x16x32_bf16 v[220:223], v[44:47], a[20:23], v[220:223]
  s_waitcnt lgkmcnt(8)
  v_mfma_f32_16x16x32_bf16 v[224:227], v[48:51], a[16:19], v[224:227]
  ds_read_b128 v[84:87], v1 offset:33792
  v_mfma_f32_16x16x32_bf16 v[228:231], v[48:51], a[20:23], v[228:231]
  s_waitcnt lgkmcnt(8)
  v_mfma_f32_16x16x32_bf16 v[232:235], v[52:55], a[16:19], v[232:235]
  ds_read_b128 v[88:91], v1 offset:34816
  v_mfma_f32_16x16x32_bf16 v[236:239], v[52:55], a[20:23], v[236:239]
  s_waitcnt lgkmcnt(8)
  v_mfma_f32_16x16x32_bf16 v[240:243], v[56:59], a[16:19], v[240:243]
  ds_read_b128 v[92:95], v1 offset:35840
  v_mfma_f32_16x16x32_bf16 v[244:247], v[56:59], a[20:23], v[244:247]
  s_waitcnt vmcnt(18)
  s_barrier
  s_waitcnt lgkmcnt(8)
  v_mfma_f32_16x16x32_bf16 v[176:179], v[60:63], a[24:27], v[176:179]
  ds_read_b128 v[24:27], v11 offset:0
  v_mfma_f32_16x16x32_bf16 v[180:183], v[60:63], a[28:31], v[180:183]
  s_waitcnt lgkmcnt(8)
  v_mfma_f32_16x16x32_bf16 v[184:187], v[64:67], a[24:27], v[184:187]
  ds_read_b128 v[28:31], v11 offset:1024
  v_mfma_f32_16x16x32_bf16 v[188:191], v[64:67], a[28:31], v[188:191]
  s_waitcnt lgkmcnt(8)
  v_mfma_f32_16x16x32_bf16 v[192:195], v[68:71], a[24:27], v[192:195]
  ds_read_b128 v[32:35], v11 offset:2048
  v_mfma_f32_16x16x32_bf16 v[196:199], v[68:71], a[28:31], v[196:199]
  s_waitcnt lgkmcnt(8)
  v_mfma_f32_16x16x32_bf16 v[200:203], v[72:75], a[24:27], v[200:203]
  ds_read_b128 v[36:39], v11 offset:3072
  v_mfma_f32_16x16x32_bf16 v[204:207], v[72:75], a[28:31], v[204:207]
  s_waitcnt lgkmcnt(8)
  v_mfma_f32_16x16x32_bf16 v[208:211], v[76:79], a[24:27], v[208:211]
  ds_read_b128 v[40:43], v11 offset:4096
  v_mfma_f32_16x16x32_bf16 v[212:215], v[76:79], a[28:31], v[212:215]
  s_waitcnt lgkmcnt(8)
  v_mfma_f32_16x16x32_bf16 v[216:219], v[80:83], a[24:27], v[216:219]
  ds_read_b128 v[44:47], v11 offset:5120
  v_mfma_f32_16x16x32_bf16 v[220:223], v[80:83], a[28:31], v[220:223]
  s_waitcnt lgkmcnt(8)
  v_mfma_f32_16x16x32_bf16 v[224:227], v[84:87], a[24:27], v[224:227]
  ds_read_b128 v[48:51], v11 offset:6144
  v_mfma_f32_16x16x32_bf16 v[228:231], v[84:87], a[28:31], v[228:231]
  s_waitcnt lgkmcnt(8)
  v_mfma_f32_16x16x32_bf16 v[232:235], v[88:91], a[24:27], v[232:235]
  ds_read_b128 v[52:55], v11 offset:7168
  v_mfma_f32_16x16x32_bf16 v[236:239], v[88:91], a[28:31], v[236:239]
  s_waitcnt lgkmcnt(8)
  v_mfma_f32_16x16x32_bf16 v[240:243], v[92:95], a[24:27], v[240:243]
  ds_read_b128 v[56:59], v11 offset:8192
  v_mfma_f32_16x16x32_bf16 v[244:247], v[92:95], a[28:31], v[244:247]
  s_waitcnt lgkmcnt(8)
  v_mfma_f32_16x16x32_bf16 v[176:179], v[24:27], a[32:35], v[176:179]
  ds_read_b128 v[60:63], v11 offset:9216
  v_mfma_f32_16x16x32_bf16 v[180:183], v[24:27], a[36:39], v[180:183]
  s_waitcnt lgkmcnt(8)
  v_mfma_f32_16x16x32_bf16 v[184:187], v[28:31], a[32:35], v[184:187]
  ds_read_b128 v[64:67], v11 offset:10240
  v_mfma_f32_16x16x32_bf16 v[188:191], v[28:31], a[36:39], v[188:191]
  s_waitcnt lgkmcnt(8)
  v_mfma_f32_16x16x32_bf16 v[192:195], v[32:35], a[32:35], v[192:195]
  ds_read_b128 v[68:71], v11 offset:11264
  v_mfma_f32_16x16x32_bf16 v[196:199], v[32:35], a[36:39], v[196:199]
  s_waitcnt lgkmcnt(8)
  v_mfma_f32_16x16x32_bf16 v[200:203], v[36:39], a[32:35], v[200:203]
  ds_read_b128 v[72:75], v11 offset:12288
  v_mfma_f32_16x16x32_bf16 v[204:207], v[36:39], a[36:39], v[204:207]
  s_waitcnt lgkmcnt(8)
  v_mfma_f32_16x16x32_bf16 v[208:211], v[40:43], a[32:35], v[208:211]
  ds_read_b128 v[76:79], v11 offset:13312
  v_mfma_f32_16x16x32_bf16 v[212:215], v[40:43], a[36:39], v[212:215]
  s_waitcnt lgkmcnt(8)
  v_mfma_f32_16x16x32_bf16 v[216:219], v[44:47], a[32:35], v[216:219]
  ds_read_b128 v[80:83], v11 offset:14336
  v_mfma_f32_16x16x32_bf16 v[220:223], v[44:47], a[36:39], v[220:223]
  s_waitcnt lgkmcnt(8)
  v_mfma_f32_16x16x32_bf16 v[224:227], v[48:51], a[32:35], v[224:227]
  ds_read_b128 v[84:87], v11 offset:15360
  v_mfma_f32_16x16x32_bf16 v[228:231], v[48:51], a[36:39], v[228:231]
  s_waitcnt lgkmcnt(8)
  v_mfma_f32_16x16x32_bf16 v[232:235], v[52:55], a[32:35], v[232:235]
  ds_read_b128 v[88:91], v11 offset:16384
  v_mfma_f32_16x16x32_bf16 v[236:239], v[52:55], a[36:39], v[236:239]
  s_waitcnt lgkmcnt(8)
  v_mfma_f32_16x16x32_bf16 v[240:243], v[56:59], a[32:35], v[240:243]
  ds_read_b128 v[92:95], v11 offset:17408
  v_mfma_f32_16x16x32_bf16 v[244:247], v[56:59], a[36:39], v[244:247]
  s_waitcnt lgkmcnt(8)
  v_mfma_f32_16x16x32_bf16 v[176:179], v[60:63], a[40:43], v[176:179]
  ds_read_b128 v[24:27], v11 offset:18432
  v_mfma_f32_16x16x32_bf16 v[180:183], v[60:63], a[44:47], v[180:183]
  s_waitcnt lgkmcnt(8)
  v_mfma_f32_16x16x32_bf16 v[184:187], v[64:67], a[40:43], v[184:187]
  ds_read_b128 v[28:31], v11 offset:19456
  v_mfma_f32_16x16x32_bf16 v[188:191], v[64:67], a[44:47], v[188:191]
  s_waitcnt lgkmcnt(8)
  v_mfma_f32_16x16x32_bf16 v[192:195], v[68:71], a[40:43], v[192:195]
  ds_read_b128 v[32:35], v11 offset:20480
  v_mfma_f32_16x16x32_bf16 v[196:199], v[68:71], a[44:47], v[196:199]
  s_waitcnt lgkmcnt(8)
  v_mfma_f32_16x16x32_bf16 v[200:203], v[72:75], a[40:43], v[200:203]
  ds_read_b128 v[36:39], v11 offset:21504
  v_mfma_f32_16x16x32_bf16 v[204:207], v[72:75], a[44:47], v[204:207]
  s_waitcnt lgkmcnt(8)
  v_mfma_f32_16x16x32_bf16 v[208:211], v[76:79], a[40:43], v[208:211]
  ds_read_b128 v[40:43], v11 offset:22528
  v_mfma_f32_16x16x32_bf16 v[212:215], v[76:79], a[44:47], v[212:215]
  s_waitcnt lgkmcnt(8)
  v_mfma_f32_16x16x32_bf16 v[216:219], v[80:83], a[40:43], v[216:219]
  ds_read_b128 v[44:47], v11 offset:23552
  v_mfma_f32_16x16x32_bf16 v[220:223], v[80:83], a[44:47], v[220:223]
  s_waitcnt lgkmcnt(8)
  v_mfma_f32_16x16x32_bf16 v[224:227], v[84:87], a[40:43], v[224:227]
  ds_read_b128 v[48:51], v11 offset:24576
  v_mfma_f32_16x16x32_bf16 v[228:231], v[84:87], a[44:47], v[228:231]
  s_waitcnt lgkmcnt(8)
  v_mfma_f32_16x16x32_bf16 v[232:235], v[88:91], a[40:43], v[232:235]
  ds_read_b128 v[52:55], v11 offset:25600
  v_mfma_f32_16x16x32_bf16 v[236:239], v[88:91], a[44:47], v[236:239]
  s_waitcnt lgkmcnt(8)
  v_mfma_f32_16x16x32_bf16 v[240:243], v[92:95], a[40:43], v[240:243]
  ds_read_b128 v[56:59], v11 offset:26624
  v_mfma_f32_16x16x32_bf16 v[244:247], v[92:95], a[44:47], v[244:247]
  s_waitcnt lgkmcnt(8)
  v_mfma_f32_16x16x32_bf16 v[176:179], v[24:27], a[48:51], v[176:179]
  ds_read_b128 v[60:63], v11 offset:27648
  v_mfma_f32_16x16x32_bf16 v[180:183], v[24:27], a[52:55], v[180:183]
  s_waitcnt lgkmcnt(8)
  v_mfma_f32_16x16x32_bf16 v[184:187], v[28:31], a[48:51], v[184:187]
  ds_read_b128 v[64:67], v11 offset:28672
  v_mfma_f32_16x16x32_bf16 v[188:191], v[28:31], a[52:55], v[188:191]
  s_waitcnt lgkmcnt(8)
  v_mfma_f32_16x16x32_bf16 v[192:195], v[32:35], a[48:51], v[192:195]
  ds_read_b128 v[68:71], v11 offset:29696
  v_mfma_f32_16x16x32_bf16 v[196:199], v[32:35], a[52:55], v[196:199]
  s_waitcnt lgkmcnt(8)
  v_mfma_f32_16x16x32_bf16 v[200:203], v[36:39], a[48:51], v[200:203]
  ds_read_b128 v[72:75], v11 offset:30720
  v_mfma_f32_16x16x32_bf16 v[204:207], v[36:39], a[52:55], v[204:207]
  s_waitcnt lgkmcnt(8)
  v_mfma_f32_16x16x32_bf16 v[208:211], v[40:43], a[48:51], v[208:211]
  ds_read_b128 v[76:79], v11 offset:31744
  v_mfma_f32_16x16x32_bf16 v[212:215], v[40:43], a[52:55], v[212:215]
  s_waitcnt lgkmcnt(8)
  v_mfma_f32_16x16x32_bf16 v[216:219], v[44:47], a[48:51], v[216:219]
  ds_read_b128 v[80:83], v11 offset:32768
  v_mfma_f32_16x16x32_bf16 v[220:223], v[44:47], a[52:55], v[220:223]
  s_waitcnt lgkmcnt(8)
  v_mfma_f32_16x16x32_bf16 v[224:227], v[48:51], a[48:51], v[224:227]
  ds_read_b128 v[84:87], v11 offset:33792
  v_mfma_f32_16x16x32_bf16 v[228:231], v[48:51], a[52:55], v[228:231]
  s_waitcnt lgkmcnt(8)
  v_mfma_f32_16x16x32_bf16 v[232:235], v[52:55], a[48:51], v[232:235]
  ds_read_b128 v[88:91], v11 offset:34816
  v_mfma_f32_16x16x32_bf16 v[236:239], v[52:55], a[52:55], v[236:239]
  s_waitcnt lgkmcnt(8)
  v_mfma_f32_16x16x32_bf16 v[240:243], v[56:59], a[48:51], v[240:243]
  ds_read_b128 v[92:95], v11 offset:35840
  v_mfma_f32_16x16x32_bf16 v[244:247], v[56:59], a[52:55], v[244:247]
  s_waitcnt vmcnt(9)
  s_barrier
  s_waitcnt lgkmcnt(8)
  v_mfma_f32_16x16x32_bf16 v[176:179], v[60:63], a[56:59], v[176:179]
  ds_read_b128 v[24:27], v12 offset:0
  v_mfma_f32_16x16x32_bf16 v[180:183], v[60:63], a[60:63], v[180:183]
  s_add_u32 m0, s47, 0
  s_nop 0
  buffer_load_dwordx4 v2, s[8:11], s40 offen sc1 lds
  s_waitcnt lgkmcnt(8)
  v_mfma_f32_16x16x32_bf16 v[184:187], v[64:67], a[56:59], v[184:187]
  ds_read_b128 v[28:31], v12 offset:1024
  v_mfma_f32_16x16x32_bf16 v[188:191], v[64:67], a[60:63], v[188:191]
  s_add_u32 m0, s47, 1024
  s_nop 0
  buffer_load_dwordx4 v3, s[8:11], s40 offen sc1 lds
  s_waitcnt lgkmcnt(8)
  v_mfma_f32_16x16x32_bf16 v[192:195], v[68:71], a[56:59], v[192:195]
  ds_read_b128 v[32:35], v12 offset:2048
  v_mfma_f32_16x16x32_bf16 v[196:199], v[68:71], a[60:63], v[196:199]
  s_add_u32 m0, s47, 2048
  s_nop 0
  buffer_load_dwordx4 v4, s[8:11], s40 offen sc1 lds
  s_waitcnt lgkmcnt(8)
  v_mfma_f32_16x16x32_bf16 v[200:203], v[72:75], a[56:59], v[200:203]
  ds_read_b128 v[36:39], v12 offset:3072
  v_mfma_f32_16x16x32_bf16 v[204:207], v[72:75], a[60:63], v[204:207]
  s_add_u32 m0, s47, 3072
  s_nop 0
  buffer_load_dwordx4 v5, s[8:11], s40 offen sc1 lds
  s_waitcnt lgkmcnt(8)
  v_mfma_f32_16x16x32_bf16 v[208:211], v[76:79], a[56:59], v[208:211]
  ds_read_b128 v[40:43], v12 offset:4096
  v_mfma_f32_16x16x32_bf16 v[212:215], v[76:79], a[60:63], v[212:215]
  s_add_u32 m0, s47, 4096
  s_nop 0
  buffer_load_dwordx4 v6, s[8:11], s40 offen sc1 lds
  s_waitcnt lgkmcnt(8)
  v_mfma_f32_16x16x32_bf16 v[216:219], v[80:83], a[56:59], v[216:219]
  ds_read_b128 v[44:47], v12 offset:5120
  v_mfma_f32_16x16x32_bf16 v[220:223], v[80:83], a[60:63], v[220:223]
  s_add_u32 m0, s47, 5120
  s_nop 0
  buffer_load_dwordx4 v7, s[8:11], s40 offen sc1 lds
  s_waitcnt lgkmcnt(8)
  v_mfma_f32_16x16x32_bf16 v[224:227], v[84:87], a[56:59], v[224:227]
  ds_read_b128 v[48:51], v12 offset:6144
  v_mfma_f32_16x16x32_bf16 v[228:231], v[84:87], a[60:63], v[228:231]
  s_add_u32 m0, s47, 6144
  s_nop 0
  buffer_load_dwordx4 v8, s[8:11], s40 offen sc1 lds
  s_waitcnt lgkmcnt(8)
  v_mfma_f32_16x16x32_bf16 v[232:235], v[88:91], a[56:59], v[232:235]
  ds_read_b128 v[52:55], v12 offset:7168
  v_mfma_f32_16x16x32_bf16 v[236:239], v[88:91], a[60:63], v[236:239]
  s_add_u32 m0, s47, 7168
  s_nop 0
  buffer_load_dwordx4 v9, s[8:11], s40 offen sc1 lds
  s_waitcnt lgkmcnt(8)
  v_mfma_f32_16x16x32_bf16 v[240:243], v[92:95], a[56:59], v[240:243]
  ds_read_b128 v[56:59], v12 offset:8192
  v_mfma_f32_16x16x32_bf16 v[244:247], v[92:95], a[60:63], v[244:247]
  s_add_u32 m0, s47, 8192
  s_nop 0
  buffer_load_dwordx4 v10, s[8:11], s40 offen sc1 lds
  s_add_u32 s40, s40, 4096
  s_waitcnt lgkmcnt(8)
  v_mfma_f32_16x16x32_bf16 v[176:179], v[24:27], a[64:67], v[176:179]
  ds_read_b128 v[60:63], v12 offset:9216
  v_mfma_f32_16x16x32_bf16 v[180:183], v[24:27], a[68:71], v[180:183]
  s_waitcnt lgkmcnt(8)
  v_mfma_f32_16x16x32_bf16 v[184:187], v[28:31], a[64:67], v[184:187]
  ds_read_b128 v[64:67], v12 offset:10240
  v_mfma_f32_16x16x32_bf16 v[188:191], v[28:31], a[68:71], v[188:191]
  s_waitcnt lgkmcnt(8)
  v_mfma_f32_16x16x32_bf16 v[192:195], v[32:35], a[64:67], v[192:195]
  ds_read_b128 v[68:71], v12 offset:11264
  v_mfma_f32_16x16x32_bf16 v[196:199], v[32:35], a[68:71], v[196:199]
  s_waitcnt lgkmcnt(8)
  v_mfma_f32_16x16x32_bf16 v[200:203], v[36:39], a[64:67], v[200:203]
  ds_read_b128 v[72:75], v12 offset:12288
  v_mfma_f32_16x16x32_bf16 v[204:207], v[36:39], a[68:71], v[204:207]
  s_waitcnt lgkmcnt(8)
  v_mfma_f32_16x16x32_bf16 v[208:211], v[40:43], a[64:67], v[208:211]
  ds_read_b128 v[76:79], v12 offset:13312
  v_mfma_f32_16x16x32_bf16 v[212:215], v[40:43], a[68:71], v[212:215]
  s_waitcnt lgkmcnt(8)
  v_mfma_f32_16x16x32_bf16 v[216:219], v[44:47], a[64:67], v[216:219]
  ds_read_b128 v[80:83], v12 offset:14336
  v_mfma_f32_16x16x32_bf16 v[220:223], v[44:47], a[68:71], v[220:223]
  s_waitcnt lgkmcnt(8)
  v_mfma_f32_16x16x32_bf16 v[224:227], v[48:51], a[64:67], v[224:227]
  ds_read_b128 v[84:87], v12 offset:15360
  v_mfma_f32_16x16x32_bf16 v[228:231], v[48:51], a[68:71], v[228:231]
  s_waitcnt lgkmcnt(8)
  v_mfma_f32_16x16x32_bf16 v[232:235], v[52:55], a[64:67], v[232:235]
  ds_read_b128 v[88:91], v12 offset:16384
  v_mfma_f32_16x16x32_bf16 v[236:239], v[52:55], a[68:71], v[236:239]
  s_waitcnt lgkmcnt(8)
  v_mfma_f32_16x16x32_bf16 v[240:243], v[56:59], a[64:67], v[240:243]
  ds_read_b128 v[92:95], v12 offset:17408
  v_mfma_f32_16x16x32_bf16 v[244:247], v[56:59], a[68:71], v[244:247]
  s_waitcnt lgkmcnt(8)
  v_mfma_f32_16x16x32_bf16 v[176:179], v[60:63], a[72:75], v[176:179]
  ds_read_b128 v[24:27], v12 offset:18432
  v_mfma_f32_16x16x32_bf16 v[180:183], v[60:63], a[76:79], v[180:183]
  s_waitcnt lgkmcnt(8)
  v_mfma_f32_16x16x32_bf16 v[184:187], v[64:67], a[72:75], v[184:187]
  ds_read_b128 v[28:31], v12 offset:19456
  v_mfma_f32_16x16x32_bf16 v[188:191], v[64:67], a[76:79], v[188:191]
  s_waitcnt lgkmcnt(8)
  v_mfma_f32_16x16x32_bf16 v[192:195], v[68:71], a[72:75], v[192:195]
  ds_read_b128 v[32:35], v12 offset:20480
  v_mfma_f32_16x16x32_bf16 v[196:199], v[68:71], a[76:79], v[196:199]
  s_waitcnt lgkmcnt(8)
  v_mfma_f32_16x16x32_bf16 v[200:203], v[72:75], a[72:75], v[200:203]
  ds_read_b128 v[36:39], v12 offset:21504
  v_mfma_f32_16x16x32_bf16 v[204:207], v[72:75], a[76:79], v[204:207]
  s_waitcnt lgkmcnt(8)
  v_mfma_f32_16x16x32_bf16 v[208:211], v[76:79], a[72:75], v[208:211]
  ds_read_b128 v[40:43], v12 offset:22528
  v_mfma_f32_16x16x32_bf16 v[212:215], v[76:79], a[76:79], v[212:215]
  s_waitcnt lgkmcnt(8)
  v_mfma_f32_16x16x32_bf16 v[216:219], v[80:83], a[72:75], v[216:219]
  ds_read_b128 v[44:47], v12 offset:23552
  v_mfma_f32_16x16x32_bf16 v[220:223], v[80:83], a[76:79], v[220:223]
  s_waitcnt lgkmcnt(8)
  v_mfma_f32_16x16x32_bf16 v[224:227], v[84:87], a[72:75], v[224:227]
  ds_read_b128 v[48:51], v12 offset:24576
  v_mfma_f32_16x16x32_bf16 v[228:231], v[84:87], a[76:79], v[228:231]
  s_waitcnt lgkmcnt(8)
  v_mfma_f32_16x16x32_bf16 v[232:235], v[88:91], a[72:75], v[232:235]
  ds_read_b128 v[52:55], v12 offset:25600
  v_mfma_f32_16x16x32_bf16 v[236:239], v[88:91], a[76:79], v[236:239]
  s_waitcnt lgkmcnt(8)
  v_mfma_f32_16x16x32_bf16 v[240:243], v[92:95], a[72:75], v[240:243]
  ds_read_b128 v[56:59], v12 offset:26624
  v_mfma_f32_16x16x32_bf16 v[244:247], v[92:95], a[76:79], v[244:247]
  s_waitcnt lgkmcnt(8)
  v_mfma_f32_16x16x32_bf16 v[176:179], v[24:27], a[80:83], v[176:179]
  ds_read_b128 v[60:63], v12 offset:27648
  v_mfma_f32_16x16x32_bf16 v[180:183], v[24:27], a[84:87], v[180:183]
  s_waitcnt lgkmcnt(8)
  v_mfma_f32_16x16x32_bf16 v[184:187], v[28:31], a[80:83], v[184:187]
  ds_read_b128 v[64:67], v12 offset:28672
  v_mfma_f32_16x16x32_bf16 v[188:191], v[28:31], a[84:87], v[188:191]
  s_waitcnt lgkmcnt(8)
  v_mfma_f32_16x16x32_bf16 v[192:195], v[32:35], a[80:83], v[192:195]
  ds_read_b128 v[68:71], v12 offset:29696
  v_mfma_f32_16x16x32_bf16 v[196:199], v[32:35], a[84:87], v[196:199]
  s_waitcnt lgkmcnt(8)
  v_mfma_f32_16x16x32_bf16 v[200:203], v[36:39], a[80:83], v[200:203]
  ds_read_b128 v[72:75], v12 offset:30720
  v_mfma_f32_16x16x32_bf16 v[204:207], v[36:39], a[84:87], v[204:207]
  s_waitcnt lgkmcnt(8)
  v_mfma_f32_16x16x32_bf16 v[208:211], v[40:43], a[80:83], v[208:211]
  ds_read_b128 v[76:79], v12 offset:31744
  v_mfma_f32_16x16x32_bf16 v[212:215], v[40:43], a[84:87], v[212:215]
  s_waitcnt lgkmcnt(8)
  v_mfma_f32_16x16x32_bf16 v[216:219], v[44:47], a[80:83], v[216:219]
  ds_read_b128 v[80:83], v12 offset:32768
  v_mfma_f32_16x16x32_bf16 v[220:223], v[44:47], a[84:87], v[220:223]
  s_waitcnt lgkmcnt(8)
  v_mfma_f32_16x16x32_bf16 v[224:227], v[48:51], a[80:83], v[224:227]
  ds_read_b128 v[84:87], v12 offset:33792
  v_mfma_f32_16x16x32_bf16 v[228:231], v[48:51], a[84:87], v[228:231]
  s_waitcnt lgkmcnt(8)
  v_mfma_f32_16x16x32_bf16 v[232:235], v[52:55], a[80:83], v[232:235]
  ds_read_b128 v[88:91], v12 offset:34816
  v_mfma_f32_16x16x32_bf16 v[236:239], v[52:55], a[84:87], v[236:239]
  s_waitcnt lgkmcnt(8)
  v_mfma_f32_16x16x32_bf16 v[240:243], v[56:59], a[80:83], v[240:243]
  ds_read_b128 v[92:95], v12 offset:35840
  v_mfma_f32_16x16x32_bf16 v[244:247], v[56:59], a[84:87], v[244:247]
  s_waitcnt vmcnt(9)
  s_barrier
  s_waitcnt lgkmcnt(8)
  v_mfma_f32_16x16x32_bf16 v[176:179], v[60:63], a[88:91], v[176:179]
  ds_read_b128 v[24:27], v13 offset:0
  v_mfma_f32_16x16x32_bf16 v[180:183], v[60:63], a[92:95], v[180:183]
  s_add_u32 m0, s47, 36864
  s_nop 0
  buffer_load_dwordx4 v2, s[8:11], s40 offen sc1 lds
  s_waitcnt lgkmcnt(8)
  v_mfma_f32_16x16x32_bf16 v[184:187], v[64:67], a[88:91], v[184:187]
  ds_read_b128 v[28:31], v13 offset:1024
  v_mfma_f32_16x16x32_bf16 v[188:191], v[64:67], a[92:95], v[188:191]
  s_add_u32 m0, s47, 37888
  s_nop 0
  buffer_load_dwordx4 v3, s[8:11], s40 offen sc1 lds
  s_waitcnt lgkmcnt(8)
  v_mfma_f32_16x16x32_bf16 v[192:195], v[68:71], a[88:91], v[192:195]
  ds_read_b128 v[32:35], v13 offset:2048
  v_mfma_f32_16x16x32_bf16 v[196:199], v[68:71], a[92:95], v[196:199]
  s_add_u32 m0, s47, 38912
  s_nop 0
  buffer_load_dwordx4 v4, s[8:11], s40 offen sc1 lds
  s_waitcnt lgkmcnt(8)
  v_mfma_f32_16x16x32_bf16 v[200:203], v[72:75], a[88:91], v[200:203]
  ds_read_b128 v[36:39], v13 offset:3072
  v_mfma_f32_16x16x32_bf16 v[204:207], v[72:75], a[92:95], v[204:207]
  s_add_u32 m0, s47, 39936
  s_nop 0
  buffer_load_dwordx4 v5, s[8:11], s40 offen sc1 lds
  s_waitcnt lgkmcnt(8)
  v_mfma_f32_16x16x32_bf16 v[208:211], v[76:79], a[88:91], v[208:211]
  ds_read_b128 v[40:43], v13 offset:4096
  v_mfma_f32_16x16x32_bf16 v[212:215], v[76:79], a[92:95], v[212:215]
  s_add_u32 m0, s47, 40960
  s_nop 0
  buffer_load_dwordx4 v6, s[8:11], s40 offen sc1 lds
  s_waitcnt lgkmcnt(8)
  v_mfma_f32_16x16x32_bf16 v[216:219], v[80:83], a[88:91], v[216:219]
  ds_read_b128 v[44:47], v13 offset:5120
  v_mfma_f32_16x16x32_bf16 v[220:223], v[80:83], a[92:95], v[220:223]
  s_add_u32 m0, s47, 41984
  s_nop 0
  buffer_load_dwordx4 v7, s[8:11], s40 offen sc1 lds
  s_waitcnt lgkmcnt(8)
  v_mfma_f32_16x16x32_bf16 v[224:227], v[84:87], a[88:91], v[224:227]
  ds_read_b128 v[48:51], v13 offset:6144
  v_mfma_f32_16x16x32_bf16 v[228:231], v[84:87], a[92:95], v[228:231]
  s_add_u32 m0, s47, 43008
  s_nop 0
  buffer_load_dwordx4 v8, s[8:11], s40 offen sc1 lds
  s_waitcnt lgkmcnt(8)
  v_mfma_f32_16x16x32_bf16 v[232:235], v[88:91], a[88:91], v[232:235]
  ds_read_b128 v[52:55], v13 offset:7168
  v_mfma_f32_16x16x32_bf16 v[236:239], v[88:91], a[92:95], v[236:239]
  s_add_u32 m0, s47, 44032
  s_nop 0
  buffer_load_dwordx4 v9, s[8:11], s40 offen sc1 lds
  s_waitcnt lgkmcnt(8)
  v_mfma_f32_16x16x32_bf16 v[240:243], v[92:95], a[88:91], v[240:243]
  ds_read_b128 v[56:59], v13 offset:8192
  v_mfma_f32_16x16x32_bf16 v[244:247], v[92:95], a[92:95], v[244:247]
  s_add_u32 m0, s47, 45056
  s_nop 0
  buffer_load_dwordx4 v10, s[8:11], s40 offen sc1 lds
  s_add_u32 s40, s40, 4096
  s_waitcnt lgkmcnt(8)
  v_mfma_f32_16x16x32_bf16 v[176:179], v[24:27], a[96:99], v[176:179]
  ds_read_b128 v[60:63], v13 offset:9216
  v_mfma_f32_16x16x32_bf16 v[180:183], v[24:27], a[100:103], v[180:183]
  s_waitcnt lgkmcnt(8)
  v_mfma_f32_16x16x32_bf16 v[184:187], v[28:31], a[96:99], v[184:187]
  ds_read_b128 v[64:67], v13 offset:10240
  v_mfma_f32_16x16x32_bf16 v[188:191], v[28:31], a[100:103], v[188:191]
  s_waitcnt lgkmcnt(8)
  v_mfma_f32_16x16x32_bf16 v[192:195], v[32:35], a[96:99], v[192:195]
  ds_read_b128 v[68:71], v13 offset:11264
  v_mfma_f32_16x16x32_bf16 v[196:199], v[32:35], a[100:103], v[196:199]
  s_waitcnt lgkmcnt(8)
  v_mfma_f32_16x16x32_bf16 v[200:203], v[36:39], a[96:99], v[200:203]
  ds_read_b128 v[72:75], v13 offset:12288
  v_mfma_f32_16x16x32_bf16 v[204:207], v[36:39], a[100:103], v[204:207]
  s_waitcnt lgkmcnt(8)
  v_mfma_f32_16x16x32_bf16 v[208:211], v[40:43], a[96:99], v[208:211]
  ds_read_b128 v[76:79], v13 offset:13312
  v_mfma_f32_16x16x32_bf16 v[212:215], v[40:43], a[100:103], v[212:215]
  s_waitcnt lgkmcnt(8)
  v_mfma_f32_16x16x32_bf16 v[216:219], v[44:47], a[96:99], v[216:219]
  ds_read_b128 v[80:83], v13 offset:14336
  v_mfma_f32_16x16x32_bf16 v[220:223], v[44:47], a[100:103], v[220:223]
  s_waitcnt lgkmcnt(8)
  v_mfma_f32_16x16x32_bf16 v[224:227], v[48:51], a[96:99], v[224:227]
  ds_read_b128 v[84:87], v13 offset:15360
  v_mfma_f32_16x16x32_bf16 v[228:231], v[48:51], a[100:103], v[228:231]
  s_waitcnt lgkmcnt(8)
  v_mfma_f32_16x16x32_bf16 v[232:235], v[52:55], a[96:99], v[232:235]
  ds_read_b128 v[88:91], v13 offset:16384
  v_mfma_f32_16x16x32_bf16 v[236:239], v[52:55], a[100:103], v[236:239]
  s_waitcnt lgkmcnt(8)
  v_mfma_f32_16x16x32_bf16 v[240:243], v[56:59], a[96:99], v[240:243]
  ds_read_b128 v[92:95], v13 offset:17408
  v_mfma_f32_16x16x32_bf16 v[244:247], v[56:59], a[100:103], v[244:247]
  s_waitcnt lgkmcnt(8)
  v_mfma_f32_16x16x32_bf16 v[176:179], v[60:63], a[104:107], v[176:179]
  ds_read_b128 v[24:27], v13 offset:18432
  v_mfma_f32_16x16x32_bf16 v[180:183], v[60:63], a[108:111], v[180:183]
  s_waitcnt lgkmcnt(8)
  v_mfma_f32_16x16x32_bf16 v[184:187], v[64:67], a[104:107], v[184:187]
  ds_read_b128 v[28:31], v13 offset:19456
  v_mfma_f32_16x16x32_bf16 v[188:191], v[64:67], a[108:111], v[188:191]
  s_waitcnt lgkmcnt(8)
  v_mfma_f32_16x16x32_bf16 v[192:195], v[68:71], a[104:107], v[192:195]
  ds_read_b128 v[32:35], v13 offset:20480
  v_mfma_f32_16x16x32_bf16 v[196:199], v[68:71], a[108:111], v[196:199]
  s_waitcnt lgkmcnt(8)
  v_mfma_f32_16x16x32_bf16 v[200:203], v[72:75], a[104:107], v[200:203]
  ds_read_b128 v[36:39], v13 offset:21504
  v_mfma_f32_16x16x32_bf16 v[204:207], v[72:75], a[108:111], v[204:207]
  s_waitcnt lgkmcnt(8)
  v_mfma_f32_16x16x32_bf16 v[208:211], v[76:79], a[104:107], v[208:211]
  ds_read_b128 v[40:43], v13 offset:22528
  v_mfma_f32_16x16x32_bf16 v[212:215], v[76:79], a[108:111], v[212:215]
  s_waitcnt lgkmcnt(8)
  v_mfma_f32_16x16x32_bf16 v[216:219], v[80:83], a[104:107], v[216:219]
  ds_read_b128 v[44:47], v13 offset:23552
  v_mfma_f32_16x16x32_bf16 v[220:223], v[80:83], a[108:111], v[220:223]
  s_waitcnt lgkmcnt(8)
  v_mfma_f32_16x16x32_bf16 v[224:227], v[84:87], a[104:107], v[224:227]
  ds_read_b128 v[48:51], v13 offset:24576
  v_mfma_f32_16x16x32_bf16 v[228:231], v[84:87], a[108:111], v[228:231]
  s_waitcnt lgkmcnt(8)
  v_mfma_f32_16x16x32_bf16 v[232:235], v[88:91], a[104:107], v[232:235]
  ds_read_b128 v[52:55], v13 offset:25600
  v_mfma_f32_16x16x32_bf16 v[236:239], v[88:91], a[108:111], v[236:239]
  s_waitcnt lgkmcnt(8)
  v_mfma_f32_16x16x32_bf16 v[240:243], v[92:95], a[104:107], v[240:243]
  ds_read_b128 v[56:59], v13 offset:26624
  v_mfma_f32_16x16x32_bf16 v[244:247], v[92:95], a[108:111], v[244:247]
  s_waitcnt lgkmcnt(8)
  v_mfma_f32_16x16x32_bf16 v[176:179], v[24:27], a[112:115], v[176:179]
  ds_read_b128 v[60:63], v13 offset:27648
  v_mfma_f32_16x16x32_bf16 v[180:183], v[24:27], a[116:119], v[180:183]
  s_waitcnt lgkmcnt(8)
  v_mfma_f32_16x16x32_bf16 v[184:187], v[28:31], a[112:115], v[184:187]
  ds_read_b128 v[64:67], v13 offset:28672
  v_mfma_f32_16x16x32_bf16 v[188:191], v[28:31], a[116:119], v[188:191]
  s_waitcnt lgkmcnt(8)
  v_mfma_f32_16x16x32_bf16 v[192:195], v[32:35], a[112:115], v[192:195]
  ds_read_b128 v[68:71], v13 offset:29696
  v_mfma_f32_16x16x32_bf16 v[196:199], v[32:35], a[116:119], v[196:199]
  s_waitcnt lgkmcnt(8)
  v_mfma_f32_16x16x32_bf16 v[200:203], v[36:39], a[112:115], v[200:203]
  ds_read_b128 v[72:75], v13 offset:30720
  v_mfma_f32_16x16x32_bf16 v[204:207], v[36:39], a[116:119], v[204:207]
  s_waitcnt lgkmcnt(8)
  v_mfma_f32_16x16x32_bf16 v[208:211], v[40:43], a[112:115], v[208:211]
  ds_read_b128 v[76:79], v13 offset:31744
  v_mfma_f32_16x16x32_bf16 v[212:215], v[40:43], a[116:119], v[212:215]
  s_waitcnt lgkmcnt(8)
  v_mfma_f32_16x16x32_bf16 v[216:219], v[44:47], a[112:115], v[216:219]
  ds_read_b128 v[80:83], v13 offset:32768
  v_mfma_f32_16x16x32_bf16 v[220:223], v[44:47], a[116:119], v[220:223]
  s_waitcnt lgkmcnt(8)
  v_mfma_f32_16x16x32_bf16 v[224:227], v[48:51], a[112:115], v[224:227]
  ds_read_b128 v[84:87], v13 offset:33792
  v_mfma_f32_16x16x32_bf16 v[228:231], v[48:51], a[116:119], v[228:231]
  s_waitcnt lgkmcnt(8)
  v_mfma_f32_16x16x32_bf16 v[232:235], v[52:55], a[112:115], v[232:235]
  ds_read_b128 v[88:91], v13 offset:34816
  v_mfma_f32_16x16x32_bf16 v[236:239], v[52:55], a[116:119], v[236:239]
  s_waitcnt lgkmcnt(8)
  v_mfma_f32_16x16x32_bf16 v[240:243], v[56:59], a[112:115], v[240:243]
  ds_read_b128 v[92:95], v13 offset:35840
  v_mfma_f32_16x16x32_bf16 v[244:247], v[56:59], a[116:119], v[244:247]
  s_waitcnt vmcnt(9)
  s_barrier
  s_waitcnt lgkmcnt(8)
  v_mfma_f32_16x16x32_bf16 v[176:179], v[60:63], a[120:123], v[176:179]
  ds_read_b128 v[24:27], v1 offset:0
  v_mfma_f32_16x16x32_bf16 v[180:183], v[60:63], a[124:127], v[180:183]
  s_add_u32 m0, s47, 73728
  s_nop 0
  buffer_load_dwordx4 v2, s[8:11], s40 offen sc1 lds
  s_waitcnt lgkmcnt(8)
  v_mfma_f32_16x16x32_bf16 v[184:187], v[64:67], a[120:123], v[184:187]
  ds_read_b128 v[28:31], v1 offset:1024
  v_mfma_f32_16x16x32_bf16 v[188:191], v[64:67], a[124:127], v[188:191]
  s_add_u32 m0, s47, 74752
  s_nop 0
  buffer_load_dwordx4 v3, s[8:11], s40 offen sc1 lds
  s_waitcnt lgkmcnt(8)
  v_mfma_f32_16x16x32_bf16 v[192:195], v[68:71], a[120:123], v[192:195]
  ds_read_b128 v[32:35], v1 offset:2048
  v_mfma_f32_16x16x32_bf16 v[196:199], v[68:71], a[124:127], v[196:199]
  s_add_u32 m0, s47, 75776
  s_nop 0
  buffer_load_dwordx4 v4, s[8:11], s40 offen sc1 lds
  s_waitcnt lgkmcnt(8)
  v_mfma_f32_16x16x32_bf16 v[200:203], v[72:75], a[120:123], v[200:203]
  ds_read_b128 v[36:39], v1 offset:3072
  v_mfma_f32_16x16x32_bf16 v[204:207], v[72:75], a[124:127], v[204:207]
  s_add_u32 m0, s47, 76800
  s_nop 0
  buffer_load_dwordx4 v5, s[8:11], s40 offen sc1 lds
  s_waitcnt lgkmcnt(8)
  v_mfma_f32_16x16x32_bf16 v[208:211], v[76:79], a[120:123], v[208:211]
  ds_read_b128 v[40:43], v1 offset:4096
  v_mfma_f32_16x16x32_bf16 v[212:215], v[76:79], a[124:127], v[212:215]
  s_add_u32 m0, s47, 77824
  s_nop 0
  buffer_load_dwordx4 v6, s[8:11], s40 offen sc1 lds
  s_waitcnt lgkmcnt(8)
  v_mfma_f32_16x16x32_bf16 v[216:219], v[80:83], a[120:123], v[216:219]
  ds_read_b128 v[44:47], v1 offset:5120
  v_mfma_f32_16x16x32_bf16 v[220:223], v[80:83], a[124:127], v[220:223]
  s_add_u32 m0, s47, 78848
  s_nop 0
  buffer_load_dwordx4 v7, s[8:11], s40 offen sc1 lds
  s_waitcnt lgkmcnt(8)
  v_mfma_f32_16x16x32_bf16 v[224:227], v[84:87], a[120:123], v[224:227]
  ds_read_b128 v[48:51], v1 offset:6144
  v_mfma_f32_16x16x32_bf16 v[228:231], v[84:87], a[124:127], v[228:231]
  s_add_u32 m0, s47, 79872
  s_nop 0
  buffer_load_dwordx4 v8, s[8:11], s40 offen sc1 lds
  s_waitcnt lgkmcnt(8)
  v_mfma_f32_16x16x32_bf16 v[232:235], v[88:91], a[120:123], v[232:235]
  ds_read_b128 v[52:55], v1 offset:7168
  v_mfma_f32_16x16x32_bf16 v[236:239], v[88:91], a[124:127], v[236:239]
  s_add_u32 m0, s47, 80896
  s_nop 0
  buffer_load_dwordx4 v9, s[8:11], s40 offen sc1 lds
  s_waitcnt lgkmcnt(8)
  v_mfma_f32_16x16x32_bf16 v[240:243], v[92:95], a[120:123], v[240:243]
  ds_read_b128 v[56:59], v1 offset:8192
  v_mfma_f32_16x16x32_bf16 v[244:247], v[92:95], a[124:127], v[244:247]
  s_add_u32 m0, s47, 81920
  s_nop 0
  buffer_load_dwordx4 v10, s[8:11], s40 offen sc1 lds
  s_add_u32 s40, s40, 4096
  s_waitcnt lgkmcnt(8)
  v_mfma_f32_16x16x32_bf16 v[176:179], v[24:27], a[128:131], v[176:179]
  ds_read_b128 v[60:63], v1 offset:9216
  v_mfma_f32_16x16x32_bf16 v[180:183], v[24:27], a[132:135], v[180:183]
  s_waitcnt lgkmcnt(8)
  v_mfma_f32_16x16x32_bf16 v[184:187], v[28:31], a[128:131], v[184:187]
  ds_read_b128 v[64:67], v1 offset:10240
  v_mfma_f32_16x16x32_bf16 v[188:191], v[28:31], a[132:135], v[188:191]
  s_waitcnt lgkmcnt(8)
  v_mfma_f32_16x16x32_bf16 v[192:195], v[32:35], a[128:131], v[192:195]
  ds_read_b128 v[68:71], v1 offset:11264
  v_mfma_f32_16x16x32_bf16 v[196:199], v[32:35], a[132:135], v[196:199]
  s_waitcnt lgkmcnt(8)
  v_mfma_f32_16x16x32_bf16 v[200:203], v[36:39], a[128:131], v[200:203]
  ds_read_b128 v[72:75], v1 offset:12288
  v_mfma_f32_16x16x32_bf16 v[204:207], v[36:39], a[132:135], v[204:207]
  s_waitcnt lgkmcnt(8)
  v_mfma_f32_16x16x32_bf16 v[208:211], v[40:43], a[128:131], v[208:211]
  ds_read_b128 v[76:79], v1 offset:13312
  v_mfma_f32_16x16x32_bf16 v[212:215], v[40:43], a[132:135], v[212:215]
  s_waitcnt lgkmcnt(8)
  v_mfma_f32_16x16x32_bf16 v[216:219], v[44:47], a[128:131], v[216:219]
  ds_read_b128 v[80:83], v1 offset:14336
  v_mfma_f32_16x16x32_bf16 v[220:223], v[44:47], a[132:135], v[220:223]
  s_waitcnt lgkmcnt(8)
  v_mfma_f32_16x16x32_bf16 v[224:227], v[48:51], a[128:131], v[224:227]
  ds_read_b128 v[84:87], v1 offset:15360
  v_mfma_f32_16x16x32_bf16 v[228:231], v[48:51], a[132:135], v[228:231]
  s_waitcnt lgkmcnt(8)
  v_mfma_f32_16x16x32_bf16 v[232:235], v[52:55], a[128:131], v[232:235]
  ds_read_b128 v[88:91], v1 offset:16384
  v_mfma_f32_16x16x32_bf16 v[236:239], v[52:55], a[132:135], v[236:239]
  s_waitcnt lgkmcnt(8)
  v_mfma_f32_16x16x32_bf16 v[240:243], v[56:59], a[128:131], v[240:243]
  ds_read_b128 v[92:95], v1 offset:17408
  v_mfma_f32_16x16x32_bf16 v[244:247], v[56:59], a[132:135], v[244:247]
  s_waitcnt lgkmcnt(8)
  v_mfma_f32_16x16x32_bf16 v[176:179], v[60:63], a[136:139], v[176:179]
  ds_read_b128 v[24:27], v1 offset:18432
  v_mfma_f32_16x16x32_bf16 v[180:183], v[60:63], a[140:143], v[180:183]
  s_waitcnt lgkmcnt(8)
  v_mfma_f32_16x16x32_bf16 v[184:187], v[64:67], a[136:139], v[184:187]
  ds_read_b128 v[28:31], v1 offset:19456
  v_mfma_f32_16x16x32_bf16 v[188:191], v[64:67], a[140:143], v[188:191]
  s_waitcnt lgkmcnt(8)
  v_mfma_f32_16x16x32_bf16 v[192:195], v[68:71], a[136:139], v[192:195]
  ds_read_b128 v[32:35], v1 offset:20480
  v_mfma_f32_16x16x32_bf16 v[196:199], v[68:71], a[140:143], v[196:199]
  s_waitcnt lgkmcnt(8)
  v_mfma_f32_16x16x32_bf16 v[200:203], v[72:75], a[136:139], v[200:203]
  ds_read_b128 v[36:39], v1 offset:21504
  v_mfma_f32_16x16x32_bf16 v[204:207], v[72:75], a[140:143], v[204:207]
  s_waitcnt lgkmcnt(8)
  v_mfma_f32_16x16x32_bf16 v[208:211], v[76:79], a[136:139], v[208:211]
  ds_read_b128 v[40:43], v1 offset:22528
  v_mfma_f32_16x16x32_bf16 v[212:215], v[76:79], a[140:143], v[212:215]
  s_waitcnt lgkmcnt(8)
  v_mfma_f32_16x16x32_bf16 v[216:219], v[80:83], a[136:139], v[216:219]
  ds_read_b128 v[44:47], v1 offset:23552
  v_mfma_f32_16x16x32_bf16 v[220:223], v[80:83], a[140:143], v[220:223]
  s_waitcnt lgkmcnt(8)
  v_mfma_f32_16x16x32_bf16 v[224:227], v[84:87], a[136:139], v[224:227]
  ds_read_b128 v[48:51], v1 offset:24576
  v_mfma_f32_16x16x32_bf16 v[228:231], v[84:87], a[140:143], v[228:231]
  s_waitcnt lgkmcnt(8)
  v_mfma_f32_16x16x32_bf16 v[232:235], v[88:91], a[136:139], v[232:235]
  ds_read_b128 v[52:55], v1 offset:25600
  v_mfma_f32_16x16x32_bf16 v[236:239], v[88:91], a[140:143], v[236:239]
  s_waitcnt lgkmcnt(8)
  v_mfma_f32_16x16x32_bf16 v[240:243], v[92:95], a[136:139], v[240:243]
  ds_read_b128 v[56:59], v1 offset:26624
  v_mfma_f32_16x16x32_bf16 v[244:247], v[92:95], a[140:143], v[244:247]
  s_waitcnt lgkmcnt(8)
  v_mfma_f32_16x16x32_bf16 v[176:179], v[24:27], a[144:147], v[176:179]
  ds_read_b128 v[60:63], v1 offset:27648
  v_mfma_f32_16x16x32_bf16 v[180:183], v[24:27], a[148:151], v[180:183]
  s_waitcnt lgkmcnt(8)
  v_mfma_f32_16x16x32_bf16 v[184:187], v[28:31], a[144:147], v[184:187]
  ds_read_b128 v[64:67], v1 offset:28672
  v_mfma_f32_16x16x32_bf16 v[188:191], v[28:31], a[148:151], v[188:191]
  s_waitcnt lgkmcnt(8)
  v_mfma_f32_16x16x32_bf16 v[192:195], v[32:35], a[144:147], v[192:195]
  ds_read_b128 v[68:71], v1 offset:29696
  v_mfma_f32_16x16x32_bf16 v[196:199], v[32:35], a[148:151], v[196:199]
  s_waitcnt lgkmcnt(8)
  v_mfma_f32_16x16x32_bf16 v[200:203], v[36:39], a[144:147], v[200:203]
  ds_read_b128 v[72:75], v1 offset:30720
  v_mfma_f32_16x16x32_bf16 v[204:207], v[36:39], a[148:151], v[204:207]
  s_waitcnt lgkmcnt(8)
  v_mfma_f32_16x16x32_bf16 v[208:211], v[40:43], a[144:147], v[208:211]
  ds_read_b128 v[76:79], v1 offset:31744
  v_mfma_f32_16x16x32_bf16 v[212:215], v[40:43], a[148:151], v[212:215]
  s_waitcnt lgkmcnt(8)
  v_mfma_f32_16x16x32_bf16 v[216:219], v[44:47], a[144:147], v[216:219]
  ds_read_b128 v[80:83], v1 offset:32768
  v_mfma_f32_16x16x32_bf16 v[220:223], v[44:47], a[148:151], v[220:223]
  s_waitcnt lgkmcnt(8)
  v_mfma_f32_16x16x32_bf16 v[224:227], v[48:51], a[144:147], v[224:227]
  ds_read_b128 v[84:87], v1 offset:33792
  v_mfma_f32_16x16x32_bf16 v[228:231], v[48:51], a[148:151], v[228:231]
  s_waitcnt lgkmcnt(8)
  v_mfma_f32_16x16x32_bf16 v[232:235], v[52:55], a[144:147], v[232:235]
  ds_read_b128 v[88:91], v1 offset:34816
  v_mfma_f32_16x16x32_bf16 v[236:239], v[52:55], a[148:151], v[236:239]
  s_waitcnt lgkmcnt(8)
  v_mfma_f32_16x16x32_bf16 v[240:243], v[56:59], a[144:147], v[240:243]
  ds_read_b128 v[92:95], v1 offset:35840
  v_mfma_f32_16x16x32_bf16 v[244:247], v[56:59], a[148:151], v[244:247]
  s_waitcnt vmcnt(9)
  s_barrier
  s_waitcnt lgkmcnt(8)
  v_mfma_f32_16x16x32_bf16 v[176:179], v[60:63], a[152:155], v[176:179]
  ds_read_b128 v[24:27], v11 offset:0
  v_mfma_f32_16x16x32_bf16 v[180:183], v[60:63], a[156:159], v[180:183]
  s_add_u32 m0, s47, 110592
  s_nop 0
  buffer_load_dwordx4 v2, s[8:11], s40 offen sc1 lds
  s_waitcnt lgkmcnt(8)
  v_mfma_f32_16x16x32_bf16 v[184:187], v[64:67], a[152:155], v[184:187]
  ds_read_b128 v[28:31], v11 offset:1024
  v_mfma_f32_16x16x32_bf16 v[188:191], v[64:67], a[156:159], v[188:191]
  s_add_u32 m0, s47, 111616
  s_nop 0
  buffer_load_dwordx4 v3, s[8:11], s40 offen sc1 lds
  s_waitcnt lgkmcnt(8)
  v_mfma_f32_16x16x32_bf16 v[192:195], v[68:71], a[152:155], v[192:195]
  ds_read_b128 v[32:35], v11 offset:2048
  v_mfma_f32_16x16x32_bf16 v[196:199], v[68:71], a[156:159], v[196:199]
  s_add_u32 m0, s47, 112640
  s_nop 0
  buffer_load_dwordx4 v4, s[8:11], s40 offen sc1 lds
  s_waitcnt lgkmcnt(8)
  v_mfma_f32_16x16x32_bf16 v[200:203], v[72:75], a[152:155], v[200:203]
  ds_read_b128 v[36:39], v11 offset:3072
  v_mfma_f32_16x16x32_bf16 v[204:207], v[72:75], a[156:159], v[204:207]
  s_add_u32 m0, s47, 113664
  s_nop 0
  buffer_load_dwordx4 v5, s[8:11], s40 offen sc1 lds
  s_waitcnt lgkmcnt(8)
  v_mfma_f32_16x16x32_bf16 v[208:211], v[76:79], a[152:155], v[208:211]
  ds_read_b128 v[40:43], v11 offset:4096
  v_mfma_f32_16x16x32_bf16 v[212:215], v[76:79], a[156:159], v[212:215]
  s_add_u32 m0, s47, 114688
  s_nop 0
  buffer_load_dwordx4 v6, s[8:11], s40 offen sc1 lds
  s_waitcnt lgkmcnt(8)
  v_mfma_f32_16x16x32_bf16 v[216:219], v[80:83], a[152:155], v[216:219]
  ds_read_b128 v[44:47], v11 offset:5120
  v_mfma_f32_16x16x32_bf16 v[220:223], v[80:83], a[156:159], v[220:223]
  s_add_u32 m0, s47, 115712
  s_nop 0
  buffer_load_dwordx4 v7, s[8:11], s40 offen sc1 lds
  s_waitcnt lgkmcnt(8)
  v_mfma_f32_16x16x32_bf16 v[224:227], v[84:87], a[152:155], v[224:227]
  ds_read_b128 v[48:51], v11 offset:6144
  v_mfma_f32_16x16x32_bf16 v[228:231], v[84:87], a[156:159], v[228:231]
  s_add_u32 m0, s47, 116736
  s_nop 0
  buffer_load_dwordx4 v8, s[8:11], s40 offen sc1 lds
  s_waitcnt lgkmcnt(8)
  v_mfma_f32_16x16x32_bf16 v[232:235], v[88:91], a[152:155], v[232:235]
  ds_read_b128 v[52:55], v11 offset:7168
  v_mfma_f32_16x16x32_bf16 v[236:239], v[88:91], a[156:159], v[236:239]
  s_add_u32 m0, s47, 117760
  s_nop 0
  buffer_load_dwordx4 v9, s[8:11], s40 offen sc1 lds
  s_waitcnt lgkmcnt(8)
  v_mfma_f32_16x16x32_bf16 v[240:243], v[92:95], a[152:155], v[240:243]
  ds_read_b128 v[56:59], v11 offset:8192
  v_mfma_f32_16x16x32_bf16 v[244:247], v[92:95], a[156:159], v[244:247]
  s_add_u32 m0, s47, 118784
  s_nop 0
  buffer_load_dwordx4 v10, s[8:11], s40 offen sc1 lds
  s_add_u32 s40, s40, 4096
  s_waitcnt lgkmcnt(8)
  v_mfma_f32_16x16x32_bf16 v[176:179], v[24:27], a[160:163], v[176:179]
  ds_read_b128 v[60:63], v11 offset:9216
  v_mfma_f32_16x16x32_bf16 v[180:183], v[24:27], a[164:167], v[180:183]
  s_waitcnt lgkmcnt(8)
  v_mfma_f32_16x16x32_bf16 v[184:187], v[28:31], a[160:163], v[184:187]
  ds_read_b128 v[64:67], v11 offset:10240
  v_mfma_f32_16x16x32_bf16 v[188:191], v[28:31], a[164:167], v[188:191]
  s_waitcnt lgkmcnt(8)
  v_mfma_f32_16x16x32_bf16 v[192:195], v[32:35], a[160:163], v[192:195]
  ds_read_b128 v[68:71], v11 offset:11264
  v_mfma_f32_16x16x32_bf16 v[196:199], v[32:35], a[164:167], v[196:199]
  s_waitcnt lgkmcnt(8)
  v_mfma_f32_16x16x32_bf16 v[200:203], v[36:39], a[160:163], v[200:203]
  ds_read_b128 v[72:75], v11 offset:12288
  v_mfma_f32_16x16x32_bf16 v[204:207], v[36:39], a[164:167], v[204:207]
  s_waitcnt lgkmcnt(8)
  v_mfma_f32_16x16x32_bf16 v[208:211], v[40:43], a[160:163], v[208:211]
  ds_read_b128 v[76:79], v11 offset:13312
  v_mfma_f32_16x16x32_bf16 v[212:215], v[40:43], a[164:167], v[212:215]
  s_waitcnt lgkmcnt(8)
  v_mfma_f32_16x16x32_bf16 v[216:219], v[44:47], a[160:163], v[216:219]
  ds_read_b128 v[80:83], v11 offset:14336
  v_mfma_f32_16x16x32_bf16 v[220:223], v[44:47], a[164:167], v[220:223]
  s_waitcnt lgkmcnt(8)
  v_mfma_f32_16x16x32_bf16 v[224:227], v[48:51], a[160:163], v[224:227]
  ds_read_b128 v[84:87], v11 offset:15360
  v_mfma_f32_16x16x32_bf16 v[228:231], v[48:51], a[164:167], v[228:231]
  s_waitcnt lgkmcnt(8)
  v_mfma_f32_16x16x32_bf16 v[232:235], v[52:55], a[160:163], v[232:235]
  ds_read_b128 v[88:91], v11 offset:16384
  v_mfma_f32_16x16x32_bf16 v[236:239], v[52:55], a[164:167], v[236:239]
  s_waitcnt lgkmcnt(8)
  v_mfma_f32_16x16x32_bf16 v[240:243], v[56:59], a[160:163], v[240:243]
  ds_read_b128 v[92:95], v11 offset:17408
  v_mfma_f32_16x16x32_bf16 v[244:247], v[56:59], a[164:167], v[244:247]
  s_waitcnt lgkmcnt(8)
  v_mfma_f32_16x16x32_bf16 v[176:179], v[60:63], a[168:171], v[176:179]
  ds_read_b128 v[24:27], v11 offset:18432
  v_mfma_f32_16x16x32_bf16 v[180:183], v[60:63], a[172:175], v[180:183]
  s_waitcnt lgkmcnt(8)
  v_mfma_f32_16x16x32_bf16 v[184:187], v[64:67], a[168:171], v[184:187]
  ds_read_b128 v[28:31], v11 offset:19456
  v_mfma_f32_16x16x32_bf16 v[188:191], v[64:67], a[172:175], v[188:191]
  s_waitcnt lgkmcnt(8)
  v_mfma_f32_16x16x32_bf16 v[192:195], v[68:71], a[168:171], v[192:195]
  ds_read_b128 v[32:35], v11 offset:20480
  v_mfma_f32_16x16x32_bf16 v[196:199], v[68:71], a[172:175], v[196:199]
  s_waitcnt lgkmcnt(8)
  v_mfma_f32_16x16x32_bf16 v[200:203], v[72:75], a[168:171], v[200:203]
  ds_read_b128 v[36:39], v11 offset:21504
  v_mfma_f32_16x16x32_bf16 v[204:207], v[72:75], a[172:175], v[204:207]
  s_waitcnt lgkmcnt(8)
  v_mfma_f32_16x16x32_bf16 v[208:211], v[76:79], a[168:171], v[208:211]
  ds_read_b128 v[40:43], v11 offset:22528
  v_mfma_f32_16x16x32_bf16 v[212:215], v[76:79], a[172:175], v[212:215]
  s_waitcnt lgkmcnt(8)
  v_mfma_f32_16x16x32_bf16 v[216:219], v[80:83], a[168:171], v[216:219]
  ds_read_b128 v[44:47], v11 offset:23552
  v_mfma_f32_16x16x32_bf16 v[220:223], v[80:83], a[172:175], v[220:223]
  s_waitcnt lgkmcnt(8)
  v_mfma_f32_16x16x32_bf16 v[224:227], v[84:87], a[168:171], v[224:227]
  ds_read_b128 v[48:51], v11 offset:24576
  v_mfma_f32_16x16x32_bf16 v[228:231], v[84:87], a[172:175], v[228:231]
  s_waitcnt lgkmcnt(8)
  v_mfma_f32_16x16x32_bf16 v[232:235], v[88:91], a[168:171], v[232:235]
  ds_read_b128 v[52:55], v11 offset:25600
  v_mfma_f32_16x16x32_bf16 v[236:239], v[88:91], a[172:175], v[236:239]
  s_waitcnt lgkmcnt(8)
  v_mfma_f32_16x16x32_bf16 v[240:243], v[92:95], a[168:171], v[240:243]
  ds_read_b128 v[56:59], v11 offset:26624
  v_mfma_f32_16x16x32_bf16 v[244:247], v[92:95], a[172:175], v[244:247]
  s_waitcnt lgkmcnt(8)
  v_mfma_f32_16x16x32_bf16 v[176:179], v[24:27], a[176:179], v[176:179]
  ds_read_b128 v[60:63], v11 offset:27648
  v_mfma_f32_16x16x32_bf16 v[180:183], v[24:27], a[180:183], v[180:183]
  s_waitcnt lgkmcnt(8)
  v_mfma_f32_16x16x32_bf16 v[184:187], v[28:31], a[176:179], v[184:187]
  ds_read_b128 v[64:67], v11 offset:28672
  v_mfma_f32_16x16x32_bf16 v[188:191], v[28:31], a[180:183], v[188:191]
  s_waitcnt lgkmcnt(8)
  v_mfma_f32_16x16x32_bf16 v[192:195], v[32:35], a[176:179], v[192:195]
  ds_read_b128 v[68:71], v11 offset:29696
  v_mfma_f32_16x16x32_bf16 v[196:199], v[32:35], a[180:183], v[196:199]
  s_waitcnt lgkmcnt(8)
  v_mfma_f32_16x16x32_bf16 v[200:203], v[36:39], a[176:179], v[200:203]
  ds_read_b128 v[72:75], v11 offset:30720
  v_mfma_f32_16x16x32_bf16 v[204:207], v[36:39], a[180:183], v[204:207]
  s_waitcnt lgkmcnt(8)
  v_mfma_f32_16x16x32_bf16 v[208:211], v[40:43], a[176:179], v[208:211]
  ds_read_b128 v[76:79], v11 offset:31744
  v_mfma_f32_16x16x32_bf16 v[212:215], v[40:43], a[180:183], v[212:215]
  s_waitcnt lgkmcnt(8)
  v_mfma_f32_16x16x32_bf16 v[216:219], v[44:47], a[176:179], v[216:219]
  ds_read_b128 v[80:83], v11 offset:32768
  v_mfma_f32_16x16x32_bf16 v[220:223], v[44:47], a[180:183], v[220:223]
  s_waitcnt lgkmcnt(8)
  v_mfma_f32_16x16x32_bf16 v[224:227], v[48:51], a[176:179], v[224:227]
  ds_read_b128 v[84:87], v11 offset:33792
  v_mfma_f32_16x16x32_bf16 v[228:231], v[48:51], a[180:183], v[228:231]
  s_waitcnt lgkmcnt(8)
  v_mfma_f32_16x16x32_bf16 v[232:235], v[52:55], a[176:179], v[232:235]
  ds_read_b128 v[88:91], v11 offset:34816
  v_mfma_f32_16x16x32_bf16 v[236:239], v[52:55], a[180:183], v[236:239]
  s_waitcnt lgkmcnt(8)
  v_mfma_f32_16x16x32_bf16 v[240:243], v[56:59], a[176:179], v[240:243]
  ds_read_b128 v[92:95], v11 offset:35840
  v_mfma_f32_16x16x32_bf16 v[244:247], v[56:59], a[180:183], v[244:247]
  s_waitcnt vmcnt(9)
  s_barrier
  s_waitcnt lgkmcnt(8)
  v_mfma_f32_16x16x32_bf16 v[176:179], v[60:63], a[184:187], v[176:179]
  ds_read_b128 v[24:27], v12 offset:0
  v_mfma_f32_16x16x32_bf16 v[180:183], v[60:63], a[188:191], v[180:183]
  s_add_u32 m0, s47, 0
  s_nop 0
  buffer_load_dwordx4 v2, s[8:11], s40 offen sc1 lds
  s_waitcnt lgkmcnt(8)
  v_mfma_f32_16x16x32_bf16 v[184:187], v[64:67], a[184:187], v[184:187]
  ds_read_b128 v[28:31], v12 offset:1024
  v_mfma_f32_16x16x32_bf16 v[188:191], v[64:67], a[188:191], v[188:191]
  s_add_u32 m0, s47, 1024
  s_nop 0
  buffer_load_dwordx4 v3, s[8:11], s40 offen sc1 lds
  s_waitcnt lgkmcnt(8)
  v_mfma_f32_16x16x32_bf16 v[192:195], v[68:71], a[184:187], v[192:195]
  ds_read_b128 v[32:35], v12 offset:2048
  v_mfma_f32_16x16x32_bf16 v[196:199], v[68:71], a[188:191], v[196:199]
  s_add_u32 m0, s47, 2048
  s_nop 0
  buffer_load_dwordx4 v4, s[8:11], s40 offen sc1 lds
  s_waitcnt lgkmcnt(8)
  v_mfma_f32_16x16x32_bf16 v[200:203], v[72:75], a[184:187], v[200:203]
  ds_read_b128 v[36:39], v12 offset:3072
  v_mfma_f32_16x16x32_bf16 v[204:207], v[72:75], a[188:191], v[204:207]
  s_add_u32 m0, s47, 3072
  s_nop 0
  buffer_load_dwordx4 v5, s[8:11], s40 offen sc1 lds
  s_waitcnt lgkmcnt(8)
  v_mfma_f32_16x16x32_bf16 v[208:211], v[76:79], a[184:187], v[208:211]
  ds_read_b128 v[40:43], v12 offset:4096
  v_mfma_f32_16x16x32_bf16 v[212:215], v[76:79], a[188:191], v[212:215]
  s_add_u32 m0, s47, 4096
  s_nop 0
  buffer_load_dwordx4 v6, s[8:11], s40 offen sc1 lds
  s_waitcnt lgkmcnt(8)
  v_mfma_f32_16x16x32_bf16 v[216:219], v[80:83], a[184:187], v[216:219]
  ds_read_b128 v[44:47], v12 offset:5120
  v_mfma_f32_16x16x32_bf16 v[220:223], v[80:83], a[188:191], v[220:223]
  s_add_u32 m0, s47, 5120
  s_nop 0
  buffer_load_dwordx4 v7, s[8:11], s40 offen sc1 lds
  s_waitcnt lgkmcnt(8)
  v_mfma_f32_16x16x32_bf16 v[224:227], v[84:87], a[184:187], v[224:227]
  ds_read_b128 v[48:51], v12 offset:6144
  v_mfma_f32_16x16x32_bf16 v[228:231], v[84:87], a[188:191], v[228:231]
  s_add_u32 m0, s47, 6144
  s_nop 0
  buffer_load_dwordx4 v8, s[8:11], s40 offen sc1 lds
  s_waitcnt lgkmcnt(8)
  v_mfma_f32_16x16x32_bf16 v[232:235], v[88:91], a[184:187], v[232:235]
  ds_read_b128 v[52:55], v12 offset:7168
  v_mfma_f32_16x16x32_bf16 v[236:239], v[88:91], a[188:191], v[236:239]
  s_add_u32 m0, s47, 7168
  s_nop 0
  buffer_load_dwordx4 v9, s[8:11], s40 offen sc1 lds
  s_waitcnt lgkmcnt(8)
  v_mfma_f32_16x16x32_bf16 v[240:243], v[92:95], a[184:187], v[240:243]
  ds_read_b128 v[56:59], v12 offset:8192
  v_mfma_f32_16x16x32_bf16 v[244:247], v[92:95], a[188:191], v[244:247]
  s_add_u32 m0, s47, 8192
  s_nop 0
  buffer_load_dwordx4 v10, s[8:11], s40 offen sc1 lds
  s_add_u32 s40, s40, 4096
  s_waitcnt lgkmcnt(8)
  v_mfma_f32_16x16x32_bf16 v[176:179], v[24:27], a[240:243], v[176:179]
  ds_read_b128 v[60:63], v12 offset:9216
  v_mfma_f32_16x16x32_bf16 v[180:183], v[24:27], a[244:247], v[180:183]
  s_waitcnt lgkmcnt(8)
  v_mfma_f32_16x16x32_bf16 v[184:187], v[28:31], a[240:243], v[184:187]
  ds_read_b128 v[64:67], v12 offset:10240
  v_mfma_f32_16x16x32_bf16 v[188:191], v[28:31], a[244:247], v[188:191]
  s_waitcnt lgkmcnt(8)
  v_mfma_f32_16x16x32_bf16 v[192:195], v[32:35], a[240:243], v[192:195]
  ds_read_b128 v[68:71], v12 offset:11264
  v_mfma_f32_16x16x32_bf16 v[196:199], v[32:35], a[244:247], v[196:199]
  s_waitcnt lgkmcnt(8)
  v_mfma_f32_16x16x32_bf16 v[200:203], v[36:39], a[240:243], v[200:203]
  ds_read_b128 v[72:75], v12 offset:12288
  v_mfma_f32_16x16x32_bf16 v[204:207], v[36:39], a[244:247], v[204:207]
  s_waitcnt lgkmcnt(8)
  v_mfma_f32_16x16x32_bf16 v[208:211], v[40:43], a[240:243], v[208:211]
  ds_read_b128 v[76:79], v12 offset:13312
  v_mfma_f32_16x16x32_bf16 v[212:215], v[40:43], a[244:247], v[212:215]
  s_waitcnt lgkmcnt(8)
  v_mfma_f32_16x16x32_bf16 v[216:219], v[44:47], a[240:243], v[216:219]
  ds_read_b128 v[80:83], v12 offset:14336
  v_mfma_f32_16x16x32_bf16 v[220:223], v[44:47], a[244:247], v[220:223]
  s_waitcnt lgkmcnt(8)
  v_mfma_f32_16x16x32_bf16 v[224:227], v[48:51], a[240:243], v[224:227]
  ds_read_b128 v[84:87], v12 offset:15360
  v_mfma_f32_16x16x32_bf16 v[228:231], v[48:51], a[244:247], v[228:231]
  s_waitcnt lgkmcnt(8)
  v_mfma_f32_16x16x32_bf16 v[232:235], v[52:55], a[240:243], v[232:235]
  ds_read_b128 v[88:91], v12 offset:16384
  v_mfma_f32_16x16x32_bf16 v[236:239], v[52:55], a[244:247], v[236:239]
  s_waitcnt lgkmcnt(8)
  v_mfma_f32_16x16x32_bf16 v[240:243], v[56:59], a[240:243], v[240:243]
  ds_read_b128 v[92:95], v12 offset:17408
  v_mfma_f32_16x16x32_bf16 v[244:247], v[56:59], a[244:247], v[244:247]
  s_waitcnt lgkmcnt(8)
  v_mfma_f32_16x16x32_bf16 v[176:179], v[60:63], a[248:251], v[176:179]
  ds_read_b128 v[24:27], v12 offset:18432
  v_mfma_f32_16x16x32_bf16 v[180:183], v[60:63], a[252:255], v[180:183]
  s_waitcnt lgkmcnt(8)
  v_mfma_f32_16x16x32_bf16 v[184:187], v[64:67], a[248:251], v[184:187]
  ds_read_b128 v[28:31], v12 offset:19456
  v_mfma_f32_16x16x32_bf16 v[188:191], v[64:67], a[252:255], v[188:191]
  s_waitcnt lgkmcnt(8)
  v_mfma_f32_16x16x32_bf16 v[192:195], v[68:71], a[248:251], v[192:195]
  ds_read_b128 v[32:35], v12 offset:20480
  v_mfma_f32_16x16x32_bf16 v[196:199], v[68:71], a[252:255], v[196:199]
  s_waitcnt lgkmcnt(8)
  v_mfma_f32_16x16x32_bf16 v[200:203], v[72:75], a[248:251], v[200:203]
  ds_read_b128 v[36:39], v12 offset:21504
  v_mfma_f32_16x16x32_bf16 v[204:207], v[72:75], a[252:255], v[204:207]
  s_waitcnt lgkmcnt(8)
  v_mfma_f32_16x16x32_bf16 v[208:211], v[76:79], a[248:251], v[208:211]
  ds_read_b128 v[40:43], v12 offset:22528
  v_mfma_f32_16x16x32_bf16 v[212:215], v[76:79], a[252:255], v[212:215]
  s_waitcnt lgkmcnt(8)
  v_mfma_f32_16x16x32_bf16 v[216:219], v[80:83], a[248:251], v[216:219]
  ds_read_b128 v[44:47], v12 offset:23552
  v_mfma_f32_16x16x32_bf16 v[220:223], v[80:83], a[252:255], v[220:223]
  s_waitcnt lgkmcnt(8)
  v_mfma_f32_16x16x32_bf16 v[224:227], v[84:87], a[248:251], v[224:227]
  ds_read_b128 v[48:51], v12 offset:24576
  v_mfma_f32_16x16x32_bf16 v[228:231], v[84:87], a[252:255], v[228:231]
  s_waitcnt lgkmcnt(8)
  v_mfma_f32_16x16x32_bf16 v[232:235], v[88:91], a[248:251], v[232:235]
  ds_read_b128 v[52:55], v12 offset:25600
  v_mfma_f32_16x16x32_bf16 v[236:239], v[88:91], a[252:255], v[236:239]
  s_waitcnt lgkmcnt(8)
  v_mfma_f32_16x16x32_bf16 v[240:243], v[92:95], a[248:251], v[240:243]
  ds_read_b128 v[56:59], v12 offset:26624
  v_mfma_f32_16x16x32_bf16 v[244:247], v[92:95], a[252:255], v[244:247]
  s_waitcnt lgkmcnt(8)
  v_mfma_f32_16x16x32_bf16 v[176:179], v[24:27], v[96:99], v[176:179]
  ds_read_b128 v[60:63], v12 offset:27648
  v_mfma_f32_16x16x32_bf16 v[180:183], v[24:27], v[100:103], v[180:183]
  s_waitcnt lgkmcnt(8)
  v_mfma_f32_16x16x32_bf16 v[184:187], v[28:31], v[96:99], v[184:187]
  ds_read_b128 v[64:67], v12 offset:28672
  v_mfma_f32_16x16x32_bf16 v[188:191], v[28:31], v[100:103], v[188:191]
  s_waitcnt lgkmcnt(8)
  v_mfma_f32_16x16x32_bf16 v[192:195], v[32:35], v[96:99], v[192:195]
  ds_read_b128 v[68:71], v12 offset:29696
  v_mfma_f32_16x16x32_bf16 v[196:199], v[32:35], v[100:103], v[196:199]
  s_waitcnt lgkmcnt(8)
  v_mfma_f32_16x16x32_bf16 v[200:203], v[36:39], v[96:99], v[200:203]
  ds_read_b128 v[72:75], v12 offset:30720
  v_mfma_f32_16x16x32_bf16 v[204:207], v[36:39], v[100:103], v[204:207]
  s_waitcnt lgkmcnt(8)
  v_mfma_f32_16x16x32_bf16 v[208:211], v[40:43], v[96:99], v[208:211]
  ds_read_b128 v[76:79], v12 offset:31744
  v_mfma_f32_16x16x32_bf16 v[212:215], v[40:43], v[100:103], v[212:215]
  s_waitcnt lgkmcnt(8)
  v_mfma_f32_16x16x32_bf16 v[216:219], v[44:47], v[96:99], v[216:219]
  ds_read_b128 v[80:83], v12 offset:32768
  v_mfma_f32_16x16x32_bf16 v[220:223], v[44:47], v[100:103], v[220:223]
  s_waitcnt lgkmcnt(8)
  v_mfma_f32_16x16x32_bf16 v[224:227], v[48:51], v[96:99], v[224:227]
  ds_read_b128 v[84:87], v12 offset:33792
  v_mfma_f32_16x16x32_bf16 v[228:231], v[48:51], v[100:103], v[228:231]
  s_waitcnt lgkmcnt(8)
  v_mfma_f32_16x16x32_bf16 v[232:235], v[52:55], v[96:99], v[232:235]
  ds_read_b128 v[88:91], v12 offset:34816
  v_mfma_f32_16x16x32_bf16 v[236:239], v[52:55], v[100:103], v[236:239]
  s_waitcnt lgkmcnt(8)
  v_mfma_f32_16x16x32_bf16 v[240:243], v[56:59], v[96:99], v[240:243]
  ds_read_b128 v[92:95], v12 offset:35840
  v_mfma_f32_16x16x32_bf16 v[244:247], v[56:59], v[100:103], v[244:247]
  s_waitcnt vmcnt(9)
  s_barrier
  s_waitcnt lgkmcnt(8)
  v_mfma_f32_16x16x32_bf16 v[176:179], v[60:63], v[104:107], v[176:179]
  ds_read_b128 v[24:27], v13 offset:0
  v_mfma_f32_16x16x32_bf16 v[180:183], v[60:63], v[108:111], v[180:183]
  s_waitcnt lgkmcnt(8)
  v_mfma_f32_16x16x32_bf16 v[184:187], v[64:67], v[104:107], v[184:187]
  ds_read_b128 v[28:31], v13 offset:1024
  v_mfma_f32_16x16x32_bf16 v[188:191], v[64:67], v[108:111], v[188:191]
  s_waitcnt lgkmcnt(8)
  v_mfma_f32_16x16x32_bf16 v[192:195], v[68:71], v[104:107], v[192:195]
  ds_read_b128 v[32:35], v13 offset:2048
  v_mfma_f32_16x16x32_bf16 v[196:199], v[68:71], v[108:111], v[196:199]
  s_waitcnt lgkmcnt(8)
  v_mfma_f32_16x16x32_bf16 v[200:203], v[72:75], v[104:107], v[200:203]
  ds_read_b128 v[36:39], v13 offset:3072
  v_mfma_f32_16x16x32_bf16 v[204:207], v[72:75], v[108:111], v[204:207]
  s_waitcnt lgkmcnt(8)
  v_mfma_f32_16x16x32_bf16 v[208:211], v[76:79], v[104:107], v[208:211]
  ds_read_b128 v[40:43], v13 offset:4096
  v_mfma_f32_16x16x32_bf16 v[212:215], v[76:79], v[108:111], v[212:215]
  s_waitcnt lgkmcnt(8)
  v_mfma_f32_16x16x32_bf16 v[216:219], v[80:83], v[104:107], v[216:219]
  ds_read_b128 v[44:47], v13 offset:5120
  v_mfma_f32_16x16x32_bf16 v[220:223], v[80:83], v[108:111], v[220:223]
  s_waitcnt lgkmcnt(8)
  v_mfma_f32_16x16x32_bf16 v[224:227], v[84:87], v[104:107], v[224:227]
  ds_read_b128 v[48:51], v13 offset:6144
  v_mfma_f32_16x16x32_bf16 v[228:231], v[84:87], v[108:111], v[228:231]
  s_waitcnt lgkmcnt(8)
  v_mfma_f32_16x16x32_bf16 v[232:235], v[88:91], v[104:107], v[232:235]
  ds_read_b128 v[52:55], v13 offset:7168
  v_mfma_f32_16x16x32_bf16 v[236:239], v[88:91], v[108:111], v[236:239]
  s_waitcnt lgkmcnt(8)
  v_mfma_f32_16x16x32_bf16 v[240:243], v[92:95], v[104:107], v[240:243]
  ds_read_b128 v[56:59], v13 offset:8192
  v_mfma_f32_16x16x32_bf16 v[244:247], v[92:95], v[108:111], v[244:247]
  s_waitcnt lgkmcnt(8)
  v_mfma_f32_16x16x32_bf16 v[176:179], v[24:27], v[112:115], v[176:179]
  ds_read_b128 v[60:63], v13 offset:9216
  v_mfma_f32_16x16x32_bf16 v[180:183], v[24:27], v[116:119], v[180:183]
  s_waitcnt lgkmcnt(8)
  v_mfma_f32_16x16x32_bf16 v[184:187], v[28:31], v[112:115], v[184:187]
  ds_read_b128 v[64:67], v13 offset:10240
  v_mfma_f32_16x16x32_bf16 v[188:191], v[28:31], v[116:119], v[188:191]
  s_waitcnt lgkmcnt(8)
  v_mfma_f32_16x16x32_bf16 v[192:195], v[32:35], v[112:115], v[192:195]
  ds_read_b128 v[68:71], v13 offset:11264
  v_mfma_f32_16x16x32_bf16 v[196:199], v[32:35], v[116:119], v[196:199]
  s_waitcnt lgkmcnt(8)
  v_mfma_f32_16x16x32_bf16 v[200:203], v[36:39], v[112:115], v[200:203]
  ds_read_b128 v[72:75], v13 offset:12288
  v_mfma_f32_16x16x32_bf16 v[204:207], v[36:39], v[116:119], v[204:207]
  s_waitcnt lgkmcnt(8)
  v_mfma_f32_16x16x32_bf16 v[208:211], v[40:43], v[112:115], v[208:211]
  ds_read_b128 v[76:79], v13 offset:13312
  v_mfma_f32_16x16x32_bf16 v[212:215], v[40:43], v[116:119], v[212:215]
  s_waitcnt lgkmcnt(8)
  v_mfma_f32_16x16x32_bf16 v[216:219], v[44:47], v[112:115], v[216:219]
  ds_read_b128 v[80:83], v13 offset:14336
  v_mfma_f32_16x16x32_bf16 v[220:223], v[44:47], v[116:119], v[220:223]
  s_waitcnt lgkmcnt(8)
  v_mfma_f32_16x16x32_bf16 v[224:227], v[48:51], v[112:115], v[224:227]
  ds_read_b128 v[84:87], v13 offset:15360
  v_mfma_f32_16x16x32_bf16 v[228:231], v[48:51], v[116:119], v[228:231]
  s_waitcnt lgkmcnt(8)
  v_mfma_f32_16x16x32_bf16 v[232:235], v[52:55], v[112:115], v[232:235]
  ds_read_b128 v[88:91], v13 offset:16384
  v_mfma_f32_16x16x32_bf16 v[236:239], v[52:55], v[116:119], v[236:239]
  s_waitcnt lgkmcnt(8)
  v_mfma_f32_16x16x32_bf16 v[240:243], v[56:59], v[112:115], v[240:243]
  ds_read_b128 v[92:95], v13 offset:17408
  v_mfma_f32_16x16x32_bf16 v[244:247], v[56:59], v[116:119], v[244:247]
  s_waitcnt lgkmcnt(8)
  v_mfma_f32_16x16x32_bf16 v[176:179], v[60:63], v[120:123], v[176:179]
  ds_read_b128 v[24:27], v13 offset:18432
  v_mfma_f32_16x16x32_bf16 v[180:183], v[60:63], v[124:127], v[180:183]
  s_waitcnt lgkmcnt(8)
  v_mfma_f32_16x16x32_bf16 v[184:187], v[64:67], v[120:123], v[184:187]
  ds_read_b128 v[28:31], v13 offset:19456
  v_mfma_f32_16x16x32_bf16 v[188:191], v[64:67], v[124:127], v[188:191]
  s_waitcnt lgkmcnt(8)
  v_mfma_f32_16x16x32_bf16 v[192:195], v[68:71], v[120:123], v[192:195]
  ds_read_b128 v[32:35], v13 offset:20480
  v_mfma_f32_16x16x32_bf16 v[196:199], v[68:71], v[124:127], v[196:199]
  s_waitcnt lgkmcnt(8)
  v_mfma_f32_16x16x32_bf16 v[200:203], v[72:75], v[120:123], v[200:203]
  ds_read_b128 v[36:39], v13 offset:21504
  v_mfma_f32_16x16x32_bf16 v[204:207], v[72:75], v[124:127], v[204:207]
  s_waitcnt lgkmcnt(8)
  v_mfma_f32_16x16x32_bf16 v[208:211], v[76:79], v[120:123], v[208:211]
  ds_read_b128 v[40:43], v13 offset:22528
  v_mfma_f32_16x16x32_bf16 v[212:215], v[76:79], v[124:127], v[212:215]
  s_waitcnt lgkmcnt(8)
  v_mfma_f32_16x16x32_bf16 v[216:219], v[80:83], v[120:123], v[216:219]
  ds_read_b128 v[44:47], v13 offset:23552
  v_mfma_f32_16x16x32_bf16 v[220:223], v[80:83], v[124:127], v[220:223]
  s_waitcnt lgkmcnt(8)
  v_mfma_f32_16x16x32_bf16 v[224:227], v[84:87], v[120:123], v[224:227]
  ds_read_b128 v[48:51], v13 offset:24576
  v_mfma_f32_16x16x32_bf16 v[228:231], v[84:87], v[124:127], v[228:231]
  s_waitcnt lgkmcnt(8)
  v_mfma_f32_16x16x32_bf16 v[232:235], v[88:91], v[120:123], v[232:235]
  ds_read_b128 v[52:55], v13 offset:25600
  v_mfma_f32_16x16x32_bf16 v[236:239], v[88:91], v[124:127], v[236:239]
  s_waitcnt lgkmcnt(8)
  v_mfma_f32_16x16x32_bf16 v[240:243], v[92:95], v[120:123], v[240:243]
  ds_read_b128 v[56:59], v13 offset:26624
  v_mfma_f32_16x16x32_bf16 v[244:247], v[92:95], v[124:127], v[244:247]
  s_waitcnt lgkmcnt(8)
  v_mfma_f32_16x16x32_bf16 v[176:179], v[24:27], v[128:131], v[176:179]
  ds_read_b128 v[60:63], v13 offset:27648
  v_mfma_f32_16x16x32_bf16 v[180:183], v[24:27], v[132:135], v[180:183]
  s_waitcnt lgkmcnt(8)
  v_mfma_f32_16x16x32_bf16 v[184:187], v[28:31], v[128:131], v[184:187]
  ds_read_b128 v[64:67], v13 offset:28672
  v_mfma_f32_16x16x32_bf16 v[188:191], v[28:31], v[132:135], v[188:191]
  s_waitcnt lgkmcnt(8)
  v_mfma_f32_16x16x32_bf16 v[192:195], v[32:35], v[128:131], v[192:195]
  ds_read_b128 v[68:71], v13 offset:29696
  v_mfma_f32_16x16x32_bf16 v[196:199], v[32:35], v[132:135], v[196:199]
  s_waitcnt lgkmcnt(8)
  v_mfma_f32_16x16x32_bf16 v[200:203], v[36:39], v[128:131], v[200:203]
  ds_read_b128 v[72:75], v13 offset:30720
  v_mfma_f32_16x16x32_bf16 v[204:207], v[36:39], v[132:135], v[204:207]
  s_waitcnt lgkmcnt(8)
  v_mfma_f32_16x16x32_bf16 v[208:211], v[40:43], v[128:131], v[208:211]
  ds_read_b128 v[76:79], v13 offset:31744
  v_mfma_f32_16x16x32_bf16 v[212:215], v[40:43], v[132:135], v[212:215]
  s_waitcnt lgkmcnt(8)
  v_mfma_f32_16x16x32_bf16 v[216:219], v[44:47], v[128:131], v[216:219]
  ds_read_b128 v[80:83], v13 offset:32768
  v_mfma_f32_16x16x32_bf16 v[220:223], v[44:47], v[132:135], v[220:223]
  s_waitcnt lgkmcnt(8)
  v_mfma_f32_16x16x32_bf16 v[224:227], v[48:51], v[128:131], v[224:227]
  ds_read_b128 v[84:87], v13 offset:33792
  v_mfma_f32_16x16x32_bf16 v[228:231], v[48:51], v[132:135], v[228:231]
  s_waitcnt lgkmcnt(8)
  v_mfma_f32_16x16x32_bf16 v[232:235], v[52:55], v[128:131], v[232:235]
  ds_read_b128 v[88:91], v13 offset:34816
  v_mfma_f32_16x16x32_bf16 v[236:239], v[52:55], v[132:135], v[236:239]
  s_waitcnt lgkmcnt(8)
  v_mfma_f32_16x16x32_bf16 v[240:243], v[56:59], v[128:131], v[240:243]
  ds_read_b128 v[92:95], v13 offset:35840
  v_mfma_f32_16x16x32_bf16 v[244:247], v[56:59], v[132:135], v[244:247]
  s_waitcnt vmcnt(0)
  s_barrier
  s_waitcnt lgkmcnt(8)
  v_mfma_f32_16x16x32_bf16 v[176:179], v[60:63], v[136:139], v[176:179]
  ds_read_b128 v[24:27], v1 offset:0
  v_mfma_f32_16x16x32_bf16 v[180:183], v[60:63], v[140:143], v[180:183]
  s_waitcnt lgkmcnt(8)
  v_mfma_f32_16x16x32_bf16 v[184:187], v[64:67], v[136:139], v[184:187]
  ds_read_b128 v[28:31], v1 offset:1024
  v_mfma_f32_16x16x32_bf16 v[188:191], v[64:67], v[140:143], v[188:191]
  s_waitcnt lgkmcnt(8)
  v_mfma_f32_16x16x32_bf16 v[192:195], v[68:71], v[136:139], v[192:195]
  ds_read_b128 v[32:35], v1 offset:2048
  v_mfma_f32_16x16x32_bf16 v[196:199], v[68:71], v[140:143], v[196:199]
  s_waitcnt lgkmcnt(8)
  v_mfma_f32_16x16x32_bf16 v[200:203], v[72:75], v[136:139], v[200:203]
  ds_read_b128 v[36:39], v1 offset:3072
  v_mfma_f32_16x16x32_bf16 v[204:207], v[72:75], v[140:143], v[204:207]
  s_waitcnt lgkmcnt(8)
  v_mfma_f32_16x16x32_bf16 v[208:211], v[76:79], v[136:139], v[208:211]
  ds_read_b128 v[40:43], v1 offset:4096
  v_mfma_f32_16x16x32_bf16 v[212:215], v[76:79], v[140:143], v[212:215]
  s_waitcnt lgkmcnt(8)
  v_mfma_f32_16x16x32_bf16 v[216:219], v[80:83], v[136:139], v[216:219]
  ds_read_b128 v[44:47], v1 offset:5120
  v_mfma_f32_16x16x32_bf16 v[220:223], v[80:83], v[140:143], v[220:223]
  s_waitcnt lgkmcnt(8)
  v_mfma_f32_16x16x32_bf16 v[224:227], v[84:87], v[136:139], v[224:227]
  ds_read_b128 v[48:51], v1 offset:6144
  v_mfma_f32_16x16x32_bf16 v[228:231], v[84:87], v[140:143], v[228:231]
  s_waitcnt lgkmcnt(8)
  v_mfma_f32_16x16x32_bf16 v[232:235], v[88:91], v[136:139], v[232:235]
  ds_read_b128 v[52:55], v1 offset:7168
  v_mfma_f32_16x16x32_bf16 v[236:239], v[88:91], v[140:143], v[236:239]
  s_waitcnt lgkmcnt(8)
  v_mfma_f32_16x16x32_bf16 v[240:243], v[92:95], v[136:139], v[240:243]
  ds_read_b128 v[56:59], v1 offset:8192
  v_mfma_f32_16x16x32_bf16 v[244:247], v[92:95], v[140:143], v[244:247]
  s_waitcnt lgkmcnt(8)
  v_mfma_f32_16x16x32_bf16 v[176:179], v[24:27], v[144:147], v[176:179]
  ds_read_b128 v[60:63], v1 offset:9216
  v_mfma_f32_16x16x32_bf16 v[180:183], v[24:27], v[148:151], v[180:183]
  s_waitcnt lgkmcnt(8)
  v_mfma_f32_16x16x32_bf16 v[184:187], v[28:31], v[144:147], v[184:187]
  ds_read_b128 v[64:67], v1 offset:10240
  v_mfma_f32_16x16x32_bf16 v[188:191], v[28:31], v[148:151], v[188:191]
  s_waitcnt lgkmcnt(8)
  v_mfma_f32_16x16x32_bf16 v[192:195], v[32:35], v[144:147], v[192:195]
  ds_read_b128 v[68:71], v1 offset:11264
  v_mfma_f32_16x16x32_bf16 v[196:199], v[32:35], v[148:151], v[196:199]
  s_waitcnt lgkmcnt(8)
  v_mfma_f32_16x16x32_bf16 v[200:203], v[36:39], v[144:147], v[200:203]
  ds_read_b128 v[72:75], v1 offset:12288
  v_mfma_f32_16x16x32_bf16 v[204:207], v[36:39], v[148:151], v[204:207]
  s_waitcnt lgkmcnt(8)
  v_mfma_f32_16x16x32_bf16 v[208:211], v[40:43], v[144:147], v[208:211]
  ds_read_b128 v[76:79], v1 offset:13312
  v_mfma_f32_16x16x32_bf16 v[212:215], v[40:43], v[148:151], v[212:215]
  s_waitcnt lgkmcnt(8)
  v_mfma_f32_16x16x32_bf16 v[216:219], v[44:47], v[144:147], v[216:219]
  ds_read_b128 v[80:83], v1 offset:14336
  v_mfma_f32_16x16x32_bf16 v[220:223], v[44:47], v[148:151], v[220:223]
  s_waitcnt lgkmcnt(8)
  v_mfma_f32_16x16x32_bf16 v[224:227], v[48:51], v[144:147], v[224:227]
  ds_read_b128 v[84:87], v1 offset:15360
  v_mfma_f32_16x16x32_bf16 v[228:231], v[48:51], v[148:151], v[228:231]
  s_waitcnt lgkmcnt(8)
  v_mfma_f32_16x16x32_bf16 v[232:235], v[52:55], v[144:147], v[232:235]
  ds_read_b128 v[88:91], v1 offset:16384
  v_mfma_f32_16x16x32_bf16 v[236:239], v[52:55], v[148:151], v[236:239]
  s_waitcnt lgkmcnt(8)
  v_mfma_f32_16x16x32_bf16 v[240:243], v[56:59], v[144:147], v[240:243]
  ds_read_b128 v[92:95], v1 offset:17408
  v_mfma_f32_16x16x32_bf16 v[244:247], v[56:59], v[148:151], v[244:247]
  s_waitcnt lgkmcnt(8)
  v_mfma_f32_16x16x32_bf16 v[176:179], v[60:63], v[152:155], v[176:179]
  ds_read_b128 v[24:27], v1 offset:18432
  v_mfma_f32_16x16x32_bf16 v[180:183], v[60:63], v[156:159], v[180:183]
  s_waitcnt lgkmcnt(8)
  v_mfma_f32_16x16x32_bf16 v[184:187], v[64:67], v[152:155], v[184:187]
  ds_read_b128 v[28:31], v1 offset:19456
  v_mfma_f32_16x16x32_bf16 v[188:191], v[64:67], v[156:159], v[188:191]
  s_waitcnt lgkmcnt(8)
  v_mfma_f32_16x16x32_bf16 v[192:195], v[68:71], v[152:155], v[192:195]
  ds_read_b128 v[32:35], v1 offset:20480
  v_mfma_f32_16x16x32_bf16 v[196:199], v[68:71], v[156:159], v[196:199]
  s_waitcnt lgkmcnt(8)
  v_mfma_f32_16x16x32_bf16 v[200:203], v[72:75], v[152:155], v[200:203]
  ds_read_b128 v[36:39], v1 offset:21504
  v_mfma_f32_16x16x32_bf16 v[204:207], v[72:75], v[156:159], v[204:207]
  s_waitcnt lgkmcnt(8)
  v_mfma_f32_16x16x32_bf16 v[208:211], v[76:79], v[152:155], v[208:211]
  ds_read_b128 v[40:43], v1 offset:22528
  v_mfma_f32_16x16x32_bf16 v[212:215], v[76:79], v[156:159], v[212:215]
  s_waitcnt lgkmcnt(8)
  v_mfma_f32_16x16x32_bf16 v[216:219], v[80:83], v[152:155], v[216:219]
  ds_read_b128 v[44:47], v1 offset:23552
  v_mfma_f32_16x16x32_bf16 v[220:223], v[80:83], v[156:159], v[220:223]
  s_waitcnt lgkmcnt(8)
  v_mfma_f32_16x16x32_bf16 v[224:227], v[84:87], v[152:155], v[224:227]
  ds_read_b128 v[48:51], v1 offset:24576
  v_mfma_f32_16x16x32_bf16 v[228:231], v[84:87], v[156:159], v[228:231]
  s_waitcnt lgkmcnt(8)
  v_mfma_f32_16x16x32_bf16 v[232:235], v[88:91], v[152:155], v[232:235]
  ds_read_b128 v[52:55], v1 offset:25600
  v_mfma_f32_16x16x32_bf16 v[236:239], v[88:91], v[156:159], v[236:239]
  s_waitcnt lgkmcnt(8)
  v_mfma_f32_16x16x32_bf16 v[240:243], v[92:95], v[152:155], v[240:243]
  ds_read_b128 v[56:59], v1 offset:26624
  v_mfma_f32_16x16x32_bf16 v[244:247], v[92:95], v[156:159], v[244:247]
  s_waitcnt lgkmcnt(8)
  v_mfma_f32_16x16x32_bf16 v[176:179], v[24:27], v[160:163], v[176:179]
  ds_read_b128 v[60:63], v1 offset:27648
  v_mfma_f32_16x16x32_bf16 v[180:183], v[24:27], v[164:167], v[180:183]
  s_waitcnt lgkmcnt(8)
  v_mfma_f32_16x16x32_bf16 v[184:187], v[28:31], v[160:163], v[184:187]
  ds_read_b128 v[64:67], v1 offset:28672
  v_mfma_f32_16x16x32_bf16 v[188:191], v[28:31], v[164:167], v[188:191]
  s_waitcnt lgkmcnt(8)
  v_mfma_f32_16x16x32_bf16 v[192:195], v[32:35], v[160:163], v[192:195]
  ds_read_b128 v[68:71], v1 offset:29696
  v_mfma_f32_16x16x32_bf16 v[196:199], v[32:35], v[164:167], v[196:199]
  s_waitcnt lgkmcnt(8)
  v_mfma_f32_16x16x32_bf16 v[200:203], v[36:39], v[160:163], v[200:203]
  ds_read_b128 v[72:75], v1 offset:30720
  v_mfma_f32_16x16x32_bf16 v[204:207], v[36:39], v[164:167], v[204:207]
  s_waitcnt lgkmcnt(8)
  v_mfma_f32_16x16x32_bf16 v[208:211], v[40:43], v[160:163], v[208:211]
  ds_read_b128 v[76:79], v1 offset:31744
  v_mfma_f32_16x16x32_bf16 v[212:215], v[40:43], v[164:167], v[212:215]
  s_waitcnt lgkmcnt(8)
  v_mfma_f32_16x16x32_bf16 v[216:219], v[44:47], v[160:163], v[216:219]
  ds_read_b128 v[80:83], v1 offset:32768
  v_mfma_f32_16x16x32_bf16 v[220:223], v[44:47], v[164:167], v[220:223]
  s_waitcnt lgkmcnt(8)
  v_mfma_f32_16x16x32_bf16 v[224:227], v[48:51], v[160:163], v[224:227]
  ds_read_b128 v[84:87], v1 offset:33792
  v_mfma_f32_16x16x32_bf16 v[228:231], v[48:51], v[164:167], v[228:231]
  s_waitcnt lgkmcnt(8)
  v_mfma_f32_16x16x32_bf16 v[232:235], v[52:55], v[160:163], v[232:235]
  ds_read_b128 v[88:91], v1 offset:34816
  v_mfma_f32_16x16x32_bf16 v[236:239], v[52:55], v[164:167], v[236:239]
  s_waitcnt lgkmcnt(8)
  v_mfma_f32_16x16x32_bf16 v[240:243], v[56:59], v[160:163], v[240:243]
  ds_read_b128 v[92:95], v1 offset:35840
  v_mfma_f32_16x16x32_bf16 v[244:247], v[56:59], v[164:167], v[244:247]
  s_waitcnt lgkmcnt(8)
  v_mfma_f32_16x16x32_bf16 v[176:179], v[60:63], v[168:171], v[176:179]
  v_mfma_f32_16x16x32_bf16 v[180:183], v[60:63], v[172:175], v[180:183]
  s_waitcnt lgkmcnt(7)
  v_mfma_f32_16x16x32_bf16 v[184:187], v[64:67], v[168:171], v[184:187]
  v_mfma_f32_16x16x32_bf16 v[188:191], v[64:67], v[172:175], v[188:191]
  s_waitcnt lgkmcnt(6)
  v_mfma_f32_16x16x32_bf16 v[192:195], v[68:71], v[168:171], v[192:195]
  v_mfma_f32_16x16x32_bf16 v[196:199], v[68:71], v[172:175], v[196:199]
  s_waitcnt lgkmcnt(5)
  v_mfma_f32_16x16x32_bf16 v[200:203], v[72:75], v[168:171], v[200:203]
  v_mfma_f32_16x16x32_bf16 v[204:207], v[72:75], v[172:175], v[204:207]
  s_waitcnt lgkmcnt(4)
  v_mfma_f32_16x16x32_bf16 v[208:211], v[76:79], v[168:171], v[208:211]
  v_mfma_f32_16x16x32_bf16 v[212:215], v[76:79], v[172:175], v[212:215]
  s_waitcnt lgkmcnt(3)
  v_mfma_f32_16x16x32_bf16 v[216:219], v[80:83], v[168:171], v[216:219]
  v_mfma_f32_16x16x32_bf16 v[220:223], v[80:83], v[172:175], v[220:223]
  s_waitcnt lgkmcnt(2)
  v_mfma_f32_16x16x32_bf16 v[224:227], v[84:87], v[168:171], v[224:227]
  v_mfma_f32_16x16x32_bf16 v[228:231], v[84:87], v[172:175], v[228:231]
  s_waitcnt lgkmcnt(1)
  v_mfma_f32_16x16x32_bf16 v[232:235], v[88:91], v[168:171], v[232:235]
  v_mfma_f32_16x16x32_bf16 v[236:239], v[88:91], v[172:175], v[236:239]
  s_waitcnt lgkmcnt(0)
  v_mfma_f32_16x16x32_bf16 v[240:243], v[92:95], v[168:171], v[240:243]
  v_mfma_f32_16x16x32_bf16 v[244:247], v[92:95], v[172:175], v[244:247]
  s_lshl_b32 s44, s82, 2
  s_add_u32 s44, s44, s83
  s_lshl_b32 s75, s44, 7
  s_add_u32 s75, s75, 71991296
  s_mul_i32 s44, s44, 147456
  s_add_u32 s44, s44, 218103808
  s_lshl_b32 s45, s21, 2
  s_add_u32 s45, s45, s84
  s_mul_i32 s45, s45, 9216
  s_add_u32 s45, s45, s44
  s_mul_i32 s46, s84, 36864
  s_add_u32 s46, s46, s44
  s_nop 3
  v_cvt_pk_bf16_f32 v24, v176, v177
  v_cvt_pk_bf16_f32 v25, v178, v179
  v_cvt_pk_bf16_f32 v26, v180, v181
  v_cvt_pk_bf16_f32 v27, v182, v183
  buffer_store_dwordx4 v[24:27], v1, s[8:11], s45 offen offset:0 sc1
  v_cvt_pk_bf16_f32 v28, v184, v185
  v_cvt_pk_bf16_f32 v29, v186, v187
  v_cvt_pk_bf16_f32 v30, v188, v189
  v_cvt_pk_bf16_f32 v31, v190, v191
  buffer_store_dwordx4 v[28:31], v1, s[8:11], s45 offen offset:1024 sc1
  v_cvt_pk_bf16_f32 v32, v192, v193
  v_cvt_pk_bf16_f32 v33, v194, v195
  v_cvt_pk_bf16_f32 v34, v196, v197
  v_cvt_pk_bf16_f32 v35, v198, v199
  buffer_store_dwordx4 v[32:35], v1, s[8:11], s45 offen offset:2048 sc1
  v_cvt_pk_bf16_f32 v36, v200, v201
  v_cvt_pk_bf16_f32 v37, v202, v203
  v_cvt_pk_bf16_f32 v38, v204, v205
  v_cvt_pk_bf16_f32 v39, v206, v207
  buffer_store_dwordx4 v[36:39], v1, s[8:11], s45 offen offset:3072 sc1
  s_add_u32 s45, s45, 4096
  v_cvt_pk_bf16_f32 v40, v208, v209
  v_cvt_pk_bf16_f32 v41, v210, v211
  v_cvt_pk_bf16_f32 v42, v212, v213
  v_cvt_pk_bf16_f32 v43, v214, v215
  buffer_store_dwordx4 v[40:43], v1, s[8:11], s45 offen offset:0 sc1
  v_cvt_pk_bf16_f32 v44, v216, v217
  v_cvt_pk_bf16_f32 v45, v218, v219
  v_cvt_pk_bf16_f32 v46, v220, v221
  v_cvt_pk_bf16_f32 v47, v222, v223
  buffer_store_dwordx4 v[44:47], v1, s[8:11], s45 offen offset:1024 sc1
  v_cvt_pk_bf16_f32 v48, v224, v225
  v_cvt_pk_bf16_f32 v49, v226, v227
  v_cvt_pk_bf16_f32 v50, v228, v229
  v_cvt_pk_bf16_f32 v51, v230, v231
  buffer_store_dwordx4 v[48:51], v1, s[8:11], s45 offen offset:2048 sc1
  v_cvt_pk_bf16_f32 v52, v232, v233
  v_cvt_pk_bf16_f32 v53, v234, v235
  v_cvt_pk_bf16_f32 v54, v236, v237
  v_cvt_pk_bf16_f32 v55, v238, v239
  buffer_store_dwordx4 v[52:55], v1, s[8:11], s45 offen offset:3072 sc1
  s_add_u32 s45, s45, 4096
  v_cvt_pk_bf16_f32 v56, v240, v241
  v_cvt_pk_bf16_f32 v57, v242, v243
  v_cvt_pk_bf16_f32 v58, v244, v245
  v_cvt_pk_bf16_f32 v59, v246, v247
  buffer_store_dwordx4 v[56:59], v1, s[8:11], s45 offen offset:0 sc1
  v_bfe_u32 v2, v0, 0, 4
  v_mul_u32_u24 v2, 1152, v2
  v_bfe_u32 v3, v0, 4, 2
  v_mul_u32_u24 v3, 8, v3
  v_add_u32 v2, v2, v3
  v_bfe_u32 v3, v0, 0, 4
  v_mul_u32_u24 v3, 2, v3
  v_add_u32 v4, 9216, v1
  v_add_u32 v5, 18432, v1
  v_add_u32 v6, 27648, v1
  v_add_u32 v7, 18432, v2
  s_min_u32 s44, s21, 2
  s_mul_i32 s45, s44, 3072
  s_add_u32 s46, s46, s45
  s_lshl_b32 s50, s82, 2
  s_add_u32 s50, s50, s84
  s_mul_i32 s45, s50, 36864
  s_lshl_b32 s50, s50, 6
  s_mul_i32 s44, s44, 96
  s_add_u32 s45, s45, s44
  s_mul_i32 s44, s83, 288
  s_add_u32 s60, s45, s44
  s_add_u32 s45, s60, 92274688
  buffer_load_ushort v20, v3, s[24:27], s50 offen
  buffer_load_ushort v21, v3, s[24:27], s50 offen offset:32
  buffer_load_dwordx2 v[8:9], v2, s[8:11], s45 offen offset:0 sc1
  buffer_load_dwordx2 v[10:11], v7, s[8:11], s45 offen offset:0 sc1
  buffer_load_dwordx2 v[12:13], v2, s[8:11], s45 offen offset:32 sc1
  buffer_load_dwordx2 v[14:15], v7, s[8:11], s45 offen offset:32 sc1
  buffer_load_dwordx2 v[16:17], v2, s[8:11], s45 offen offset:64 sc1
  buffer_load_dwordx2 v[18:19], v7, s[8:11], s45 offen offset:64 sc1
  s_waitcnt vmcnt(0)
  s_barrier
  s_cmp_lg_u32 s21, 0
  s_cbranch_scc1 S_22
  v_mov_b32 v251, 1
  s_mov_b64 exec, 1
  buffer_atomic_add v251, off, s[8:11], s75 offset:0 sc1
  s_mov_b64 exec, -1
S_22:
  s_cmp_lg_u32 s21, 0
  s_cbranch_scc1 W_23_ok
  s_mov_b32 s79, 0
W_23:
  buffer_load_dword v251, off, s[8:11], s75 offset:0 sc1
  s_add_u32 s79, s79, 1
  s_cmp_gt_u32 s79, 0x40000
  s_cbranch_scc1 BG_END
  s_waitcnt vmcnt(0)
  v_readfirstlane_b32 s78, v251
  s_bfe_u32 s78, s78, 0x80000
  s_cmp_eq_u32 s78, 4
  s_cbranch_scc1 W_23_ok
  s_sleep 1
  s_branch W_23
W_23_ok:
  s_barrier
  s_cmp_eq_u32 s21, 3
  s_cbranch_scc1 BG_END
  buffer_load_dwordx4 v[64:67], v1, s[8:11], s46 offen offset:0 sc1
  buffer_load_dwordx4 v[68:71], v4, s[8:11], s46 offen offset:0 sc1
  buffer_load_dwordx4 v[72:75], v5, s[8:11], s46 offen offset:0 sc1
  buffer_load_dwordx4 v[76:79], v6, s[8:11], s46 offen offset:0 sc1
  buffer_load_dwordx4 v[80:83], v1, s[8:11], s46 offen offset:1024 sc1
  buffer_load_dwordx4 v[84:87], v4, s[8:11], s46 offen offset:1024 sc1
  buffer_load_dwordx4 v[88:91], v5, s[8:11], s46 offen offset:1024 sc1
  buffer_load_dwordx4 v[92:95], v6, s[8:11], s46 offen offset:1024 sc1
  buffer_load_dwordx4 v[96:99], v1, s[8:11], s46 offen offset:2048 sc1
  buffer_load_dwordx4 v[100:103], v4, s[8:11], s46 offen offset:2048 sc1
  buffer_load_dwordx4 v[104:107], v5, s[8:11], s46 offen offset:2048 sc1
  buffer_load_dwordx4 v[108:111], v6, s[8:11], s46 offen offset:2048 sc1
  v_lshlrev_b32 v20, 16, v20
  v_lshlrev_b32 v21, 16, v21
  v_lshlrev_b32 v24, 16, v8
  v_add_f32 v24, v20, v24
  v_and_b32 v25, 0xffff0000, v8
  v_add_f32 v25, v20, v25
  v_lshlrev_b32 v26, 16, v9
  v_add_f32 v26, v20, v26
  v_and_b32 v27, 0xffff0000, v9
  v_add_f32 v27, v20, v27
  v_lshlrev_b32 v28, 16, v10
  v_add_f32 v28, v21, v28
  v_and_b32 v29, 0xffff0000, v10
  v_add_f32 v29, v21, v29
  v_lshlrev_b32 v30, 16, v11
  v_add_f32 v30, v21, v30
  v_and_b32 v31, 0xffff0000, v11
  v_add_f32 v31, v21, v31
  s_waitcnt vmcnt(8)
  v_lshlrev_b32 v32, 16, v64
  v_and_b32 v33, 0xffff0000, v64
  v_lshlrev_b32 v34, 16, v65
  v_and_b32 v35, 0xffff0000, v65
  v_lshlrev_b32 v36, 16, v66
  v_and_b32 v37, 0xffff0000, v66
  v_lshlrev_b32 v38, 16, v67
  v_and_b32 v39, 0xffff0000, v67
  v_pk_add_f32 v[24:25], v[24:25], v[32:33]
  v_pk_add_f32 v[26:27], v[26:27], v[34:35]
  v_pk_add_f32 v[28:29], v[28:29], v[36:37]
  v_pk_add_f32 v[30:31], v[30:31], v[38:39]
  v_lshlrev_b32 v32, 16, v68
  v_and_b32 v33, 0xffff0000, v68
  v_lshlrev_b32 v34, 16, v69
  v_and_b32 v35, 0xffff0000, v69
  v_lshlrev_b32 v36, 16, v70
  v_and_b32 v37, 0xffff0000, v70
  v_lshlrev_b32 v38, 16, v71
  v_and_b32 v39, 0xffff0000, v71
  v_pk_add_f32 v[24:25], v[24:25], v[32:33]
  v_pk_add_f32 v[26:27], v[26:27], v[34:35]
  v_pk_add_f32 v[28:29], v[28:29], v[36:37]
  v_pk_add_f32 v[30:31], v[30:31], v[38:39]
  v_lshlrev_b32 v32, 16, v72
  v_and_b32 v33, 0xffff0000, v72
  v_lshlrev_b32 v34, 16, v73
  v_and_b32 v35, 0xffff0000, v73
  v_lshlrev_b32 v36, 16, v74
  v_and_b32 v37, 0xffff0000, v74
  v_lshlrev_b32 v38, 16, v75
  v_and_b32 v39, 0xffff0000, v75
  v_pk_add_f32 v[24:25], v[24:25], v[32:33]
  v_pk_add_f32 v[26:27], v[26:27], v[34:35]
  v_pk_add_f32 v[28:29], v[28:29], v[36:37]
  v_pk_add_f32 v[30:31], v[30:31], v[38:39]
  v_lshlrev_b32 v32, 16, v76
  v_and_b32 v33, 0xffff0000, v76
  v_lshlrev_b32 v34, 16, v77
  v_and_b32 v35, 0xffff0000, v77
  v_lshlrev_b32 v36, 16, v78
  v_and_b32 v37, 0xffff0000, v78
  v_lshlrev_b32 v38, 16, v79
  v_and_b32 v39, 0xffff0000, v79
  v_pk_add_f32 v[24:25], v[24:25], v[32:33]
  v_pk_add_f32 v[26:27], v[26:27], v[34:35]
  v_pk_add_f32 v[28:29], v[28:29], v[36:37]
  v_pk_add_f32 v[30:31], v[30:31], v[38:39]
  v_cvt_pk_bf16_f32 v8, v24, v25
  v_cvt_pk_bf16_f32 v9, v26, v27
  v_cvt_pk_bf16_f32 v10, v28, v29
  v_cvt_pk_bf16_f32 v11, v30, v31
  buffer_store_dwordx2 v[8:9], v2, s[28:31], s60 offen offset:0
  buffer_store_dwordx2 v[10:11], v7, s[28:31], s60 offen offset:0
  v_lshlrev_b32 v24, 16, v12
  v_add_f32 v24, v20, v24
  v_and_b32 v25, 0xffff0000, v12
  v_add_f32 v25, v20, v25
  v_lshlrev_b32 v26, 16, v13
  v_add_f32 v26, v20, v26
  v_and_b32 v27, 0xffff0000, v13
  v_add_f32 v27, v20, v27
  v_lshlrev_b32 v28, 16, v14
  v_add_f32 v28, v21, v28
  v_and_b32 v29, 0xffff0000, v14
  v_add_f32 v29, v21, v29
  v_lshlrev_b32 v30, 16, v15
  v_add_f32 v30, v21, v30
  v_and_b32 v31, 0xffff0000, v15
  v_add_f32 v31, v21, v31
  s_waitcnt vmcnt(6)
  v_lshlrev_b32 v32, 16, v80
  v_and_b32 v33, 0xffff0000, v80
  v_lshlrev_b32 v34, 16, v81
  v_and_b32 v35, 0xffff0000, v81
  v_lshlrev_b32 v36, 16, v82
  v_and_b32 v37, 0xffff0000, v82
  v_lshlrev_b32 v38, 16, v83
  v_and_b32 v39, 0xffff0000, v83
  v_pk_add_f32 v[24:25], v[24:25], v[32:33]
  v_pk_add_f32 v[26:27], v[26:27], v[34:35]
  v_pk_add_f32 v[28:29], v[28:29], v[36:37]
  v_pk_add_f32 v[30:31], v[30:31], v[38:39]
  v_lshlrev_b32 v32, 16, v84
  v_and_b32 v33, 0xffff0000, v84
  v_lshlrev_b32 v34, 16, v85
  v_and_b32 v35, 0xffff0000, v85
  v_lshlrev_b32 v36, 16, v86
  v_and_b32 v37, 0xffff0000, v86
  v_lshlrev_b32 v38, 16, v87
  v_and_b32 v39, 0xffff0000, v87
  v_pk_add_f32 v[24:25], v[24:25], v[32:33]
  v_pk_add_f32 v[26:27], v[26:27], v[34:35]
  v_pk_add_f32 v[28:29], v[28:29], v[36:37]
  v_pk_add_f32 v[30:31], v[30:31], v[38:39]
  v_lshlrev_b32 v32, 16, v88
  v_and_b32 v33, 0xffff0000, v88
  v_lshlrev_b32 v34, 16, v89
  v_and_b32 v35, 0xffff0000, v89
  v_lshlrev_b32 v36, 16, v90
  v_and_b32 v37, 0xffff0000, v90
  v_lshlrev_b32 v38, 16, v91
  v_and_b32 v39, 0xffff0000, v91
  v_pk_add_f32 v[24:25], v[24:25], v[32:33]
  v_pk_add_f32 v[26:27], v[26:27], v[34:35]
  v_pk_add_f32 v[28:29], v[28:29], v[36:37]
  v_pk_add_f32 v[30:31], v[30:31], v[38:39]
  v_lshlrev_b32 v32, 16, v92
  v_and_b32 v33, 0xffff0000, v92
  v_lshlrev_b32 v34, 16, v93
  v_and_b32 v35, 0xffff0000, v93
  v_lshlrev_b32 v36, 16, v94
  v_and_b32 v37, 0xffff0000, v94
  v_lshlrev_b32 v38, 16, v95
  v_and_b32 v39, 0xffff0000, v95
  v_pk_add_f32 v[24:25], v[24:25], v[32:33]
  v_pk_add_f32 v[26:27], v[26:27], v[34:35]
  v_pk_add_f32 v[28:29], v[28:29], v[36:37]
  v_pk_add_f32 v[30:31], v[30:31], v[38:39]
  v_cvt_pk_bf16_f32 v12, v24, v25
  v_cvt_pk_bf16_f32 v13, v26, v27
  v_cvt_pk_bf16_f32 v14, v28, v29
  v_cvt_pk_bf16_f32 v15, v30, v31
  buffer_store_dwordx2 v[12:13], v2, s[28:31], s60 offen offset:32
  buffer_store_dwordx2 v[14:15], v7, s[28:31], s60 offen offset:32
  v_lshlrev_b32 v24, 16, v16
  v_add_f32 v24, v20, v24
  v_and_b32 v25, 0xffff0000, v16
  v_add_f32 v25, v20, v25
  v_lshlrev_b32 v26, 16, v17
  v_add_f32 v26, v20, v26
  v_and_b32 v27, 0xffff0000, v17
  v_add_f32 v27, v20, v27
  v_lshlrev_b32 v28, 16, v18
  v_add_f32 v28, v21, v28
  v_and_b32 v29, 0xffff0000, v18
  v_add_f32 v29, v21, v29
  v_lshlrev_b32 v30, 16, v19
  v_add_f32 v30, v21, v30
  v_and_b32 v31, 0xffff0000, v19
  v_add_f32 v31, v21, v31
  s_waitcnt vmcnt(4)
  v_lshlrev_b32 v32, 16, v96
  v_and_b32 v33, 0xffff0000, v96
  v_lshlrev_b32 v34, 16, v97
  v_and_b32 v35, 0xffff0000, v97
  v_lshlrev_b32 v36, 16, v98
  v_and_b32 v37, 0xffff0000, v98
  v_lshlrev_b32 v38, 16, v99
  v_and_b32 v39, 0xffff0000, v99
  v_pk_add_f32 v[24:25], v[24:25], v[32:33]
  v_pk_add_f32 v[26:27], v[26:27], v[34:35]
  v_pk_add_f32 v[28:29], v[28:29], v[36:37]
  v_pk_add_f32 v[30:31], v[30:31], v[38:39]
  v_lshlrev_b32 v32, 16, v100
  v_and_b32 v33, 0xffff0000, v100
  v_lshlrev_b32 v34, 16, v101
  v_and_b32 v35, 0xffff0000, v101
  v_lshlrev_b32 v36, 16, v102
  v_and_b32 v37, 0xffff0000, v102
  v_lshlrev_b32 v38, 16, v103
  v_and_b32 v39, 0xffff0000, v103
  v_pk_add_f32 v[24:25], v[24:25], v[32:33]
  v_pk_add_f32 v[26:27], v[26:27], v[34:35]
  v_pk_add_f32 v[28:29], v[28:29], v[36:37]
  v_pk_add_f32 v[30:31], v[30:31], v[38:39]
  v_lshlrev_b32 v32, 16, v104
  v_and_b32 v33, 0xffff0000, v104
  v_lshlrev_b32 v34, 16, v105
  v_and_b32 v35, 0xffff0000, v105
  v_lshlrev_b32 v36, 16, v106
  v_and_b32 v37, 0xffff0000, v106
  v_lshlrev_b32 v38, 16, v107
  v_and_b32 v39, 0xffff0000, v107
  v_pk_add_f32 v[24:25], v[24:25], v[32:33]
  v_pk_add_f32 v[26:27], v[26:27], v[34:35]
  v_pk_add_f32 v[28:29], v[28:29], v[36:37]
  v_pk_add_f32 v[30:31], v[30:31], v[38:39]
  v_lshlrev_b32 v32, 16, v108
  v_and_b32 v33, 0xffff0000, v108
  v_lshlrev_b32 v34, 16, v109
  v_and_b32 v35, 0xffff0000, v109
  v_lshlrev_b32 v36, 16, v110
  v_and_b32 v37, 0xffff0000, v110
  v_lshlrev_b32 v38, 16, v111
  v_and_b32 v39, 0xffff0000, v111
  v_pk_add_f32 v[24:25], v[24:25], v[32:33]
  v_pk_add_f32 v[26:27], v[26:27], v[34:35]
  v_pk_add_f32 v[28:29], v[28:29], v[36:37]
  v_pk_add_f32 v[30:31], v[30:31], v[38:39]
  v_cvt_pk_bf16_f32 v16, v24, v25
  v_cvt_pk_bf16_f32 v17, v26, v27
  v_cvt_pk_bf16_f32 v18, v28, v29
  v_cvt_pk_bf16_f32 v19, v30, v31
  buffer_store_dwordx2 v[16:17], v2, s[28:31], s60 offen offset:64
  buffer_store_dwordx2 v[18:19], v7, s[28:31], s60 offen offset:64
  s_waitcnt vmcnt(0)
BG_END:
  s_waitcnt vmcnt(0)
  s_endpgm
.section .rodata,"a"
.p2align 6
.amdhsa_kernel sequential_preLN__memory_aug_recurrent_mem_tr__mixer_token_mlp__prompt_kernel
  .amdhsa_next_free_vgpr 512
  .amdhsa_next_free_sgpr 102
  .amdhsa_accum_offset 256
  .amdhsa_group_segment_fixed_size 0
  .amdhsa_kernarg_size 120
  .amdhsa_user_sgpr_count 2
  .amdhsa_user_sgpr_kernarg_segment_ptr 1
  .amdhsa_system_sgpr_workgroup_id_x 1
.end_amdhsa_kernel
```
